```python
import torch

def _softmax(x, axis=-1):
    return torch.softmax(x, dim=axis)
def _gelu(x):
    return torch.nn.functional.gelu(x, approximate="tanh")
def _silu(x):
    return torch.nn.functional.silu(x)
def _sigmoid(x):
    return torch.sigmoid(x)
def _layernorm(x, axis=-1, eps=1e-5):
    m = x.mean(dim=axis, keepdim=True)
    v = x.var(dim=axis, keepdim=True, unbiased=False)
    return (x - m) / torch.sqrt(v + eps)
def _scatter_add(tgt, idx, src, axis=0):
    return tgt.clone().index_add_(axis, idx, src)
def _segment_sum(src, seg, n):
    out = torch.zeros((n,) + src.shape[1:], dtype=src.dtype)
    return out.index_add_(0, seg, src)
def _pad(x, pw):
    flat = tuple(v for pair in reversed(pw) for v in pair)
    return torch.nn.functional.pad(x, flat)

kernel_name = 'standalone__gqa_block_cached__near_ridge'

def setup_inputs():

    _w = (lambda a: (lambda t: t.to(torch.bfloat16) if t.is_floating_point() else t)(torch.as_tensor(a)))
    B, Sq, D = 8, 112, 448
    Hq, Hkv, Sk, Dh = 16, 8, 1024, 256
    assert Hq % Hkv == 0, (Hq, Hkv)
    return {
        "x": _w((lambda *s: torch.randn(*s, dtype=torch.bfloat16) * 0.8)(B, Sq, D)),
        "k_cache": _w((lambda *s: torch.randn(*s, dtype=torch.bfloat16) * 0.8)(B, Hkv, Sk, Dh)),
        "v_cache": _w((lambda *s: torch.randn(*s, dtype=torch.bfloat16) * 0.05)(B, Hkv, Sk, Dh)),
        "wq": _w((lambda *s: torch.randn(*s, dtype=torch.bfloat16) * 0.8)(D, Hq * Dh) * (D ** -0.5)),
        "wo": _w((lambda *s: torch.randn(*s, dtype=torch.bfloat16) * 0.05)(Hq * Dh, D) * ((Hq * Dh) ** -0.5)),
    }

def reference(x, k_cache, v_cache, wq, wo):
    B, Sq, D = x.shape
    Hq, Dh = 16, 256
    Hkv = k_cache.shape[1]
    rep = Hq // Hkv
    q = (lambda x, *d: x.permute(*d))((x @ wq).reshape(B, Sq, Hq, Dh), 0, 2, 1, 3)
    k = (lambda x, n, axis: torch.repeat_interleave(x, n, dim=axis))(k_cache, rep, axis=1)
    v = (lambda x, n, axis: torch.repeat_interleave(x, n, dim=axis))(v_cache, rep, axis=1)
    scores = torch.einsum("bhqd,bhkd->bhqk", q, k) * (Dh ** -0.5)
    p = _softmax(scores, axis=-1)
    o = torch.einsum("bhqk,bhkd->bhqd", p, v)
    return (lambda x, *d: x.permute(*d))(o, 0, 2, 1, 3).reshape(B, Sq, Hq * Dh) @ wo
```

```asm
; @launch kernel=attn_kernel grid=(256,1,1) block=(256,1,1) lds=163840
; @launch kernel=oproj_kernel grid=(224,1,1) block=(256,1,1) lds=131072
.amdgcn_target "amdgcn-amd-amdhsa--gfx950"
.text
.globl attn_kernel
.p2align 8
.type attn_kernel,@function
attn_kernel:
    s_cmp_ge_u32 s2, 256
    s_cbranch_scc1 LA_end
    s_load_dwordx16 s[4:19], s[0:1], 0
    v_lshrrev_b32 v1, 6, v0
    s_nop 0
    v_readfirstlane_b32 s40, v1
    s_and_b32 s46, s2, 7
    s_lshr_b32 s45, s2, 3
    s_lshr_b32 s44, s45, 2
    s_lshr_b32 s49, s45, 1
    s_and_b32 s49, s49, 1
    s_and_b32 s42, s45, 1
    s_lshl_b32 s48, s44, 1
    s_add_u32 s48, s48, s49
    s_mul_i32 s50, s46, 112
    s_lshl_b32 s51, s46, 3
    s_add_u32 s51, s51, s44
    s_waitcnt lgkmcnt(0)
    s_mov_b32 s20, s4
    s_mov_b32 s21, s5
    s_mov_b32 s22, 802816
    s_mov_b32 s23, 0x00020000
    s_lshl_b32 s52, s51, 19
    s_add_u32 s24, s6, s52
    s_addc_u32 s25, s7, 0
    s_mov_b32 s26, 524288
    s_mov_b32 s27, 0x00020000
    s_add_u32 s28, s8, s52
    s_addc_u32 s29, s9, 0
    s_mov_b32 s30, 524288
    s_mov_b32 s31, 0x00020000
    s_mov_b32 s32, s10
    s_mov_b32 s33, s11
    s_mov_b32 s34, 3670016
    s_mov_b32 s35, 0x00020000
    s_mov_b32 s36, s18
    s_mov_b32 s37, s19
    s_mov_b32 s38, 14794752
    s_mov_b32 s39, 0x00020000
    s_mov_b32 s92, s16
    s_mov_b32 s93, s17
    s_mov_b32 s94, 256
    s_mov_b32 s95, 0x00020000
    s_cmp_eq_u32 s2, 0
    s_cselect_b32 s94, s94, 0
    s_cmp_eq_u32 s40, 0
    s_cselect_b32 s94, s94, 0
    v_and_b32 v1, 63, v0
    v_and_b32 v2, 31, v1
    v_lshrrev_b32 v3, 5, v1
    v_bfe_u32 v4, v1, 4, 1
    v_bfe_u32 v5, v1, 2, 2
    v_and_b32 v6, 3, v1
    s_lshl_b32 s52, s40, 3
    v_add_u32 v9, 0, v3
    v_add_u32 v9, s52, v9
    v_and_b32 v38, 15, v9
    v_xor_b32 v38, v38, v2
    v_lshlrev_b32 v38, 4, v38
    v_lshl_add_u32 v28, v9, 9, v38
    v_add_u32 v9, 2, v3
    v_add_u32 v9, s52, v9
    v_and_b32 v38, 15, v9
    v_xor_b32 v38, v38, v2
    v_lshlrev_b32 v38, 4, v38
    v_lshl_add_u32 v29, v9, 9, v38
    v_add_u32 v9, 4, v3
    v_add_u32 v9, s52, v9
    v_and_b32 v38, 15, v9
    v_xor_b32 v38, v38, v2
    v_lshlrev_b32 v38, 4, v38
    v_lshl_add_u32 v30, v9, 9, v38
    v_add_u32 v9, 6, v3
    v_add_u32 v9, s52, v9
    v_and_b32 v38, 15, v9
    v_xor_b32 v38, v38, v2
    v_lshlrev_b32 v38, 4, v38
    v_lshl_add_u32 v31, v9, 9, v38
    v_lshlrev_b32 v9, 2, v3
    v_add_u32 v9, 0, v9
    v_xor_b32 v9, v9, v2
    v_lshlrev_b32 v9, 4, v9
    v_lshl_add_u32 v36, v3, 9, v9
    v_lshlrev_b32 v9, 2, v3
    v_add_u32 v9, 8, v9
    v_xor_b32 v9, v9, v2
    v_lshlrev_b32 v9, 4, v9
    v_lshl_add_u32 v37, v3, 9, v9
    s_lshl_b32 s56, s40, 12
    s_lshl_b32 s57, s42, 18
    s_add_u32 s59, s57, s56
    v_lshlrev_b32 v9, 2, v3
    v_add_u32 v9, 0, v9
    v_xor_b32 v9, v9, v2
    v_lshlrev_b32 v9, 4, v9
    v_lshl_add_u32 v9, v3, 13, v9
    s_lshl_b32 s52, s48, 9
    v_add_u32 v10, s52, v9
    v_lshlrev_b32 v9, 2, v3
    v_add_u32 v9, 8, v9
    v_xor_b32 v9, v9, v2
    v_lshlrev_b32 v9, 4, v9
    v_lshl_add_u32 v9, v3, 13, v9
    s_lshl_b32 s52, s48, 9
    v_add_u32 v11, s52, v9
    s_lshl_b32 s52, s40, 5
    s_add_u32 s52, s52, s50
    v_add_u32 v7, s52, v2
    v_mul_u32_u24 v8, 896, v7
    v_lshl_add_u32 v8, v3, 4, v8
    s_add_u32 m0, s56, 65536
    s_lshl_b32 s53, s40, 16
    s_add_u32 s53, s53, 0
    buffer_load_dwordx4 v10, s[32:35], s53 offen lds
    s_add_u32 m0, s56, 66560
    s_lshl_b32 s53, s40, 16
    s_add_u32 s53, s53, 16384
    buffer_load_dwordx4 v11, s[32:35], s53 offen lds
    s_add_u32 m0, s56, 67584
    s_lshl_b32 s53, s40, 16
    s_add_u32 s53, s53, 32768
    buffer_load_dwordx4 v10, s[32:35], s53 offen lds
    s_add_u32 m0, s56, 68608
    s_lshl_b32 s53, s40, 16
    s_add_u32 s53, s53, 49152
    buffer_load_dwordx4 v11, s[32:35], s53 offen lds
    buffer_load_dwordx4 v[128:131], v8, s[20:23], 0 offen offset:0
    buffer_load_dwordx4 v[132:135], v8, s[20:23], 0 offen offset:32
    s_add_u32 m0, s56, 81920
    s_lshl_b32 s53, s40, 16
    s_add_u32 s53, s53, 262144
    buffer_load_dwordx4 v10, s[32:35], s53 offen lds
    s_add_u32 m0, s56, 82944
    s_lshl_b32 s53, s40, 16
    s_add_u32 s53, s53, 278528
    buffer_load_dwordx4 v11, s[32:35], s53 offen lds
    s_add_u32 m0, s56, 83968
    s_lshl_b32 s53, s40, 16
    s_add_u32 s53, s53, 294912
    buffer_load_dwordx4 v10, s[32:35], s53 offen lds
    s_add_u32 m0, s56, 84992
    s_lshl_b32 s53, s40, 16
    s_add_u32 s53, s53, 311296
    buffer_load_dwordx4 v11, s[32:35], s53 offen lds
    buffer_load_dwordx4 v[136:139], v8, s[20:23], 0 offen offset:64
    buffer_load_dwordx4 v[140:143], v8, s[20:23], 0 offen offset:96
    s_add_u32 m0, s56, 98304
    s_lshl_b32 s53, s40, 16
    s_add_u32 s53, s53, 524288
    buffer_load_dwordx4 v10, s[32:35], s53 offen lds
    s_add_u32 m0, s56, 99328
    s_lshl_b32 s53, s40, 16
    s_add_u32 s53, s53, 540672
    buffer_load_dwordx4 v11, s[32:35], s53 offen lds
    s_add_u32 m0, s56, 100352
    s_lshl_b32 s53, s40, 16
    s_add_u32 s53, s53, 557056
    buffer_load_dwordx4 v10, s[32:35], s53 offen lds
    s_add_u32 m0, s56, 101376
    s_lshl_b32 s53, s40, 16
    s_add_u32 s53, s53, 573440
    buffer_load_dwordx4 v11, s[32:35], s53 offen lds
    s_add_u32 m0, s56, 114688
    s_lshl_b32 s53, s40, 16
    s_add_u32 s53, s53, 786432
    buffer_load_dwordx4 v10, s[32:35], s53 offen lds
    s_add_u32 m0, s56, 115712
    s_lshl_b32 s53, s40, 16
    s_add_u32 s53, s53, 802816
    buffer_load_dwordx4 v11, s[32:35], s53 offen lds
    s_add_u32 m0, s56, 116736
    s_lshl_b32 s53, s40, 16
    s_add_u32 s53, s53, 819200
    buffer_load_dwordx4 v10, s[32:35], s53 offen lds
    s_add_u32 m0, s56, 117760
    s_lshl_b32 s53, s40, 16
    s_add_u32 s53, s53, 835584
    buffer_load_dwordx4 v11, s[32:35], s53 offen lds
    s_add_u32 m0, s56, 131072
    s_lshl_b32 s53, s40, 16
    s_add_u32 s53, s53, 1048576
    buffer_load_dwordx4 v10, s[32:35], s53 offen lds
    s_add_u32 m0, s56, 132096
    s_lshl_b32 s53, s40, 16
    s_add_u32 s53, s53, 1064960
    buffer_load_dwordx4 v11, s[32:35], s53 offen lds
    s_add_u32 m0, s56, 133120
    s_lshl_b32 s53, s40, 16
    s_add_u32 s53, s53, 1081344
    buffer_load_dwordx4 v10, s[32:35], s53 offen lds
    s_add_u32 m0, s56, 134144
    s_lshl_b32 s53, s40, 16
    s_add_u32 s53, s53, 1097728
    buffer_load_dwordx4 v11, s[32:35], s53 offen lds
    s_add_u32 m0, s56, 147456
    s_lshl_b32 s53, s40, 16
    s_add_u32 s53, s53, 1310720
    buffer_load_dwordx4 v10, s[32:35], s53 offen lds
    s_add_u32 m0, s56, 148480
    s_lshl_b32 s53, s40, 16
    s_add_u32 s53, s53, 1327104
    buffer_load_dwordx4 v11, s[32:35], s53 offen lds
    s_add_u32 m0, s56, 149504
    s_lshl_b32 s53, s40, 16
    s_add_u32 s53, s53, 1343488
    buffer_load_dwordx4 v10, s[32:35], s53 offen lds
    s_add_u32 m0, s56, 150528
    s_lshl_b32 s53, s40, 16
    s_add_u32 s53, s53, 1359872
    buffer_load_dwordx4 v11, s[32:35], s53 offen lds
    buffer_load_dwordx4 v[144:147], v8, s[20:23], 0 offen offset:128
    buffer_load_dwordx4 v[148:151], v8, s[20:23], 0 offen offset:160
    s_add_u32 m0, s56, 0
    s_add_u32 s58, s57, 0
    buffer_load_dwordx4 v28, s[24:27], s58 offen lds
    s_add_u32 m0, s56, 1024
    s_add_u32 s58, s57, 0
    buffer_load_dwordx4 v29, s[24:27], s58 offen lds
    s_add_u32 m0, s56, 2048
    s_add_u32 s58, s57, 0
    buffer_load_dwordx4 v30, s[24:27], s58 offen lds
    s_add_u32 m0, s56, 3072
    s_add_u32 s58, s57, 0
    buffer_load_dwordx4 v31, s[24:27], s58 offen lds
    s_add_u32 m0, s56, 16384
    s_add_u32 s58, s57, 16384
    buffer_load_dwordx4 v28, s[24:27], s58 offen lds
    s_add_u32 m0, s56, 17408
    s_add_u32 s58, s57, 16384
    buffer_load_dwordx4 v29, s[24:27], s58 offen lds
    s_add_u32 m0, s56, 18432
    s_add_u32 s58, s57, 16384
    buffer_load_dwordx4 v30, s[24:27], s58 offen lds
    s_add_u32 m0, s56, 19456
    s_add_u32 s58, s57, 16384
    buffer_load_dwordx4 v31, s[24:27], s58 offen lds
    v_lshlrev_b32 v9, 3, v3
    v_add_u32 v9, v9, v5
    v_lshlrev_b32 v9, 9, v9
    v_add_u32 v9, 65536, v9
    v_lshrrev_b32 v16, 1, v6
    v_lshl_add_u32 v16, v4, 1, v16
    v_lshl_add_u32 v9, v16, 4, v9
    v_and_b32 v16, 1, v6
    v_lshl_add_u32 v9, v16, 3, v9
    v_xor_b32 v16, 0, v5
    v_lshl_add_u32 v12, v16, 6, v9
    v_add_u32 v20, 65536, v12
    v_xor_b32 v16, 1, v5
    v_lshl_add_u32 v13, v16, 6, v9
    v_add_u32 v21, 65536, v13
    v_xor_b32 v16, 2, v5
    v_lshl_add_u32 v14, v16, 6, v9
    v_add_u32 v22, 65536, v14
    v_xor_b32 v16, 3, v5
    v_lshl_add_u32 v15, v16, 6, v9
    v_add_u32 v23, 65536, v15
    s_waitcnt vmcnt(34)
    s_barrier
    ds_read_b64_tr_b16 a[0:1], v12 offset:0
    ds_read_b64_tr_b16 a[2:3], v12 offset:2048
    ds_read_b64_tr_b16 a[4:5], v13 offset:0
    ds_read_b64_tr_b16 a[6:7], v13 offset:2048
    ds_read_b64_tr_b16 a[8:9], v14 offset:0
    ds_read_b64_tr_b16 a[10:11], v14 offset:2048
    ds_read_b64_tr_b16 a[12:13], v15 offset:0
    ds_read_b64_tr_b16 a[14:15], v15 offset:2048
    ds_read_b64_tr_b16 a[16:17], v12 offset:256
    ds_read_b64_tr_b16 a[18:19], v12 offset:2304
    ds_read_b64_tr_b16 a[20:21], v13 offset:256
    ds_read_b64_tr_b16 a[22:23], v13 offset:2304
    ds_read_b64_tr_b16 a[24:25], v14 offset:256
    ds_read_b64_tr_b16 a[26:27], v14 offset:2304
    ds_read_b64_tr_b16 a[28:29], v15 offset:256
    ds_read_b64_tr_b16 a[30:31], v15 offset:2304
    ds_read_b64_tr_b16 a[32:33], v12 offset:8192
    ds_read_b64_tr_b16 a[34:35], v12 offset:10240
    ds_read_b64_tr_b16 a[36:37], v13 offset:8192
    ds_read_b64_tr_b16 a[38:39], v13 offset:10240
    ds_read_b64_tr_b16 a[40:41], v14 offset:8192
    ds_read_b64_tr_b16 a[42:43], v14 offset:10240
    ds_read_b64_tr_b16 a[44:45], v15 offset:8192
    ds_read_b64_tr_b16 a[46:47], v15 offset:10240
    ds_read_b64_tr_b16 a[48:49], v12 offset:8448
    ds_read_b64_tr_b16 a[50:51], v12 offset:10496
    ds_read_b64_tr_b16 a[52:53], v13 offset:8448
    ds_read_b64_tr_b16 a[54:55], v13 offset:10496
    ds_read_b64_tr_b16 a[56:57], v14 offset:8448
    ds_read_b64_tr_b16 a[58:59], v14 offset:10496
    ds_read_b64_tr_b16 a[60:61], v15 offset:8448
    ds_read_b64_tr_b16 a[62:63], v15 offset:10496
    s_waitcnt vmcnt(28)
    s_barrier
    s_waitcnt lgkmcnt(0)
    v_mfma_f32_32x32x16_bf16 a[128:143], a[0:3], v[128:131], 0
    buffer_load_dwordx4 v[152:155], v8, s[20:23], 0 offen offset:192
    v_mfma_f32_32x32x16_bf16 a[144:159], a[4:7], v[128:131], 0
    buffer_load_dwordx4 v[156:159], v8, s[20:23], 0 offen offset:224
    v_mfma_f32_32x32x16_bf16 a[160:175], a[8:11], v[128:131], 0
    ds_read_b64_tr_b16 a[64:65], v12 offset:16384
    ds_read_b64_tr_b16 a[66:67], v12 offset:18432
    v_mfma_f32_32x32x16_bf16 a[176:191], a[12:15], v[128:131], 0
    ds_read_b64_tr_b16 a[68:69], v13 offset:16384
    ds_read_b64_tr_b16 a[70:71], v13 offset:18432
    v_mfma_f32_32x32x16_bf16 a[192:207], a[16:19], v[128:131], 0
    ds_read_b64_tr_b16 a[72:73], v14 offset:16384
    ds_read_b64_tr_b16 a[74:75], v14 offset:18432
    v_mfma_f32_32x32x16_bf16 a[208:223], a[20:23], v[128:131], 0
    ds_read_b64_tr_b16 a[76:77], v15 offset:16384
    ds_read_b64_tr_b16 a[78:79], v15 offset:18432
    v_mfma_f32_32x32x16_bf16 a[224:239], a[24:27], v[128:131], 0
    ds_read_b64_tr_b16 a[80:81], v12 offset:16640
    ds_read_b64_tr_b16 a[82:83], v12 offset:18688
    v_mfma_f32_32x32x16_bf16 a[240:255], a[28:31], v[128:131], 0
    ds_read_b64_tr_b16 a[84:85], v13 offset:16640
    ds_read_b64_tr_b16 a[86:87], v13 offset:18688
    ds_read_b64_tr_b16 a[88:89], v14 offset:16640
    ds_read_b64_tr_b16 a[90:91], v14 offset:18688
    v_mfma_f32_32x32x16_bf16 a[128:143], a[32:35], v[132:135], a[128:143]
    ds_read_b64_tr_b16 a[92:93], v15 offset:16640
    ds_read_b64_tr_b16 a[94:95], v15 offset:18688
    v_mfma_f32_32x32x16_bf16 a[144:159], a[36:39], v[132:135], a[144:159]
    ds_read_b64_tr_b16 a[96:97], v12 offset:24576
    ds_read_b64_tr_b16 a[98:99], v12 offset:26624
    v_mfma_f32_32x32x16_bf16 a[160:175], a[40:43], v[132:135], a[160:175]
    ds_read_b64_tr_b16 a[100:101], v13 offset:24576
    ds_read_b64_tr_b16 a[102:103], v13 offset:26624
    v_mfma_f32_32x32x16_bf16 a[176:191], a[44:47], v[132:135], a[176:191]
    ds_read_b64_tr_b16 a[104:105], v14 offset:24576
    ds_read_b64_tr_b16 a[106:107], v14 offset:26624
    v_mfma_f32_32x32x16_bf16 a[192:207], a[48:51], v[132:135], a[192:207]
    ds_read_b64_tr_b16 a[108:109], v15 offset:24576
    ds_read_b64_tr_b16 a[110:111], v15 offset:26624
    v_mfma_f32_32x32x16_bf16 a[208:223], a[52:55], v[132:135], a[208:223]
    ds_read_b64_tr_b16 a[112:113], v12 offset:24832
    ds_read_b64_tr_b16 a[114:115], v12 offset:26880
    v_mfma_f32_32x32x16_bf16 a[224:239], a[56:59], v[132:135], a[224:239]
    ds_read_b64_tr_b16 a[116:117], v13 offset:24832
    ds_read_b64_tr_b16 a[118:119], v13 offset:26880
    v_mfma_f32_32x32x16_bf16 a[240:255], a[60:63], v[132:135], a[240:255]
    ds_read_b64_tr_b16 a[120:121], v14 offset:24832
    ds_read_b64_tr_b16 a[122:123], v14 offset:26880
    ds_read_b64_tr_b16 a[124:125], v15 offset:24832
    ds_read_b64_tr_b16 a[126:127], v15 offset:26880
    s_waitcnt vmcnt(24)
    s_barrier
    s_waitcnt lgkmcnt(0)
    v_mfma_f32_32x32x16_bf16 a[128:143], a[64:67], v[136:139], a[128:143]
    s_add_u32 m0, s56, 65536
    s_lshl_b32 s53, s40, 16
    s_add_u32 s53, s53, 1572864
    buffer_load_dwordx4 v10, s[32:35], s53 offen lds
    v_mfma_f32_32x32x16_bf16 a[144:159], a[68:71], v[136:139], a[144:159]
    s_add_u32 m0, s56, 66560
    s_lshl_b32 s53, s40, 16
    s_add_u32 s53, s53, 1589248
    buffer_load_dwordx4 v11, s[32:35], s53 offen lds
    v_mfma_f32_32x32x16_bf16 a[160:175], a[72:75], v[136:139], a[160:175]
    s_add_u32 m0, s56, 67584
    s_lshl_b32 s53, s40, 16
    s_add_u32 s53, s53, 1605632
    buffer_load_dwordx4 v10, s[32:35], s53 offen lds
    s_add_u32 m0, s56, 68608
    s_lshl_b32 s53, s40, 16
    s_add_u32 s53, s53, 1622016
    buffer_load_dwordx4 v11, s[32:35], s53 offen lds
    v_mfma_f32_32x32x16_bf16 a[176:191], a[76:79], v[136:139], a[176:191]
    buffer_load_dwordx4 v[160:163], v8, s[20:23], 0 offen offset:256
    v_mfma_f32_32x32x16_bf16 a[192:207], a[80:83], v[136:139], a[192:207]
    buffer_load_dwordx4 v[164:167], v8, s[20:23], 0 offen offset:288
    v_mfma_f32_32x32x16_bf16 a[208:223], a[84:87], v[136:139], a[208:223]
    ds_read_b64_tr_b16 a[0:1], v12 offset:32768
    ds_read_b64_tr_b16 a[2:3], v12 offset:34816
    ds_read_b64_tr_b16 a[4:5], v13 offset:32768
    ds_read_b64_tr_b16 a[6:7], v13 offset:34816
    v_mfma_f32_32x32x16_bf16 a[224:239], a[88:91], v[136:139], a[224:239]
    ds_read_b64_tr_b16 a[8:9], v14 offset:32768
    ds_read_b64_tr_b16 a[10:11], v14 offset:34816
    v_mfma_f32_32x32x16_bf16 a[240:255], a[92:95], v[136:139], a[240:255]
    ds_read_b64_tr_b16 a[12:13], v15 offset:32768
    ds_read_b64_tr_b16 a[14:15], v15 offset:34816
    ds_read_b64_tr_b16 a[16:17], v12 offset:33024
    ds_read_b64_tr_b16 a[18:19], v12 offset:35072
    v_mfma_f32_32x32x16_bf16 a[128:143], a[96:99], v[140:143], a[128:143]
    ds_read_b64_tr_b16 a[20:21], v13 offset:33024
    ds_read_b64_tr_b16 a[22:23], v13 offset:35072
    v_mfma_f32_32x32x16_bf16 a[144:159], a[100:103], v[140:143], a[144:159]
    ds_read_b64_tr_b16 a[24:25], v14 offset:33024
    ds_read_b64_tr_b16 a[26:27], v14 offset:35072
    v_mfma_f32_32x32x16_bf16 a[160:175], a[104:107], v[140:143], a[160:175]
    ds_read_b64_tr_b16 a[28:29], v15 offset:33024
    ds_read_b64_tr_b16 a[30:31], v15 offset:35072
    ds_read_b64_tr_b16 a[32:33], v12 offset:40960
    ds_read_b64_tr_b16 a[34:35], v12 offset:43008
    v_mfma_f32_32x32x16_bf16 a[176:191], a[108:111], v[140:143], a[176:191]
    ds_read_b64_tr_b16 a[36:37], v13 offset:40960
    ds_read_b64_tr_b16 a[38:39], v13 offset:43008
    v_mfma_f32_32x32x16_bf16 a[192:207], a[112:115], v[140:143], a[192:207]
    ds_read_b64_tr_b16 a[40:41], v14 offset:40960
    ds_read_b64_tr_b16 a[42:43], v14 offset:43008
    v_mfma_f32_32x32x16_bf16 a[208:223], a[116:119], v[140:143], a[208:223]
    ds_read_b64_tr_b16 a[44:45], v15 offset:40960
    ds_read_b64_tr_b16 a[46:47], v15 offset:43008
    ds_read_b64_tr_b16 a[48:49], v12 offset:41216
    ds_read_b64_tr_b16 a[50:51], v12 offset:43264
    v_mfma_f32_32x32x16_bf16 a[224:239], a[120:123], v[140:143], a[224:239]
    ds_read_b64_tr_b16 a[52:53], v13 offset:41216
    ds_read_b64_tr_b16 a[54:55], v13 offset:43264
    v_mfma_f32_32x32x16_bf16 a[240:255], a[124:127], v[140:143], a[240:255]
    ds_read_b64_tr_b16 a[56:57], v14 offset:41216
    ds_read_b64_tr_b16 a[58:59], v14 offset:43264
    ds_read_b64_tr_b16 a[60:61], v15 offset:41216
    ds_read_b64_tr_b16 a[62:63], v15 offset:43264
    s_waitcnt vmcnt(26)
    s_barrier
    s_waitcnt vmcnt(16)
    s_waitcnt lgkmcnt(0)
    v_mfma_f32_32x32x16_bf16 a[128:143], a[0:3], v[144:147], a[128:143]
    s_add_u32 m0, s56, 81920
    s_lshl_b32 s53, s40, 16
    s_add_u32 s53, s53, 1835008
    buffer_load_dwordx4 v10, s[32:35], s53 offen lds
    v_mfma_f32_32x32x16_bf16 a[144:159], a[4:7], v[144:147], a[144:159]
    s_add_u32 m0, s56, 82944
    s_lshl_b32 s53, s40, 16
    s_add_u32 s53, s53, 1851392
    buffer_load_dwordx4 v11, s[32:35], s53 offen lds
    s_add_u32 m0, s56, 83968
    s_lshl_b32 s53, s40, 16
    s_add_u32 s53, s53, 1867776
    buffer_load_dwordx4 v10, s[32:35], s53 offen lds
    v_mfma_f32_32x32x16_bf16 a[160:175], a[8:11], v[144:147], a[160:175]
    s_add_u32 m0, s56, 84992
    s_lshl_b32 s53, s40, 16
    s_add_u32 s53, s53, 1884160
    buffer_load_dwordx4 v11, s[32:35], s53 offen lds
    v_mfma_f32_32x32x16_bf16 a[176:191], a[12:15], v[144:147], a[176:191]
    s_add_u32 m0, s56, 32768
    s_add_u32 s58, s57, 32768
    buffer_load_dwordx4 v28, s[24:27], s58 offen lds
    s_add_u32 m0, s56, 33792
    s_add_u32 s58, s57, 32768
    buffer_load_dwordx4 v29, s[24:27], s58 offen lds
    v_mfma_f32_32x32x16_bf16 a[192:207], a[16:19], v[144:147], a[192:207]
    s_add_u32 m0, s56, 34816
    s_add_u32 s58, s57, 32768
    buffer_load_dwordx4 v30, s[24:27], s58 offen lds
    s_add_u32 m0, s56, 35840
    s_add_u32 s58, s57, 32768
    buffer_load_dwordx4 v31, s[24:27], s58 offen lds
    v_mfma_f32_32x32x16_bf16 a[208:223], a[20:23], v[144:147], a[208:223]
    buffer_load_dwordx4 v[168:171], v8, s[20:23], 0 offen offset:320
    v_mfma_f32_32x32x16_bf16 a[224:239], a[24:27], v[144:147], a[224:239]
    buffer_load_dwordx4 v[172:175], v8, s[20:23], 0 offen offset:352
    ds_read_b64_tr_b16 a[64:65], v12 offset:49152
    ds_read_b64_tr_b16 a[66:67], v12 offset:51200
    v_mfma_f32_32x32x16_bf16 a[240:255], a[28:31], v[144:147], a[240:255]
    ds_read_b64_tr_b16 a[68:69], v13 offset:49152
    ds_read_b64_tr_b16 a[70:71], v13 offset:51200
    ds_read_b64_tr_b16 a[72:73], v14 offset:49152
    ds_read_b64_tr_b16 a[74:75], v14 offset:51200
    v_mfma_f32_32x32x16_bf16 a[128:143], a[32:35], v[148:151], a[128:143]
    ds_read_b64_tr_b16 a[76:77], v15 offset:49152
    ds_read_b64_tr_b16 a[78:79], v15 offset:51200
    v_mfma_f32_32x32x16_bf16 a[144:159], a[36:39], v[148:151], a[144:159]
    ds_read_b64_tr_b16 a[80:81], v12 offset:49408
    ds_read_b64_tr_b16 a[82:83], v12 offset:51456
    ds_read_b64_tr_b16 a[84:85], v13 offset:49408
    ds_read_b64_tr_b16 a[86:87], v13 offset:51456
    v_mfma_f32_32x32x16_bf16 a[160:175], a[40:43], v[148:151], a[160:175]
    ds_read_b64_tr_b16 a[88:89], v14 offset:49408
    ds_read_b64_tr_b16 a[90:91], v14 offset:51456
    v_mfma_f32_32x32x16_bf16 a[176:191], a[44:47], v[148:151], a[176:191]
    ds_read_b64_tr_b16 a[92:93], v15 offset:49408
    ds_read_b64_tr_b16 a[94:95], v15 offset:51456
    ds_read_b64_tr_b16 a[96:97], v12 offset:57344
    ds_read_b64_tr_b16 a[98:99], v12 offset:59392
    v_mfma_f32_32x32x16_bf16 a[192:207], a[48:51], v[148:151], a[192:207]
    ds_read_b64_tr_b16 a[100:101], v13 offset:57344
    ds_read_b64_tr_b16 a[102:103], v13 offset:59392
    ds_read_b64_tr_b16 a[104:105], v14 offset:57344
    ds_read_b64_tr_b16 a[106:107], v14 offset:59392
    v_mfma_f32_32x32x16_bf16 a[208:223], a[52:55], v[148:151], a[208:223]
    ds_read_b64_tr_b16 a[108:109], v15 offset:57344
    ds_read_b64_tr_b16 a[110:111], v15 offset:59392
    v_mfma_f32_32x32x16_bf16 a[224:239], a[56:59], v[148:151], a[224:239]
    ds_read_b64_tr_b16 a[112:113], v12 offset:57600
    ds_read_b64_tr_b16 a[114:115], v12 offset:59648
    ds_read_b64_tr_b16 a[116:117], v13 offset:57600
    ds_read_b64_tr_b16 a[118:119], v13 offset:59648
    v_mfma_f32_32x32x16_bf16 a[240:255], a[60:63], v[148:151], a[240:255]
    ds_read_b64_tr_b16 a[120:121], v14 offset:57600
    ds_read_b64_tr_b16 a[122:123], v14 offset:59648
    ds_read_b64_tr_b16 a[124:125], v15 offset:57600
    ds_read_b64_tr_b16 a[126:127], v15 offset:59648
    s_barrier
    s_waitcnt vmcnt(16)
    s_waitcnt lgkmcnt(0)
    v_mfma_f32_32x32x16_bf16 a[128:143], a[64:67], v[152:155], a[128:143]
    s_add_u32 m0, s56, 98304
    s_lshl_b32 s53, s40, 16
    s_add_u32 s53, s53, 2097152
    buffer_load_dwordx4 v10, s[32:35], s53 offen lds
    v_mfma_f32_32x32x16_bf16 a[144:159], a[68:71], v[152:155], a[144:159]
    s_add_u32 m0, s56, 99328
    s_lshl_b32 s53, s40, 16
    s_add_u32 s53, s53, 2113536
    buffer_load_dwordx4 v11, s[32:35], s53 offen lds
    v_mfma_f32_32x32x16_bf16 a[160:175], a[72:75], v[152:155], a[160:175]
    s_add_u32 m0, s56, 100352
    s_lshl_b32 s53, s40, 16
    s_add_u32 s53, s53, 2129920
    buffer_load_dwordx4 v10, s[32:35], s53 offen lds
    s_add_u32 m0, s56, 101376
    s_lshl_b32 s53, s40, 16
    s_add_u32 s53, s53, 2146304
    buffer_load_dwordx4 v11, s[32:35], s53 offen lds
    v_mfma_f32_32x32x16_bf16 a[176:191], a[76:79], v[152:155], a[176:191]
    buffer_load_dwordx4 v[176:179], v8, s[20:23], 0 offen offset:384
    v_mfma_f32_32x32x16_bf16 a[192:207], a[80:83], v[152:155], a[192:207]
    buffer_load_dwordx4 v[180:183], v8, s[20:23], 0 offen offset:416
    v_mfma_f32_32x32x16_bf16 a[208:223], a[84:87], v[152:155], a[208:223]
    ds_read_b64_tr_b16 a[0:1], v20 offset:0
    ds_read_b64_tr_b16 a[2:3], v20 offset:2048
    ds_read_b64_tr_b16 a[4:5], v21 offset:0
    ds_read_b64_tr_b16 a[6:7], v21 offset:2048
    v_mfma_f32_32x32x16_bf16 a[224:239], a[88:91], v[152:155], a[224:239]
    ds_read_b64_tr_b16 a[8:9], v22 offset:0
    ds_read_b64_tr_b16 a[10:11], v22 offset:2048
    v_mfma_f32_32x32x16_bf16 a[240:255], a[92:95], v[152:155], a[240:255]
    ds_read_b64_tr_b16 a[12:13], v23 offset:0
    ds_read_b64_tr_b16 a[14:15], v23 offset:2048
    ds_read_b64_tr_b16 a[16:17], v20 offset:256
    ds_read_b64_tr_b16 a[18:19], v20 offset:2304
    v_mfma_f32_32x32x16_bf16 a[128:143], a[96:99], v[156:159], a[128:143]
    ds_read_b64_tr_b16 a[20:21], v21 offset:256
    ds_read_b64_tr_b16 a[22:23], v21 offset:2304
    v_mfma_f32_32x32x16_bf16 a[144:159], a[100:103], v[156:159], a[144:159]
    ds_read_b64_tr_b16 a[24:25], v22 offset:256
    ds_read_b64_tr_b16 a[26:27], v22 offset:2304
    v_mfma_f32_32x32x16_bf16 a[160:175], a[104:107], v[156:159], a[160:175]
    ds_read_b64_tr_b16 a[28:29], v23 offset:256
    ds_read_b64_tr_b16 a[30:31], v23 offset:2304
    ds_read_b64_tr_b16 a[32:33], v20 offset:8192
    ds_read_b64_tr_b16 a[34:35], v20 offset:10240
    v_mfma_f32_32x32x16_bf16 a[176:191], a[108:111], v[156:159], a[176:191]
    ds_read_b64_tr_b16 a[36:37], v21 offset:8192
    ds_read_b64_tr_b16 a[38:39], v21 offset:10240
    v_mfma_f32_32x32x16_bf16 a[192:207], a[112:115], v[156:159], a[192:207]
    ds_read_b64_tr_b16 a[40:41], v22 offset:8192
    ds_read_b64_tr_b16 a[42:43], v22 offset:10240
    v_mfma_f32_32x32x16_bf16 a[208:223], a[116:119], v[156:159], a[208:223]
    ds_read_b64_tr_b16 a[44:45], v23 offset:8192
    ds_read_b64_tr_b16 a[46:47], v23 offset:10240
    ds_read_b64_tr_b16 a[48:49], v20 offset:8448
    ds_read_b64_tr_b16 a[50:51], v20 offset:10496
    v_mfma_f32_32x32x16_bf16 a[224:239], a[120:123], v[156:159], a[224:239]
    ds_read_b64_tr_b16 a[52:53], v21 offset:8448
    ds_read_b64_tr_b16 a[54:55], v21 offset:10496
    v_mfma_f32_32x32x16_bf16 a[240:255], a[124:127], v[156:159], a[240:255]
    ds_read_b64_tr_b16 a[56:57], v22 offset:8448
    ds_read_b64_tr_b16 a[58:59], v22 offset:10496
    ds_read_b64_tr_b16 a[60:61], v23 offset:8448
    ds_read_b64_tr_b16 a[62:63], v23 offset:10496
    s_barrier
    s_waitcnt vmcnt(16)
    s_waitcnt lgkmcnt(0)
    v_mfma_f32_32x32x16_bf16 a[128:143], a[0:3], v[160:163], a[128:143]
    s_add_u32 m0, s56, 114688
    s_lshl_b32 s53, s40, 16
    s_add_u32 s53, s53, 2359296
    buffer_load_dwordx4 v10, s[32:35], s53 offen lds
    v_mfma_f32_32x32x16_bf16 a[144:159], a[4:7], v[160:163], a[144:159]
    s_add_u32 m0, s56, 115712
    s_lshl_b32 s53, s40, 16
    s_add_u32 s53, s53, 2375680
    buffer_load_dwordx4 v11, s[32:35], s53 offen lds
    s_add_u32 m0, s56, 116736
    s_lshl_b32 s53, s40, 16
    s_add_u32 s53, s53, 2392064
    buffer_load_dwordx4 v10, s[32:35], s53 offen lds
    v_mfma_f32_32x32x16_bf16 a[160:175], a[8:11], v[160:163], a[160:175]
    s_add_u32 m0, s56, 117760
    s_lshl_b32 s53, s40, 16
    s_add_u32 s53, s53, 2408448
    buffer_load_dwordx4 v11, s[32:35], s53 offen lds
    v_mfma_f32_32x32x16_bf16 a[176:191], a[12:15], v[160:163], a[176:191]
    s_add_u32 m0, s56, 49152
    s_add_u32 s58, s57, 49152
    buffer_load_dwordx4 v28, s[24:27], s58 offen lds
    s_add_u32 m0, s56, 50176
    s_add_u32 s58, s57, 49152
    buffer_load_dwordx4 v29, s[24:27], s58 offen lds
    v_mfma_f32_32x32x16_bf16 a[192:207], a[16:19], v[160:163], a[192:207]
    s_add_u32 m0, s56, 51200
    s_add_u32 s58, s57, 49152
    buffer_load_dwordx4 v30, s[24:27], s58 offen lds
    s_add_u32 m0, s56, 52224
    s_add_u32 s58, s57, 49152
    buffer_load_dwordx4 v31, s[24:27], s58 offen lds
    v_mfma_f32_32x32x16_bf16 a[208:223], a[20:23], v[160:163], a[208:223]
    buffer_load_dwordx4 v[184:187], v8, s[20:23], 0 offen offset:448
    v_mfma_f32_32x32x16_bf16 a[224:239], a[24:27], v[160:163], a[224:239]
    buffer_load_dwordx4 v[188:191], v8, s[20:23], 0 offen offset:480
    ds_read_b64_tr_b16 a[64:65], v20 offset:16384
    ds_read_b64_tr_b16 a[66:67], v20 offset:18432
    v_mfma_f32_32x32x16_bf16 a[240:255], a[28:31], v[160:163], a[240:255]
    ds_read_b64_tr_b16 a[68:69], v21 offset:16384
    ds_read_b64_tr_b16 a[70:71], v21 offset:18432
    ds_read_b64_tr_b16 a[72:73], v22 offset:16384
    ds_read_b64_tr_b16 a[74:75], v22 offset:18432
    v_mfma_f32_32x32x16_bf16 a[128:143], a[32:35], v[164:167], a[128:143]
    ds_read_b64_tr_b16 a[76:77], v23 offset:16384
    ds_read_b64_tr_b16 a[78:79], v23 offset:18432
    v_mfma_f32_32x32x16_bf16 a[144:159], a[36:39], v[164:167], a[144:159]
    ds_read_b64_tr_b16 a[80:81], v20 offset:16640
    ds_read_b64_tr_b16 a[82:83], v20 offset:18688
    ds_read_b64_tr_b16 a[84:85], v21 offset:16640
    ds_read_b64_tr_b16 a[86:87], v21 offset:18688
    v_mfma_f32_32x32x16_bf16 a[160:175], a[40:43], v[164:167], a[160:175]
    ds_read_b64_tr_b16 a[88:89], v22 offset:16640
    ds_read_b64_tr_b16 a[90:91], v22 offset:18688
    v_mfma_f32_32x32x16_bf16 a[176:191], a[44:47], v[164:167], a[176:191]
    ds_read_b64_tr_b16 a[92:93], v23 offset:16640
    ds_read_b64_tr_b16 a[94:95], v23 offset:18688
    ds_read_b64_tr_b16 a[96:97], v20 offset:24576
    ds_read_b64_tr_b16 a[98:99], v20 offset:26624
    v_mfma_f32_32x32x16_bf16 a[192:207], a[48:51], v[164:167], a[192:207]
    ds_read_b64_tr_b16 a[100:101], v21 offset:24576
    ds_read_b64_tr_b16 a[102:103], v21 offset:26624
    ds_read_b64_tr_b16 a[104:105], v22 offset:24576
    ds_read_b64_tr_b16 a[106:107], v22 offset:26624
    v_mfma_f32_32x32x16_bf16 a[208:223], a[52:55], v[164:167], a[208:223]
    ds_read_b64_tr_b16 a[108:109], v23 offset:24576
    ds_read_b64_tr_b16 a[110:111], v23 offset:26624
    v_mfma_f32_32x32x16_bf16 a[224:239], a[56:59], v[164:167], a[224:239]
    ds_read_b64_tr_b16 a[112:113], v20 offset:24832
    ds_read_b64_tr_b16 a[114:115], v20 offset:26880
    ds_read_b64_tr_b16 a[116:117], v21 offset:24832
    ds_read_b64_tr_b16 a[118:119], v21 offset:26880
    v_mfma_f32_32x32x16_bf16 a[240:255], a[60:63], v[164:167], a[240:255]
    ds_read_b64_tr_b16 a[120:121], v22 offset:24832
    ds_read_b64_tr_b16 a[122:123], v22 offset:26880
    ds_read_b64_tr_b16 a[124:125], v23 offset:24832
    ds_read_b64_tr_b16 a[126:127], v23 offset:26880
    s_barrier
    s_waitcnt vmcnt(16)
    s_waitcnt lgkmcnt(0)
    v_mfma_f32_32x32x16_bf16 a[128:143], a[64:67], v[168:171], a[128:143]
    s_add_u32 m0, s56, 131072
    s_lshl_b32 s53, s40, 16
    s_add_u32 s53, s53, 2621440
    buffer_load_dwordx4 v10, s[32:35], s53 offen lds
    v_mfma_f32_32x32x16_bf16 a[144:159], a[68:71], v[168:171], a[144:159]
    s_add_u32 m0, s56, 132096
    s_lshl_b32 s53, s40, 16
    s_add_u32 s53, s53, 2637824
    buffer_load_dwordx4 v11, s[32:35], s53 offen lds
    v_mfma_f32_32x32x16_bf16 a[160:175], a[72:75], v[168:171], a[160:175]
    s_add_u32 m0, s56, 133120
    s_lshl_b32 s53, s40, 16
    s_add_u32 s53, s53, 2654208
    buffer_load_dwordx4 v10, s[32:35], s53 offen lds
    s_add_u32 m0, s56, 134144
    s_lshl_b32 s53, s40, 16
    s_add_u32 s53, s53, 2670592
    buffer_load_dwordx4 v11, s[32:35], s53 offen lds
    v_mfma_f32_32x32x16_bf16 a[176:191], a[76:79], v[168:171], a[176:191]
    buffer_load_dwordx4 v[192:195], v8, s[20:23], 0 offen offset:512
    v_mfma_f32_32x32x16_bf16 a[192:207], a[80:83], v[168:171], a[192:207]
    buffer_load_dwordx4 v[196:199], v8, s[20:23], 0 offen offset:544
    v_mfma_f32_32x32x16_bf16 a[208:223], a[84:87], v[168:171], a[208:223]
    ds_read_b64_tr_b16 a[0:1], v12 offset:0
    ds_read_b64_tr_b16 a[2:3], v12 offset:2048
    ds_read_b64_tr_b16 a[4:5], v13 offset:0
    ds_read_b64_tr_b16 a[6:7], v13 offset:2048
    v_mfma_f32_32x32x16_bf16 a[224:239], a[88:91], v[168:171], a[224:239]
    ds_read_b64_tr_b16 a[8:9], v14 offset:0
    ds_read_b64_tr_b16 a[10:11], v14 offset:2048
    v_mfma_f32_32x32x16_bf16 a[240:255], a[92:95], v[168:171], a[240:255]
    ds_read_b64_tr_b16 a[12:13], v15 offset:0
    ds_read_b64_tr_b16 a[14:15], v15 offset:2048
    ds_read_b64_tr_b16 a[16:17], v12 offset:256
    ds_read_b64_tr_b16 a[18:19], v12 offset:2304
    v_mfma_f32_32x32x16_bf16 a[128:143], a[96:99], v[172:175], a[128:143]
    ds_read_b64_tr_b16 a[20:21], v13 offset:256
    ds_read_b64_tr_b16 a[22:23], v13 offset:2304
    v_mfma_f32_32x32x16_bf16 a[144:159], a[100:103], v[172:175], a[144:159]
    ds_read_b64_tr_b16 a[24:25], v14 offset:256
    ds_read_b64_tr_b16 a[26:27], v14 offset:2304
    v_mfma_f32_32x32x16_bf16 a[160:175], a[104:107], v[172:175], a[160:175]
    ds_read_b64_tr_b16 a[28:29], v15 offset:256
    ds_read_b64_tr_b16 a[30:31], v15 offset:2304
    ds_read_b64_tr_b16 a[32:33], v12 offset:8192
    ds_read_b64_tr_b16 a[34:35], v12 offset:10240
    v_mfma_f32_32x32x16_bf16 a[176:191], a[108:111], v[172:175], a[176:191]
    ds_read_b64_tr_b16 a[36:37], v13 offset:8192
    ds_read_b64_tr_b16 a[38:39], v13 offset:10240
    v_mfma_f32_32x32x16_bf16 a[192:207], a[112:115], v[172:175], a[192:207]
    ds_read_b64_tr_b16 a[40:41], v14 offset:8192
    ds_read_b64_tr_b16 a[42:43], v14 offset:10240
    v_mfma_f32_32x32x16_bf16 a[208:223], a[116:119], v[172:175], a[208:223]
    ds_read_b64_tr_b16 a[44:45], v15 offset:8192
    ds_read_b64_tr_b16 a[46:47], v15 offset:10240
    ds_read_b64_tr_b16 a[48:49], v12 offset:8448
    ds_read_b64_tr_b16 a[50:51], v12 offset:10496
    v_mfma_f32_32x32x16_bf16 a[224:239], a[120:123], v[172:175], a[224:239]
    ds_read_b64_tr_b16 a[52:53], v13 offset:8448
    ds_read_b64_tr_b16 a[54:55], v13 offset:10496
    v_mfma_f32_32x32x16_bf16 a[240:255], a[124:127], v[172:175], a[240:255]
    ds_read_b64_tr_b16 a[56:57], v14 offset:8448
    ds_read_b64_tr_b16 a[58:59], v14 offset:10496
    ds_read_b64_tr_b16 a[60:61], v15 offset:8448
    ds_read_b64_tr_b16 a[62:63], v15 offset:10496
    s_barrier
    s_waitcnt vmcnt(16)
    s_waitcnt lgkmcnt(0)
    v_mfma_f32_32x32x16_bf16 a[128:143], a[0:3], v[176:179], a[128:143]
    s_add_u32 m0, s56, 147456
    s_lshl_b32 s53, s40, 16
    s_add_u32 s53, s53, 2883584
    buffer_load_dwordx4 v10, s[32:35], s53 offen lds
    v_mfma_f32_32x32x16_bf16 a[144:159], a[4:7], v[176:179], a[144:159]
    s_add_u32 m0, s56, 148480
    s_lshl_b32 s53, s40, 16
    s_add_u32 s53, s53, 2899968
    buffer_load_dwordx4 v11, s[32:35], s53 offen lds
    v_mfma_f32_32x32x16_bf16 a[160:175], a[8:11], v[176:179], a[160:175]
    s_add_u32 m0, s56, 149504
    s_lshl_b32 s53, s40, 16
    s_add_u32 s53, s53, 2916352
    buffer_load_dwordx4 v10, s[32:35], s53 offen lds
    s_add_u32 m0, s56, 150528
    s_lshl_b32 s53, s40, 16
    s_add_u32 s53, s53, 2932736
    buffer_load_dwordx4 v11, s[32:35], s53 offen lds
    v_mfma_f32_32x32x16_bf16 a[176:191], a[12:15], v[176:179], a[176:191]
    buffer_load_dwordx4 v[200:203], v8, s[20:23], 0 offen offset:576
    v_mfma_f32_32x32x16_bf16 a[192:207], a[16:19], v[176:179], a[192:207]
    buffer_load_dwordx4 v[204:207], v8, s[20:23], 0 offen offset:608
    v_mfma_f32_32x32x16_bf16 a[208:223], a[20:23], v[176:179], a[208:223]
    ds_read_b64_tr_b16 a[64:65], v12 offset:16384
    ds_read_b64_tr_b16 a[66:67], v12 offset:18432
    ds_read_b64_tr_b16 a[68:69], v13 offset:16384
    ds_read_b64_tr_b16 a[70:71], v13 offset:18432
    v_mfma_f32_32x32x16_bf16 a[224:239], a[24:27], v[176:179], a[224:239]
    ds_read_b64_tr_b16 a[72:73], v14 offset:16384
    ds_read_b64_tr_b16 a[74:75], v14 offset:18432
    v_mfma_f32_32x32x16_bf16 a[240:255], a[28:31], v[176:179], a[240:255]
    ds_read_b64_tr_b16 a[76:77], v15 offset:16384
    ds_read_b64_tr_b16 a[78:79], v15 offset:18432
    ds_read_b64_tr_b16 a[80:81], v12 offset:16640
    ds_read_b64_tr_b16 a[82:83], v12 offset:18688
    v_mfma_f32_32x32x16_bf16 a[128:143], a[32:35], v[180:183], a[128:143]
    ds_read_b64_tr_b16 a[84:85], v13 offset:16640
    ds_read_b64_tr_b16 a[86:87], v13 offset:18688
    v_mfma_f32_32x32x16_bf16 a[144:159], a[36:39], v[180:183], a[144:159]
    ds_read_b64_tr_b16 a[88:89], v14 offset:16640
    ds_read_b64_tr_b16 a[90:91], v14 offset:18688
    v_mfma_f32_32x32x16_bf16 a[160:175], a[40:43], v[180:183], a[160:175]
    ds_read_b64_tr_b16 a[92:93], v15 offset:16640
    ds_read_b64_tr_b16 a[94:95], v15 offset:18688
    ds_read_b64_tr_b16 a[96:97], v12 offset:24576
    ds_read_b64_tr_b16 a[98:99], v12 offset:26624
    v_mfma_f32_32x32x16_bf16 a[176:191], a[44:47], v[180:183], a[176:191]
    ds_read_b64_tr_b16 a[100:101], v13 offset:24576
    ds_read_b64_tr_b16 a[102:103], v13 offset:26624
    v_mfma_f32_32x32x16_bf16 a[192:207], a[48:51], v[180:183], a[192:207]
    ds_read_b64_tr_b16 a[104:105], v14 offset:24576
    ds_read_b64_tr_b16 a[106:107], v14 offset:26624
    v_mfma_f32_32x32x16_bf16 a[208:223], a[52:55], v[180:183], a[208:223]
    ds_read_b64_tr_b16 a[108:109], v15 offset:24576
    ds_read_b64_tr_b16 a[110:111], v15 offset:26624
    ds_read_b64_tr_b16 a[112:113], v12 offset:24832
    ds_read_b64_tr_b16 a[114:115], v12 offset:26880
    v_mfma_f32_32x32x16_bf16 a[224:239], a[56:59], v[180:183], a[224:239]
    ds_read_b64_tr_b16 a[116:117], v13 offset:24832
    ds_read_b64_tr_b16 a[118:119], v13 offset:26880
    v_mfma_f32_32x32x16_bf16 a[240:255], a[60:63], v[180:183], a[240:255]
    ds_read_b64_tr_b16 a[120:121], v14 offset:24832
    ds_read_b64_tr_b16 a[122:123], v14 offset:26880
    ds_read_b64_tr_b16 a[124:125], v15 offset:24832
    ds_read_b64_tr_b16 a[126:127], v15 offset:26880
    s_barrier
    s_waitcnt vmcnt(12)
    s_waitcnt lgkmcnt(0)
    v_mfma_f32_32x32x16_bf16 a[128:143], a[64:67], v[184:187], a[128:143]
    s_add_u32 m0, s56, 65536
    s_lshl_b32 s53, s40, 16
    s_add_u32 s53, s53, 3145728
    buffer_load_dwordx4 v10, s[32:35], s53 offen lds
    v_mfma_f32_32x32x16_bf16 a[144:159], a[68:71], v[184:187], a[144:159]
    s_add_u32 m0, s56, 66560
    s_lshl_b32 s53, s40, 16
    s_add_u32 s53, s53, 3162112
    buffer_load_dwordx4 v11, s[32:35], s53 offen lds
    v_mfma_f32_32x32x16_bf16 a[160:175], a[72:75], v[184:187], a[160:175]
    s_add_u32 m0, s56, 67584
    s_lshl_b32 s53, s40, 16
    s_add_u32 s53, s53, 3178496
    buffer_load_dwordx4 v10, s[32:35], s53 offen lds
    s_add_u32 m0, s56, 68608
    s_lshl_b32 s53, s40, 16
    s_add_u32 s53, s53, 3194880
    buffer_load_dwordx4 v11, s[32:35], s53 offen lds
    v_mfma_f32_32x32x16_bf16 a[176:191], a[76:79], v[184:187], a[176:191]
    buffer_load_dwordx4 v[208:211], v8, s[20:23], 0 offen offset:640
    v_mfma_f32_32x32x16_bf16 a[192:207], a[80:83], v[184:187], a[192:207]
    buffer_load_dwordx4 v[212:215], v8, s[20:23], 0 offen offset:672
    v_mfma_f32_32x32x16_bf16 a[208:223], a[84:87], v[184:187], a[208:223]
    ds_read_b64_tr_b16 a[0:1], v12 offset:32768
    ds_read_b64_tr_b16 a[2:3], v12 offset:34816
    ds_read_b64_tr_b16 a[4:5], v13 offset:32768
    ds_read_b64_tr_b16 a[6:7], v13 offset:34816
    v_mfma_f32_32x32x16_bf16 a[224:239], a[88:91], v[184:187], a[224:239]
    ds_read_b64_tr_b16 a[8:9], v14 offset:32768
    ds_read_b64_tr_b16 a[10:11], v14 offset:34816
    v_mfma_f32_32x32x16_bf16 a[240:255], a[92:95], v[184:187], a[240:255]
    ds_read_b64_tr_b16 a[12:13], v15 offset:32768
    ds_read_b64_tr_b16 a[14:15], v15 offset:34816
    ds_read_b64_tr_b16 a[16:17], v12 offset:33024
    ds_read_b64_tr_b16 a[18:19], v12 offset:35072
    v_mfma_f32_32x32x16_bf16 a[128:143], a[96:99], v[188:191], a[128:143]
    ds_read_b64_tr_b16 a[20:21], v13 offset:33024
    ds_read_b64_tr_b16 a[22:23], v13 offset:35072
    v_mfma_f32_32x32x16_bf16 a[144:159], a[100:103], v[188:191], a[144:159]
    ds_read_b64_tr_b16 a[24:25], v14 offset:33024
    ds_read_b64_tr_b16 a[26:27], v14 offset:35072
    v_mfma_f32_32x32x16_bf16 a[160:175], a[104:107], v[188:191], a[160:175]
    ds_read_b64_tr_b16 a[28:29], v15 offset:33024
    ds_read_b64_tr_b16 a[30:31], v15 offset:35072
    ds_read_b64_tr_b16 a[32:33], v12 offset:40960
    ds_read_b64_tr_b16 a[34:35], v12 offset:43008
    v_mfma_f32_32x32x16_bf16 a[176:191], a[108:111], v[188:191], a[176:191]
    ds_read_b64_tr_b16 a[36:37], v13 offset:40960
    ds_read_b64_tr_b16 a[38:39], v13 offset:43008
    v_mfma_f32_32x32x16_bf16 a[192:207], a[112:115], v[188:191], a[192:207]
    ds_read_b64_tr_b16 a[40:41], v14 offset:40960
    ds_read_b64_tr_b16 a[42:43], v14 offset:43008
    v_mfma_f32_32x32x16_bf16 a[208:223], a[116:119], v[188:191], a[208:223]
    ds_read_b64_tr_b16 a[44:45], v15 offset:40960
    ds_read_b64_tr_b16 a[46:47], v15 offset:43008
    ds_read_b64_tr_b16 a[48:49], v12 offset:41216
    ds_read_b64_tr_b16 a[50:51], v12 offset:43264
    v_mfma_f32_32x32x16_bf16 a[224:239], a[120:123], v[188:191], a[224:239]
    ds_read_b64_tr_b16 a[52:53], v13 offset:41216
    ds_read_b64_tr_b16 a[54:55], v13 offset:43264
    v_mfma_f32_32x32x16_bf16 a[240:255], a[124:127], v[188:191], a[240:255]
    ds_read_b64_tr_b16 a[56:57], v14 offset:41216
    ds_read_b64_tr_b16 a[58:59], v14 offset:43264
    ds_read_b64_tr_b16 a[60:61], v15 offset:41216
    ds_read_b64_tr_b16 a[62:63], v15 offset:43264
    s_barrier
    s_waitcnt vmcnt(12)
    s_waitcnt lgkmcnt(0)
    v_mfma_f32_32x32x16_bf16 a[128:143], a[0:3], v[192:195], a[128:143]
    s_add_u32 m0, s56, 81920
    s_lshl_b32 s53, s40, 16
    s_add_u32 s53, s53, 3407872
    buffer_load_dwordx4 v10, s[32:35], s53 offen lds
    v_mfma_f32_32x32x16_bf16 a[144:159], a[4:7], v[192:195], a[144:159]
    s_add_u32 m0, s56, 82944
    s_lshl_b32 s53, s40, 16
    s_add_u32 s53, s53, 3424256
    buffer_load_dwordx4 v11, s[32:35], s53 offen lds
    v_mfma_f32_32x32x16_bf16 a[160:175], a[8:11], v[192:195], a[160:175]
    s_add_u32 m0, s56, 83968
    s_lshl_b32 s53, s40, 16
    s_add_u32 s53, s53, 3440640
    buffer_load_dwordx4 v10, s[32:35], s53 offen lds
    s_add_u32 m0, s56, 84992
    s_lshl_b32 s53, s40, 16
    s_add_u32 s53, s53, 3457024
    buffer_load_dwordx4 v11, s[32:35], s53 offen lds
    v_mfma_f32_32x32x16_bf16 a[176:191], a[12:15], v[192:195], a[176:191]
    buffer_load_dwordx4 v[216:219], v8, s[20:23], 0 offen offset:704
    v_mfma_f32_32x32x16_bf16 a[192:207], a[16:19], v[192:195], a[192:207]
    buffer_load_dwordx4 v[220:223], v8, s[20:23], 0 offen offset:736
    v_mfma_f32_32x32x16_bf16 a[208:223], a[20:23], v[192:195], a[208:223]
    ds_read_b64_tr_b16 a[64:65], v12 offset:49152
    ds_read_b64_tr_b16 a[66:67], v12 offset:51200
    ds_read_b64_tr_b16 a[68:69], v13 offset:49152
    ds_read_b64_tr_b16 a[70:71], v13 offset:51200
    v_mfma_f32_32x32x16_bf16 a[224:239], a[24:27], v[192:195], a[224:239]
    ds_read_b64_tr_b16 a[72:73], v14 offset:49152
    ds_read_b64_tr_b16 a[74:75], v14 offset:51200
    v_mfma_f32_32x32x16_bf16 a[240:255], a[28:31], v[192:195], a[240:255]
    ds_read_b64_tr_b16 a[76:77], v15 offset:49152
    ds_read_b64_tr_b16 a[78:79], v15 offset:51200
    ds_read_b64_tr_b16 a[80:81], v12 offset:49408
    ds_read_b64_tr_b16 a[82:83], v12 offset:51456
    v_mfma_f32_32x32x16_bf16 a[128:143], a[32:35], v[196:199], a[128:143]
    ds_read_b64_tr_b16 a[84:85], v13 offset:49408
    ds_read_b64_tr_b16 a[86:87], v13 offset:51456
    v_mfma_f32_32x32x16_bf16 a[144:159], a[36:39], v[196:199], a[144:159]
    ds_read_b64_tr_b16 a[88:89], v14 offset:49408
    ds_read_b64_tr_b16 a[90:91], v14 offset:51456
    v_mfma_f32_32x32x16_bf16 a[160:175], a[40:43], v[196:199], a[160:175]
    ds_read_b64_tr_b16 a[92:93], v15 offset:49408
    ds_read_b64_tr_b16 a[94:95], v15 offset:51456
    ds_read_b64_tr_b16 a[96:97], v12 offset:57344
    ds_read_b64_tr_b16 a[98:99], v12 offset:59392
    v_mfma_f32_32x32x16_bf16 a[176:191], a[44:47], v[196:199], a[176:191]
    ds_read_b64_tr_b16 a[100:101], v13 offset:57344
    ds_read_b64_tr_b16 a[102:103], v13 offset:59392
    v_mfma_f32_32x32x16_bf16 a[192:207], a[48:51], v[196:199], a[192:207]
    ds_read_b64_tr_b16 a[104:105], v14 offset:57344
    ds_read_b64_tr_b16 a[106:107], v14 offset:59392
    v_mfma_f32_32x32x16_bf16 a[208:223], a[52:55], v[196:199], a[208:223]
    ds_read_b64_tr_b16 a[108:109], v15 offset:57344
    ds_read_b64_tr_b16 a[110:111], v15 offset:59392
    ds_read_b64_tr_b16 a[112:113], v12 offset:57600
    ds_read_b64_tr_b16 a[114:115], v12 offset:59648
    v_mfma_f32_32x32x16_bf16 a[224:239], a[56:59], v[196:199], a[224:239]
    ds_read_b64_tr_b16 a[116:117], v13 offset:57600
    ds_read_b64_tr_b16 a[118:119], v13 offset:59648
    v_mfma_f32_32x32x16_bf16 a[240:255], a[60:63], v[196:199], a[240:255]
    ds_read_b64_tr_b16 a[120:121], v14 offset:57600
    ds_read_b64_tr_b16 a[122:123], v14 offset:59648
    ds_read_b64_tr_b16 a[124:125], v15 offset:57600
    ds_read_b64_tr_b16 a[126:127], v15 offset:59648
    s_barrier
    s_waitcnt vmcnt(12)
    s_waitcnt lgkmcnt(0)
    v_mfma_f32_32x32x16_bf16 a[128:143], a[64:67], v[200:203], a[128:143]
    buffer_load_dwordx4 v[224:227], v8, s[20:23], 0 offen offset:768
    v_mfma_f32_32x32x16_bf16 a[144:159], a[68:71], v[200:203], a[144:159]
    buffer_load_dwordx4 v[228:231], v8, s[20:23], 0 offen offset:800
    v_mfma_f32_32x32x16_bf16 a[160:175], a[72:75], v[200:203], a[160:175]
    ds_read_b64_tr_b16 a[0:1], v20 offset:0
    ds_read_b64_tr_b16 a[2:3], v20 offset:2048
    v_mfma_f32_32x32x16_bf16 a[176:191], a[76:79], v[200:203], a[176:191]
    ds_read_b64_tr_b16 a[4:5], v21 offset:0
    ds_read_b64_tr_b16 a[6:7], v21 offset:2048
    v_mfma_f32_32x32x16_bf16 a[192:207], a[80:83], v[200:203], a[192:207]
    ds_read_b64_tr_b16 a[8:9], v22 offset:0
    ds_read_b64_tr_b16 a[10:11], v22 offset:2048
    v_mfma_f32_32x32x16_bf16 a[208:223], a[84:87], v[200:203], a[208:223]
    ds_read_b64_tr_b16 a[12:13], v23 offset:0
    ds_read_b64_tr_b16 a[14:15], v23 offset:2048
    v_mfma_f32_32x32x16_bf16 a[224:239], a[88:91], v[200:203], a[224:239]
    ds_read_b64_tr_b16 a[16:17], v20 offset:256
    ds_read_b64_tr_b16 a[18:19], v20 offset:2304
    v_mfma_f32_32x32x16_bf16 a[240:255], a[92:95], v[200:203], a[240:255]
    ds_read_b64_tr_b16 a[20:21], v21 offset:256
    ds_read_b64_tr_b16 a[22:23], v21 offset:2304
    ds_read_b64_tr_b16 a[24:25], v22 offset:256
    ds_read_b64_tr_b16 a[26:27], v22 offset:2304
    v_mfma_f32_32x32x16_bf16 a[128:143], a[96:99], v[204:207], a[128:143]
    ds_read_b64_tr_b16 a[28:29], v23 offset:256
    ds_read_b64_tr_b16 a[30:31], v23 offset:2304
    v_mfma_f32_32x32x16_bf16 a[144:159], a[100:103], v[204:207], a[144:159]
    ds_read_b64_tr_b16 a[32:33], v20 offset:8192
    ds_read_b64_tr_b16 a[34:35], v20 offset:10240
    v_mfma_f32_32x32x16_bf16 a[160:175], a[104:107], v[204:207], a[160:175]
    ds_read_b64_tr_b16 a[36:37], v21 offset:8192
    ds_read_b64_tr_b16 a[38:39], v21 offset:10240
    v_mfma_f32_32x32x16_bf16 a[176:191], a[108:111], v[204:207], a[176:191]
    ds_read_b64_tr_b16 a[40:41], v22 offset:8192
    ds_read_b64_tr_b16 a[42:43], v22 offset:10240
    v_mfma_f32_32x32x16_bf16 a[192:207], a[112:115], v[204:207], a[192:207]
    ds_read_b64_tr_b16 a[44:45], v23 offset:8192
    ds_read_b64_tr_b16 a[46:47], v23 offset:10240
    v_mfma_f32_32x32x16_bf16 a[208:223], a[116:119], v[204:207], a[208:223]
    ds_read_b64_tr_b16 a[48:49], v20 offset:8448
    ds_read_b64_tr_b16 a[50:51], v20 offset:10496
    v_mfma_f32_32x32x16_bf16 a[224:239], a[120:123], v[204:207], a[224:239]
    ds_read_b64_tr_b16 a[52:53], v21 offset:8448
    ds_read_b64_tr_b16 a[54:55], v21 offset:10496
    v_mfma_f32_32x32x16_bf16 a[240:255], a[124:127], v[204:207], a[240:255]
    ds_read_b64_tr_b16 a[56:57], v22 offset:8448
    ds_read_b64_tr_b16 a[58:59], v22 offset:10496
    ds_read_b64_tr_b16 a[60:61], v23 offset:8448
    ds_read_b64_tr_b16 a[62:63], v23 offset:10496
    s_barrier
    s_waitcnt vmcnt(8)
    s_waitcnt lgkmcnt(0)
    v_mfma_f32_32x32x16_bf16 a[128:143], a[0:3], v[208:211], a[128:143]
    buffer_load_dwordx4 v[232:235], v8, s[20:23], 0 offen offset:832
    v_mfma_f32_32x32x16_bf16 a[144:159], a[4:7], v[208:211], a[144:159]
    buffer_load_dwordx4 v[236:239], v8, s[20:23], 0 offen offset:864
    v_mfma_f32_32x32x16_bf16 a[160:175], a[8:11], v[208:211], a[160:175]
    ds_read_b64_tr_b16 a[64:65], v20 offset:16384
    ds_read_b64_tr_b16 a[66:67], v20 offset:18432
    v_mfma_f32_32x32x16_bf16 a[176:191], a[12:15], v[208:211], a[176:191]
    ds_read_b64_tr_b16 a[68:69], v21 offset:16384
    ds_read_b64_tr_b16 a[70:71], v21 offset:18432
    v_mfma_f32_32x32x16_bf16 a[192:207], a[16:19], v[208:211], a[192:207]
    ds_read_b64_tr_b16 a[72:73], v22 offset:16384
    ds_read_b64_tr_b16 a[74:75], v22 offset:18432
    v_mfma_f32_32x32x16_bf16 a[208:223], a[20:23], v[208:211], a[208:223]
    ds_read_b64_tr_b16 a[76:77], v23 offset:16384
    ds_read_b64_tr_b16 a[78:79], v23 offset:18432
    v_mfma_f32_32x32x16_bf16 a[224:239], a[24:27], v[208:211], a[224:239]
    ds_read_b64_tr_b16 a[80:81], v20 offset:16640
    ds_read_b64_tr_b16 a[82:83], v20 offset:18688
    v_mfma_f32_32x32x16_bf16 a[240:255], a[28:31], v[208:211], a[240:255]
    ds_read_b64_tr_b16 a[84:85], v21 offset:16640
    ds_read_b64_tr_b16 a[86:87], v21 offset:18688
    ds_read_b64_tr_b16 a[88:89], v22 offset:16640
    ds_read_b64_tr_b16 a[90:91], v22 offset:18688
    v_mfma_f32_32x32x16_bf16 a[128:143], a[32:35], v[212:215], a[128:143]
    ds_read_b64_tr_b16 a[92:93], v23 offset:16640
    ds_read_b64_tr_b16 a[94:95], v23 offset:18688
    v_mfma_f32_32x32x16_bf16 a[144:159], a[36:39], v[212:215], a[144:159]
    ds_read_b64_tr_b16 a[96:97], v20 offset:24576
    ds_read_b64_tr_b16 a[98:99], v20 offset:26624
    v_mfma_f32_32x32x16_bf16 a[160:175], a[40:43], v[212:215], a[160:175]
    ds_read_b64_tr_b16 a[100:101], v21 offset:24576
    ds_read_b64_tr_b16 a[102:103], v21 offset:26624
    v_mfma_f32_32x32x16_bf16 a[176:191], a[44:47], v[212:215], a[176:191]
    ds_read_b64_tr_b16 a[104:105], v22 offset:24576
    ds_read_b64_tr_b16 a[106:107], v22 offset:26624
    v_mfma_f32_32x32x16_bf16 a[192:207], a[48:51], v[212:215], a[192:207]
    ds_read_b64_tr_b16 a[108:109], v23 offset:24576
    ds_read_b64_tr_b16 a[110:111], v23 offset:26624
    v_mfma_f32_32x32x16_bf16 a[208:223], a[52:55], v[212:215], a[208:223]
    ds_read_b64_tr_b16 a[112:113], v20 offset:24832
    ds_read_b64_tr_b16 a[114:115], v20 offset:26880
    v_mfma_f32_32x32x16_bf16 a[224:239], a[56:59], v[212:215], a[224:239]
    ds_read_b64_tr_b16 a[116:117], v21 offset:24832
    ds_read_b64_tr_b16 a[118:119], v21 offset:26880
    v_mfma_f32_32x32x16_bf16 a[240:255], a[60:63], v[212:215], a[240:255]
    ds_read_b64_tr_b16 a[120:121], v22 offset:24832
    ds_read_b64_tr_b16 a[122:123], v22 offset:26880
    ds_read_b64_tr_b16 a[124:125], v23 offset:24832
    ds_read_b64_tr_b16 a[126:127], v23 offset:26880
    s_barrier
    s_waitcnt vmcnt(4)
    s_waitcnt lgkmcnt(0)
    v_mfma_f32_32x32x16_bf16 a[128:143], a[64:67], v[216:219], a[128:143]
    ds_read_b64_tr_b16 a[0:1], v12 offset:0
    ds_read_b64_tr_b16 a[2:3], v12 offset:2048
    v_mfma_f32_32x32x16_bf16 a[144:159], a[68:71], v[216:219], a[144:159]
    ds_read_b64_tr_b16 a[4:5], v13 offset:0
    ds_read_b64_tr_b16 a[6:7], v13 offset:2048
    v_mfma_f32_32x32x16_bf16 a[160:175], a[72:75], v[216:219], a[160:175]
    ds_read_b64_tr_b16 a[8:9], v14 offset:0
    ds_read_b64_tr_b16 a[10:11], v14 offset:2048
    v_mfma_f32_32x32x16_bf16 a[176:191], a[76:79], v[216:219], a[176:191]
    ds_read_b64_tr_b16 a[12:13], v15 offset:0
    ds_read_b64_tr_b16 a[14:15], v15 offset:2048
    v_mfma_f32_32x32x16_bf16 a[192:207], a[80:83], v[216:219], a[192:207]
    ds_read_b64_tr_b16 a[16:17], v12 offset:256
    ds_read_b64_tr_b16 a[18:19], v12 offset:2304
    v_mfma_f32_32x32x16_bf16 a[208:223], a[84:87], v[216:219], a[208:223]
    ds_read_b64_tr_b16 a[20:21], v13 offset:256
    ds_read_b64_tr_b16 a[22:23], v13 offset:2304
    v_mfma_f32_32x32x16_bf16 a[224:239], a[88:91], v[216:219], a[224:239]
    ds_read_b64_tr_b16 a[24:25], v14 offset:256
    ds_read_b64_tr_b16 a[26:27], v14 offset:2304
    v_mfma_f32_32x32x16_bf16 a[240:255], a[92:95], v[216:219], a[240:255]
    ds_read_b64_tr_b16 a[28:29], v15 offset:256
    ds_read_b64_tr_b16 a[30:31], v15 offset:2304
    v_mfma_f32_32x32x16_bf16 a[128:143], a[96:99], v[220:223], a[128:143]
    ds_read_b64_tr_b16 a[32:33], v12 offset:8192
    ds_read_b64_tr_b16 a[34:35], v12 offset:10240
    v_mfma_f32_32x32x16_bf16 a[144:159], a[100:103], v[220:223], a[144:159]
    ds_read_b64_tr_b16 a[36:37], v13 offset:8192
    ds_read_b64_tr_b16 a[38:39], v13 offset:10240
    v_mfma_f32_32x32x16_bf16 a[160:175], a[104:107], v[220:223], a[160:175]
    ds_read_b64_tr_b16 a[40:41], v14 offset:8192
    ds_read_b64_tr_b16 a[42:43], v14 offset:10240
    v_mfma_f32_32x32x16_bf16 a[176:191], a[108:111], v[220:223], a[176:191]
    ds_read_b64_tr_b16 a[44:45], v15 offset:8192
    ds_read_b64_tr_b16 a[46:47], v15 offset:10240
    v_mfma_f32_32x32x16_bf16 a[192:207], a[112:115], v[220:223], a[192:207]
    ds_read_b64_tr_b16 a[48:49], v12 offset:8448
    ds_read_b64_tr_b16 a[50:51], v12 offset:10496
    v_mfma_f32_32x32x16_bf16 a[208:223], a[116:119], v[220:223], a[208:223]
    ds_read_b64_tr_b16 a[52:53], v13 offset:8448
    ds_read_b64_tr_b16 a[54:55], v13 offset:10496
    v_mfma_f32_32x32x16_bf16 a[224:239], a[120:123], v[220:223], a[224:239]
    ds_read_b64_tr_b16 a[56:57], v14 offset:8448
    ds_read_b64_tr_b16 a[58:59], v14 offset:10496
    v_mfma_f32_32x32x16_bf16 a[240:255], a[124:127], v[220:223], a[240:255]
    ds_read_b64_tr_b16 a[60:61], v15 offset:8448
    ds_read_b64_tr_b16 a[62:63], v15 offset:10496
    s_barrier
    s_waitcnt vmcnt(2)
    s_waitcnt lgkmcnt(0)
    v_mfma_f32_32x32x16_bf16 a[128:143], a[0:3], v[224:227], a[128:143]
    ds_read_b64_tr_b16 a[64:65], v12 offset:16384
    ds_read_b64_tr_b16 a[66:67], v12 offset:18432
    v_mfma_f32_32x32x16_bf16 a[144:159], a[4:7], v[224:227], a[144:159]
    ds_read_b64_tr_b16 a[68:69], v13 offset:16384
    ds_read_b64_tr_b16 a[70:71], v13 offset:18432
    v_mfma_f32_32x32x16_bf16 a[160:175], a[8:11], v[224:227], a[160:175]
    ds_read_b64_tr_b16 a[72:73], v14 offset:16384
    ds_read_b64_tr_b16 a[74:75], v14 offset:18432
    v_mfma_f32_32x32x16_bf16 a[176:191], a[12:15], v[224:227], a[176:191]
    ds_read_b64_tr_b16 a[76:77], v15 offset:16384
    ds_read_b64_tr_b16 a[78:79], v15 offset:18432
    v_mfma_f32_32x32x16_bf16 a[192:207], a[16:19], v[224:227], a[192:207]
    ds_read_b64_tr_b16 a[80:81], v12 offset:16640
    ds_read_b64_tr_b16 a[82:83], v12 offset:18688
    v_mfma_f32_32x32x16_bf16 a[208:223], a[20:23], v[224:227], a[208:223]
    ds_read_b64_tr_b16 a[84:85], v13 offset:16640
    ds_read_b64_tr_b16 a[86:87], v13 offset:18688
    v_mfma_f32_32x32x16_bf16 a[224:239], a[24:27], v[224:227], a[224:239]
    ds_read_b64_tr_b16 a[88:89], v14 offset:16640
    ds_read_b64_tr_b16 a[90:91], v14 offset:18688
    v_mfma_f32_32x32x16_bf16 a[240:255], a[28:31], v[224:227], a[240:255]
    ds_read_b64_tr_b16 a[92:93], v15 offset:16640
    ds_read_b64_tr_b16 a[94:95], v15 offset:18688
    v_mfma_f32_32x32x16_bf16 a[128:143], a[32:35], v[228:231], a[128:143]
    ds_read_b64_tr_b16 a[96:97], v12 offset:24576
    ds_read_b64_tr_b16 a[98:99], v12 offset:26624
    v_mfma_f32_32x32x16_bf16 a[144:159], a[36:39], v[228:231], a[144:159]
    ds_read_b64_tr_b16 a[100:101], v13 offset:24576
    ds_read_b64_tr_b16 a[102:103], v13 offset:26624
    v_mfma_f32_32x32x16_bf16 a[160:175], a[40:43], v[228:231], a[160:175]
    ds_read_b64_tr_b16 a[104:105], v14 offset:24576
    ds_read_b64_tr_b16 a[106:107], v14 offset:26624
    v_mfma_f32_32x32x16_bf16 a[176:191], a[44:47], v[228:231], a[176:191]
    ds_read_b64_tr_b16 a[108:109], v15 offset:24576
    ds_read_b64_tr_b16 a[110:111], v15 offset:26624
    v_mfma_f32_32x32x16_bf16 a[192:207], a[48:51], v[228:231], a[192:207]
    ds_read_b64_tr_b16 a[112:113], v12 offset:24832
    ds_read_b64_tr_b16 a[114:115], v12 offset:26880
    v_mfma_f32_32x32x16_bf16 a[208:223], a[52:55], v[228:231], a[208:223]
    ds_read_b64_tr_b16 a[116:117], v13 offset:24832
    ds_read_b64_tr_b16 a[118:119], v13 offset:26880
    v_mfma_f32_32x32x16_bf16 a[224:239], a[56:59], v[228:231], a[224:239]
    ds_read_b64_tr_b16 a[120:121], v14 offset:24832
    ds_read_b64_tr_b16 a[122:123], v14 offset:26880
    v_mfma_f32_32x32x16_bf16 a[240:255], a[60:63], v[228:231], a[240:255]
    ds_read_b64_tr_b16 a[124:125], v15 offset:24832
    ds_read_b64_tr_b16 a[126:127], v15 offset:26880
    s_waitcnt vmcnt(0)
    s_waitcnt lgkmcnt(0)
    v_mfma_f32_32x32x16_bf16 a[128:143], a[64:67], v[232:235], a[128:143]
    v_mfma_f32_32x32x16_bf16 a[144:159], a[68:71], v[232:235], a[144:159]
    v_mfma_f32_32x32x16_bf16 a[160:175], a[72:75], v[232:235], a[160:175]
    v_mfma_f32_32x32x16_bf16 a[176:191], a[76:79], v[232:235], a[176:191]
    v_mfma_f32_32x32x16_bf16 a[192:207], a[80:83], v[232:235], a[192:207]
    v_mfma_f32_32x32x16_bf16 a[208:223], a[84:87], v[232:235], a[208:223]
    v_mfma_f32_32x32x16_bf16 a[224:239], a[88:91], v[232:235], a[224:239]
    v_mfma_f32_32x32x16_bf16 a[240:255], a[92:95], v[232:235], a[240:255]
    v_mfma_f32_32x32x16_bf16 a[128:143], a[96:99], v[236:239], a[128:143]
    v_mfma_f32_32x32x16_bf16 a[144:159], a[100:103], v[236:239], a[144:159]
    v_mfma_f32_32x32x16_bf16 a[160:175], a[104:107], v[236:239], a[160:175]
    v_mfma_f32_32x32x16_bf16 a[176:191], a[108:111], v[236:239], a[176:191]
    v_mfma_f32_32x32x16_bf16 a[192:207], a[112:115], v[236:239], a[192:207]
    v_mfma_f32_32x32x16_bf16 a[208:223], a[116:119], v[236:239], a[208:223]
    v_mfma_f32_32x32x16_bf16 a[224:239], a[120:123], v[236:239], a[224:239]
    v_mfma_f32_32x32x16_bf16 a[240:255], a[124:127], v[236:239], a[240:255]
    s_barrier
    s_add_u32 m0, s56, 65536
    s_add_u32 s58, s59, 0
    buffer_load_dwordx4 v36, s[28:31], s58 offen lds
    s_add_u32 m0, s56, 66560
    s_add_u32 s58, s59, 1024
    buffer_load_dwordx4 v37, s[28:31], s58 offen lds
    s_add_u32 m0, s56, 67584
    s_add_u32 s58, s59, 2048
    buffer_load_dwordx4 v36, s[28:31], s58 offen lds
    s_add_u32 m0, s56, 68608
    s_add_u32 s58, s59, 3072
    buffer_load_dwordx4 v37, s[28:31], s58 offen lds
    s_add_u32 m0, s56, 81920
    s_add_u32 s58, s59, 16384
    buffer_load_dwordx4 v36, s[28:31], s58 offen lds
    s_add_u32 m0, s56, 82944
    s_add_u32 s58, s59, 17408
    buffer_load_dwordx4 v37, s[28:31], s58 offen lds
    s_add_u32 m0, s56, 83968
    s_add_u32 s58, s59, 18432
    buffer_load_dwordx4 v36, s[28:31], s58 offen lds
    s_add_u32 m0, s56, 84992
    s_add_u32 s58, s59, 19456
    buffer_load_dwordx4 v37, s[28:31], s58 offen lds
    s_add_u32 m0, s56, 98304
    s_add_u32 s58, s59, 32768
    buffer_load_dwordx4 v36, s[28:31], s58 offen lds
    s_add_u32 m0, s56, 99328
    s_add_u32 s58, s59, 33792
    buffer_load_dwordx4 v37, s[28:31], s58 offen lds
    s_add_u32 m0, s56, 100352
    s_add_u32 s58, s59, 34816
    buffer_load_dwordx4 v36, s[28:31], s58 offen lds
    s_add_u32 m0, s56, 101376
    s_add_u32 s58, s59, 35840
    buffer_load_dwordx4 v37, s[28:31], s58 offen lds
    s_nop 15
    v_accvgpr_read_b32 v56, a128
    v_accvgpr_read_b32 v57, a129
    v_accvgpr_read_b32 v58, a130
    v_accvgpr_read_b32 v59, a131
    v_accvgpr_read_b32 v60, a132
    v_accvgpr_read_b32 v61, a133
    v_accvgpr_read_b32 v62, a134
    v_accvgpr_read_b32 v63, a135
    s_nop 0
    v_cvt_pk_bf16_f32 v120, v56, v57
    v_cvt_pk_bf16_f32 v121, v58, v59
    v_cvt_pk_bf16_f32 v122, v60, v61
    v_cvt_pk_bf16_f32 v123, v62, v63
    s_nop 1
    v_permlane32_swap_b32 v120, v122
    v_permlane32_swap_b32 v121, v123
    s_nop 1
    v_accvgpr_write_b32 a0, v120
    v_accvgpr_write_b32 a1, v121
    v_accvgpr_write_b32 a2, v122
    v_accvgpr_write_b32 a3, v123
    v_accvgpr_read_b32 v56, a136
    v_accvgpr_read_b32 v57, a137
    v_accvgpr_read_b32 v58, a138
    v_accvgpr_read_b32 v59, a139
    v_accvgpr_read_b32 v60, a140
    v_accvgpr_read_b32 v61, a141
    v_accvgpr_read_b32 v62, a142
    v_accvgpr_read_b32 v63, a143
    s_nop 0
    v_cvt_pk_bf16_f32 v120, v56, v57
    v_cvt_pk_bf16_f32 v121, v58, v59
    v_cvt_pk_bf16_f32 v122, v60, v61
    v_cvt_pk_bf16_f32 v123, v62, v63
    s_nop 1
    v_permlane32_swap_b32 v120, v122
    v_permlane32_swap_b32 v121, v123
    s_nop 1
    v_accvgpr_write_b32 a4, v120
    v_accvgpr_write_b32 a5, v121
    v_accvgpr_write_b32 a6, v122
    v_accvgpr_write_b32 a7, v123
    v_accvgpr_read_b32 v56, a144
    v_accvgpr_read_b32 v57, a145
    v_accvgpr_read_b32 v58, a146
    v_accvgpr_read_b32 v59, a147
    v_accvgpr_read_b32 v60, a148
    v_accvgpr_read_b32 v61, a149
    v_accvgpr_read_b32 v62, a150
    v_accvgpr_read_b32 v63, a151
    s_nop 0
    v_cvt_pk_bf16_f32 v120, v56, v57
    v_cvt_pk_bf16_f32 v121, v58, v59
    v_cvt_pk_bf16_f32 v122, v60, v61
    v_cvt_pk_bf16_f32 v123, v62, v63
    s_nop 1
    v_permlane32_swap_b32 v120, v122
    v_permlane32_swap_b32 v121, v123
    s_nop 1
    v_accvgpr_write_b32 a8, v120
    v_accvgpr_write_b32 a9, v121
    v_accvgpr_write_b32 a10, v122
    v_accvgpr_write_b32 a11, v123
    v_accvgpr_read_b32 v56, a152
    v_accvgpr_read_b32 v57, a153
    v_accvgpr_read_b32 v58, a154
    v_accvgpr_read_b32 v59, a155
    v_accvgpr_read_b32 v60, a156
    v_accvgpr_read_b32 v61, a157
    v_accvgpr_read_b32 v62, a158
    v_accvgpr_read_b32 v63, a159
    s_nop 0
    v_cvt_pk_bf16_f32 v120, v56, v57
    v_cvt_pk_bf16_f32 v121, v58, v59
    v_cvt_pk_bf16_f32 v122, v60, v61
    v_cvt_pk_bf16_f32 v123, v62, v63
    s_nop 1
    v_permlane32_swap_b32 v120, v122
    v_permlane32_swap_b32 v121, v123
    s_nop 1
    v_accvgpr_write_b32 a12, v120
    v_accvgpr_write_b32 a13, v121
    v_accvgpr_write_b32 a14, v122
    v_accvgpr_write_b32 a15, v123
    v_accvgpr_read_b32 v56, a160
    v_accvgpr_read_b32 v57, a161
    v_accvgpr_read_b32 v58, a162
    v_accvgpr_read_b32 v59, a163
    v_accvgpr_read_b32 v60, a164
    v_accvgpr_read_b32 v61, a165
    v_accvgpr_read_b32 v62, a166
    v_accvgpr_read_b32 v63, a167
    s_nop 0
    v_cvt_pk_bf16_f32 v120, v56, v57
    v_cvt_pk_bf16_f32 v121, v58, v59
    v_cvt_pk_bf16_f32 v122, v60, v61
    v_cvt_pk_bf16_f32 v123, v62, v63
    s_nop 1
    v_permlane32_swap_b32 v120, v122
    v_permlane32_swap_b32 v121, v123
    s_nop 1
    v_accvgpr_write_b32 a16, v120
    v_accvgpr_write_b32 a17, v121
    v_accvgpr_write_b32 a18, v122
    v_accvgpr_write_b32 a19, v123
    v_accvgpr_read_b32 v56, a168
    v_accvgpr_read_b32 v57, a169
    v_accvgpr_read_b32 v58, a170
    v_accvgpr_read_b32 v59, a171
    v_accvgpr_read_b32 v60, a172
    v_accvgpr_read_b32 v61, a173
    v_accvgpr_read_b32 v62, a174
    v_accvgpr_read_b32 v63, a175
    s_nop 0
    v_cvt_pk_bf16_f32 v120, v56, v57
    v_cvt_pk_bf16_f32 v121, v58, v59
    v_cvt_pk_bf16_f32 v122, v60, v61
    v_cvt_pk_bf16_f32 v123, v62, v63
    s_nop 1
    v_permlane32_swap_b32 v120, v122
    v_permlane32_swap_b32 v121, v123
    s_nop 1
    v_accvgpr_write_b32 a20, v120
    v_accvgpr_write_b32 a21, v121
    v_accvgpr_write_b32 a22, v122
    v_accvgpr_write_b32 a23, v123
    v_accvgpr_read_b32 v56, a176
    v_accvgpr_read_b32 v57, a177
    v_accvgpr_read_b32 v58, a178
    v_accvgpr_read_b32 v59, a179
    v_accvgpr_read_b32 v60, a180
    v_accvgpr_read_b32 v61, a181
    v_accvgpr_read_b32 v62, a182
    v_accvgpr_read_b32 v63, a183
    s_nop 0
    v_cvt_pk_bf16_f32 v120, v56, v57
    v_cvt_pk_bf16_f32 v121, v58, v59
    v_cvt_pk_bf16_f32 v122, v60, v61
    v_cvt_pk_bf16_f32 v123, v62, v63
    s_nop 1
    v_permlane32_swap_b32 v120, v122
    v_permlane32_swap_b32 v121, v123
    s_nop 1
    v_accvgpr_write_b32 a24, v120
    v_accvgpr_write_b32 a25, v121
    v_accvgpr_write_b32 a26, v122
    v_accvgpr_write_b32 a27, v123
    v_accvgpr_read_b32 v56, a184
    v_accvgpr_read_b32 v57, a185
    v_accvgpr_read_b32 v58, a186
    v_accvgpr_read_b32 v59, a187
    v_accvgpr_read_b32 v60, a188
    v_accvgpr_read_b32 v61, a189
    v_accvgpr_read_b32 v62, a190
    v_accvgpr_read_b32 v63, a191
    s_nop 0
    v_cvt_pk_bf16_f32 v120, v56, v57
    v_cvt_pk_bf16_f32 v121, v58, v59
    v_cvt_pk_bf16_f32 v122, v60, v61
    v_cvt_pk_bf16_f32 v123, v62, v63
    s_nop 1
    v_permlane32_swap_b32 v120, v122
    v_permlane32_swap_b32 v121, v123
    s_nop 1
    v_accvgpr_write_b32 a28, v120
    v_accvgpr_write_b32 a29, v121
    v_accvgpr_write_b32 a30, v122
    v_accvgpr_write_b32 a31, v123
    v_accvgpr_read_b32 v56, a192
    v_accvgpr_read_b32 v57, a193
    v_accvgpr_read_b32 v58, a194
    v_accvgpr_read_b32 v59, a195
    v_accvgpr_read_b32 v60, a196
    v_accvgpr_read_b32 v61, a197
    v_accvgpr_read_b32 v62, a198
    v_accvgpr_read_b32 v63, a199
    s_nop 0
    v_cvt_pk_bf16_f32 v120, v56, v57
    v_cvt_pk_bf16_f32 v121, v58, v59
    v_cvt_pk_bf16_f32 v122, v60, v61
    v_cvt_pk_bf16_f32 v123, v62, v63
    s_nop 1
    v_permlane32_swap_b32 v120, v122
    v_permlane32_swap_b32 v121, v123
    s_nop 1
    v_accvgpr_write_b32 a32, v120
    v_accvgpr_write_b32 a33, v121
    v_accvgpr_write_b32 a34, v122
    v_accvgpr_write_b32 a35, v123
    v_accvgpr_read_b32 v56, a200
    v_accvgpr_read_b32 v57, a201
    v_accvgpr_read_b32 v58, a202
    v_accvgpr_read_b32 v59, a203
    v_accvgpr_read_b32 v60, a204
    v_accvgpr_read_b32 v61, a205
    v_accvgpr_read_b32 v62, a206
    v_accvgpr_read_b32 v63, a207
    s_nop 0
    v_cvt_pk_bf16_f32 v120, v56, v57
    v_cvt_pk_bf16_f32 v121, v58, v59
    v_cvt_pk_bf16_f32 v122, v60, v61
    v_cvt_pk_bf16_f32 v123, v62, v63
    s_nop 1
    v_permlane32_swap_b32 v120, v122
    v_permlane32_swap_b32 v121, v123
    s_nop 1
    v_accvgpr_write_b32 a36, v120
    v_accvgpr_write_b32 a37, v121
    v_accvgpr_write_b32 a38, v122
    v_accvgpr_write_b32 a39, v123
    v_accvgpr_read_b32 v56, a208
    v_accvgpr_read_b32 v57, a209
    v_accvgpr_read_b32 v58, a210
    v_accvgpr_read_b32 v59, a211
    v_accvgpr_read_b32 v60, a212
    v_accvgpr_read_b32 v61, a213
    v_accvgpr_read_b32 v62, a214
    v_accvgpr_read_b32 v63, a215
    s_nop 0
    v_cvt_pk_bf16_f32 v120, v56, v57
    v_cvt_pk_bf16_f32 v121, v58, v59
    v_cvt_pk_bf16_f32 v122, v60, v61
    v_cvt_pk_bf16_f32 v123, v62, v63
    s_nop 1
    v_permlane32_swap_b32 v120, v122
    v_permlane32_swap_b32 v121, v123
    s_nop 1
    v_accvgpr_write_b32 a40, v120
    v_accvgpr_write_b32 a41, v121
    v_accvgpr_write_b32 a42, v122
    v_accvgpr_write_b32 a43, v123
    v_accvgpr_read_b32 v56, a216
    v_accvgpr_read_b32 v57, a217
    v_accvgpr_read_b32 v58, a218
    v_accvgpr_read_b32 v59, a219
    v_accvgpr_read_b32 v60, a220
    v_accvgpr_read_b32 v61, a221
    v_accvgpr_read_b32 v62, a222
    v_accvgpr_read_b32 v63, a223
    s_nop 0
    v_cvt_pk_bf16_f32 v120, v56, v57
    v_cvt_pk_bf16_f32 v121, v58, v59
    v_cvt_pk_bf16_f32 v122, v60, v61
    v_cvt_pk_bf16_f32 v123, v62, v63
    s_nop 1
    v_permlane32_swap_b32 v120, v122
    v_permlane32_swap_b32 v121, v123
    s_nop 1
    v_accvgpr_write_b32 a44, v120
    v_accvgpr_write_b32 a45, v121
    v_accvgpr_write_b32 a46, v122
    v_accvgpr_write_b32 a47, v123
    v_accvgpr_read_b32 v56, a224
    v_accvgpr_read_b32 v57, a225
    v_accvgpr_read_b32 v58, a226
    v_accvgpr_read_b32 v59, a227
    v_accvgpr_read_b32 v60, a228
    v_accvgpr_read_b32 v61, a229
    v_accvgpr_read_b32 v62, a230
    v_accvgpr_read_b32 v63, a231
    s_nop 0
    v_cvt_pk_bf16_f32 v120, v56, v57
    v_cvt_pk_bf16_f32 v121, v58, v59
    v_cvt_pk_bf16_f32 v122, v60, v61
    v_cvt_pk_bf16_f32 v123, v62, v63
    s_nop 1
    v_permlane32_swap_b32 v120, v122
    v_permlane32_swap_b32 v121, v123
    s_nop 1
    v_accvgpr_write_b32 a48, v120
    v_accvgpr_write_b32 a49, v121
    v_accvgpr_write_b32 a50, v122
    v_accvgpr_write_b32 a51, v123
    v_accvgpr_read_b32 v56, a232
    v_accvgpr_read_b32 v57, a233
    v_accvgpr_read_b32 v58, a234
    v_accvgpr_read_b32 v59, a235
    v_accvgpr_read_b32 v60, a236
    v_accvgpr_read_b32 v61, a237
    v_accvgpr_read_b32 v62, a238
    v_accvgpr_read_b32 v63, a239
    s_nop 0
    v_cvt_pk_bf16_f32 v120, v56, v57
    v_cvt_pk_bf16_f32 v121, v58, v59
    v_cvt_pk_bf16_f32 v122, v60, v61
    v_cvt_pk_bf16_f32 v123, v62, v63
    s_nop 1
    v_permlane32_swap_b32 v120, v122
    v_permlane32_swap_b32 v121, v123
    s_nop 1
    v_accvgpr_write_b32 a52, v120
    v_accvgpr_write_b32 a53, v121
    v_accvgpr_write_b32 a54, v122
    v_accvgpr_write_b32 a55, v123
    v_accvgpr_read_b32 v56, a240
    v_accvgpr_read_b32 v57, a241
    v_accvgpr_read_b32 v58, a242
    v_accvgpr_read_b32 v59, a243
    v_accvgpr_read_b32 v60, a244
    v_accvgpr_read_b32 v61, a245
    v_accvgpr_read_b32 v62, a246
    v_accvgpr_read_b32 v63, a247
    s_nop 0
    v_cvt_pk_bf16_f32 v120, v56, v57
    v_cvt_pk_bf16_f32 v121, v58, v59
    v_cvt_pk_bf16_f32 v122, v60, v61
    v_cvt_pk_bf16_f32 v123, v62, v63
    s_nop 1
    v_permlane32_swap_b32 v120, v122
    v_permlane32_swap_b32 v121, v123
    s_nop 1
    v_accvgpr_write_b32 a56, v120
    v_accvgpr_write_b32 a57, v121
    v_accvgpr_write_b32 a58, v122
    v_accvgpr_write_b32 a59, v123
    v_accvgpr_read_b32 v56, a248
    v_accvgpr_read_b32 v57, a249
    v_accvgpr_read_b32 v58, a250
    v_accvgpr_read_b32 v59, a251
    v_accvgpr_read_b32 v60, a252
    v_accvgpr_read_b32 v61, a253
    v_accvgpr_read_b32 v62, a254
    v_accvgpr_read_b32 v63, a255
    s_nop 0
    v_cvt_pk_bf16_f32 v120, v56, v57
    v_cvt_pk_bf16_f32 v121, v58, v59
    v_cvt_pk_bf16_f32 v122, v60, v61
    v_cvt_pk_bf16_f32 v123, v62, v63
    s_nop 1
    v_permlane32_swap_b32 v120, v122
    v_permlane32_swap_b32 v121, v123
    s_nop 1
    v_accvgpr_write_b32 a60, v120
    v_accvgpr_write_b32 a61, v121
    v_accvgpr_write_b32 a62, v122
    v_accvgpr_write_b32 a63, v123
    v_lshlrev_b32 v9, 9, v2
    v_and_b32 v24, 15, v2
    v_add_u32 v25, 0, v3
    v_xor_b32 v25, v25, v24
    v_lshl_add_u32 v16, v25, 4, v9
    v_add_u32 v25, 2, v3
    v_xor_b32 v25, v25, v24
    v_lshl_add_u32 v17, v25, 4, v9
    v_add_u32 v25, 4, v3
    v_xor_b32 v25, v25, v24
    v_lshl_add_u32 v18, v25, 4, v9
    v_add_u32 v25, 6, v3
    v_xor_b32 v25, v25, v24
    v_lshl_add_u32 v19, v25, 4, v9
    v_add_u32 v25, 8, v3
    v_xor_b32 v25, v25, v24
    v_lshl_add_u32 v20, v25, 4, v9
    v_add_u32 v25, 10, v3
    v_xor_b32 v25, v25, v24
    v_lshl_add_u32 v21, v25, 4, v9
    v_add_u32 v25, 12, v3
    v_xor_b32 v25, v25, v24
    v_lshl_add_u32 v22, v25, 4, v9
    v_add_u32 v25, 14, v3
    v_xor_b32 v25, v25, v24
    v_lshl_add_u32 v23, v25, 4, v9
    v_lshlrev_b32 v9, 2, v3
    v_add_u32 v9, v9, v5
    v_lshlrev_b32 v9, 9, v9
    v_add_u32 v9, 65536, v9
    v_lshrrev_b32 v38, 1, v6
    v_lshl_add_u32 v38, v4, 1, v38
    v_lshl_add_u32 v9, v38, 4, v9
    v_and_b32 v38, 1, v6
    v_lshl_add_u32 v9, v38, 3, v9
    v_xor_b32 v38, 0, v5
    v_lshl_add_u32 v24, v38, 6, v9
    v_xor_b32 v38, 1, v5
    v_lshl_add_u32 v25, v38, 6, v9
    v_xor_b32 v38, 2, v5
    v_lshl_add_u32 v26, v38, 6, v9
    v_xor_b32 v38, 3, v5
    v_lshl_add_u32 v27, v38, 6, v9
    v_mov_b32 v40, 0xff800000
    v_mov_b32 v41, 0
    v_mov_b32 v128, 0
    v_mov_b32 v129, 0
    v_mov_b32 v130, 0
    v_mov_b32 v131, 0
    v_mov_b32 v132, 0
    v_mov_b32 v133, 0
    v_mov_b32 v134, 0
    v_mov_b32 v135, 0
    v_mov_b32 v136, 0
    v_mov_b32 v137, 0
    v_mov_b32 v138, 0
    v_mov_b32 v139, 0
    v_mov_b32 v140, 0
    v_mov_b32 v141, 0
    v_mov_b32 v142, 0
    v_mov_b32 v143, 0
    v_mov_b32 v144, 0
    v_mov_b32 v145, 0
    v_mov_b32 v146, 0
    v_mov_b32 v147, 0
    v_mov_b32 v148, 0
    v_mov_b32 v149, 0
    v_mov_b32 v150, 0
    v_mov_b32 v151, 0
    v_mov_b32 v152, 0
    v_mov_b32 v153, 0
    v_mov_b32 v154, 0
    v_mov_b32 v155, 0
    v_mov_b32 v156, 0
    v_mov_b32 v157, 0
    v_mov_b32 v158, 0
    v_mov_b32 v159, 0
    v_mov_b32 v160, 0
    v_mov_b32 v161, 0
    v_mov_b32 v162, 0
    v_mov_b32 v163, 0
    v_mov_b32 v164, 0
    v_mov_b32 v165, 0
    v_mov_b32 v166, 0
    v_mov_b32 v167, 0
    v_mov_b32 v168, 0
    v_mov_b32 v169, 0
    v_mov_b32 v170, 0
    v_mov_b32 v171, 0
    v_mov_b32 v172, 0
    v_mov_b32 v173, 0
    v_mov_b32 v174, 0
    v_mov_b32 v175, 0
    v_mov_b32 v176, 0
    v_mov_b32 v177, 0
    v_mov_b32 v178, 0
    v_mov_b32 v179, 0
    v_mov_b32 v180, 0
    v_mov_b32 v181, 0
    v_mov_b32 v182, 0
    v_mov_b32 v183, 0
    v_mov_b32 v184, 0
    v_mov_b32 v185, 0
    v_mov_b32 v186, 0
    v_mov_b32 v187, 0
    v_mov_b32 v188, 0
    v_mov_b32 v189, 0
    v_mov_b32 v190, 0
    v_mov_b32 v191, 0
    v_mov_b32 v192, 0
    v_mov_b32 v193, 0
    v_mov_b32 v194, 0
    v_mov_b32 v195, 0
    v_mov_b32 v196, 0
    v_mov_b32 v197, 0
    v_mov_b32 v198, 0
    v_mov_b32 v199, 0
    v_mov_b32 v200, 0
    v_mov_b32 v201, 0
    v_mov_b32 v202, 0
    v_mov_b32 v203, 0
    v_mov_b32 v204, 0
    v_mov_b32 v205, 0
    v_mov_b32 v206, 0
    v_mov_b32 v207, 0
    v_mov_b32 v208, 0
    v_mov_b32 v209, 0
    v_mov_b32 v210, 0
    v_mov_b32 v211, 0
    v_mov_b32 v212, 0
    v_mov_b32 v213, 0
    v_mov_b32 v214, 0
    v_mov_b32 v215, 0
    v_mov_b32 v216, 0
    v_mov_b32 v217, 0
    v_mov_b32 v218, 0
    v_mov_b32 v219, 0
    v_mov_b32 v220, 0
    v_mov_b32 v221, 0
    v_mov_b32 v222, 0
    v_mov_b32 v223, 0
    v_mov_b32 v224, 0
    v_mov_b32 v225, 0
    v_mov_b32 v226, 0
    v_mov_b32 v227, 0
    v_mov_b32 v228, 0
    v_mov_b32 v229, 0
    v_mov_b32 v230, 0
    v_mov_b32 v231, 0
    v_mov_b32 v232, 0
    v_mov_b32 v233, 0
    v_mov_b32 v234, 0
    v_mov_b32 v235, 0
    v_mov_b32 v236, 0
    v_mov_b32 v237, 0
    v_mov_b32 v238, 0
    v_mov_b32 v239, 0
    v_mov_b32 v240, 0
    v_mov_b32 v241, 0
    v_mov_b32 v242, 0
    v_mov_b32 v243, 0
    v_mov_b32 v244, 0
    v_mov_b32 v245, 0
    v_mov_b32 v246, 0
    v_mov_b32 v247, 0
    v_mov_b32 v248, 0
    v_mov_b32 v249, 0
    v_mov_b32 v250, 0
    v_mov_b32 v251, 0
    v_mov_b32 v252, 0
    v_mov_b32 v253, 0
    v_mov_b32 v254, 0
    v_mov_b32 v255, 0
    s_mov_b32 s55, 0x3db8aa3b
    v_mov_b32 v39, 8.0
    s_barrier
    ds_read_b128 a[64:67], v16 offset:0
    ds_read_b128 a[68:71], v17 offset:0
    ds_read_b128 a[72:75], v18 offset:0
    ds_read_b128 a[76:79], v19 offset:0
    ds_read_b128 a[80:83], v20 offset:0
    ds_read_b128 a[84:87], v21 offset:0
    ds_read_b128 a[88:91], v22 offset:0
    ds_read_b128 a[92:95], v23 offset:0
    ds_read_b128 a[96:99], v16 offset:256
    ds_read_b128 a[100:103], v17 offset:256
    ds_read_b128 a[104:107], v18 offset:256
    ds_read_b128 a[108:111], v19 offset:256
    ds_read_b128 a[112:115], v20 offset:256
    ds_read_b128 a[116:119], v21 offset:256
    ds_read_b128 a[120:123], v22 offset:256
    ds_read_b128 a[124:127], v23 offset:256
    s_waitcnt lgkmcnt(15)
    v_mfma_f32_32x32x16_bf16 v[96:111], a[64:67], a[0:3], 0
    s_waitcnt lgkmcnt(14)
    v_mfma_f32_32x32x16_bf16 v[96:111], a[68:71], a[4:7], v[96:111]
    s_waitcnt lgkmcnt(13)
    v_mfma_f32_32x32x16_bf16 v[96:111], a[72:75], a[8:11], v[96:111]
    s_waitcnt lgkmcnt(12)
    v_mfma_f32_32x32x16_bf16 v[96:111], a[76:79], a[12:15], v[96:111]
    s_waitcnt lgkmcnt(11)
    v_mfma_f32_32x32x16_bf16 v[96:111], a[80:83], a[16:19], v[96:111]
    s_waitcnt lgkmcnt(10)
    v_mfma_f32_32x32x16_bf16 v[96:111], a[84:87], a[20:23], v[96:111]
    s_waitcnt lgkmcnt(9)
    v_mfma_f32_32x32x16_bf16 v[96:111], a[88:91], a[24:27], v[96:111]
    s_waitcnt lgkmcnt(8)
    v_mfma_f32_32x32x16_bf16 v[96:111], a[92:95], a[28:31], v[96:111]
    s_waitcnt lgkmcnt(7)
    v_mfma_f32_32x32x16_bf16 v[96:111], a[96:99], a[32:35], v[96:111]
    s_waitcnt lgkmcnt(6)
    v_mfma_f32_32x32x16_bf16 v[96:111], a[100:103], a[36:39], v[96:111]
    s_waitcnt lgkmcnt(5)
    v_mfma_f32_32x32x16_bf16 v[96:111], a[104:107], a[40:43], v[96:111]
    s_waitcnt lgkmcnt(4)
    v_mfma_f32_32x32x16_bf16 v[96:111], a[108:111], a[44:47], v[96:111]
    s_waitcnt lgkmcnt(3)
    v_mfma_f32_32x32x16_bf16 v[96:111], a[112:115], a[48:51], v[96:111]
    s_waitcnt lgkmcnt(2)
    v_mfma_f32_32x32x16_bf16 v[96:111], a[116:119], a[52:55], v[96:111]
    s_waitcnt lgkmcnt(1)
    v_mfma_f32_32x32x16_bf16 v[96:111], a[120:123], a[56:59], v[96:111]
    s_waitcnt lgkmcnt(0)
    v_mfma_f32_32x32x16_bf16 v[96:111], a[124:127], a[60:63], v[96:111]
    s_waitcnt vmcnt(8)
    s_barrier
    s_add_u32 m0, s56, 0
    s_add_u32 s58, s57, 65536
    buffer_load_dwordx4 v28, s[24:27], s58 offen lds
    s_add_u32 m0, s56, 1024
    s_add_u32 s58, s57, 65536
    buffer_load_dwordx4 v29, s[24:27], s58 offen lds
    s_add_u32 m0, s56, 2048
    s_add_u32 s58, s57, 65536
    buffer_load_dwordx4 v30, s[24:27], s58 offen lds
    s_add_u32 m0, s56, 3072
    s_add_u32 s58, s57, 65536
    buffer_load_dwordx4 v31, s[24:27], s58 offen lds
    ds_read_b128 a[64:67], v16 offset:16384
    ds_read_b128 a[68:71], v17 offset:16384
    ds_read_b128 a[72:75], v18 offset:16384
    ds_read_b128 a[76:79], v19 offset:16384
    ds_read_b128 a[80:83], v20 offset:16384
    ds_read_b128 a[84:87], v21 offset:16384
    ds_read_b128 a[88:91], v22 offset:16384
    ds_read_b128 a[92:95], v23 offset:16384
    ds_read_b128 a[96:99], v16 offset:16640
    ds_read_b128 a[100:103], v17 offset:16640
    ds_read_b128 a[104:107], v18 offset:16640
    ds_read_b128 a[108:111], v19 offset:16640
    ds_read_b128 a[112:115], v20 offset:16640
    ds_read_b128 a[116:119], v21 offset:16640
    ds_read_b128 a[120:123], v22 offset:16640
    ds_read_b128 a[124:127], v23 offset:16640
    s_add_u32 m0, s56, 114688
    s_add_u32 s58, s59, 49152
    buffer_load_dwordx4 v36, s[28:31], s58 offen lds
    s_add_u32 m0, s56, 115712
    s_add_u32 s58, s59, 50176
    buffer_load_dwordx4 v37, s[28:31], s58 offen lds
    s_add_u32 m0, s56, 116736
    s_add_u32 s58, s59, 51200
    buffer_load_dwordx4 v36, s[28:31], s58 offen lds
    s_add_u32 m0, s56, 117760
    s_add_u32 s58, s59, 52224
    buffer_load_dwordx4 v37, s[28:31], s58 offen lds
    v_max3_f32 v42, v96, v97, v98
    v_max3_f32 v42, v42, v99, v100
    v_max3_f32 v42, v42, v101, v102
    v_max3_f32 v42, v42, v103, v104
    v_max3_f32 v42, v42, v105, v106
    v_max3_f32 v42, v42, v107, v108
    v_max3_f32 v42, v42, v109, v110
    v_max_f32 v42, v42, v111
    v_mov_b32 v43, v42
    s_nop 1
    v_permlane32_swap_b32 v42, v43
    v_max_f32 v42, v42, v43
    v_mul_f32 v42, s55, v42
    v_sub_f32 v43, v42, v40
    v_cmp_gt_f32 vcc, v43, v39
    s_nop 4
    s_cbranch_vccz LA_nr0
    s_nop 15
    v_max_f32 v42, v40, v42
    v_sub_f32 v43, v40, v42
    v_exp_f32 v43, v43
    v_mov_b32 v40, v42
    s_nop 0
    v_mul_f32 v41, v41, v43
    v_mul_f32 v128, v128, v43
    v_mul_f32 v129, v129, v43
    v_mul_f32 v130, v130, v43
    v_mul_f32 v131, v131, v43
    v_mul_f32 v132, v132, v43
    v_mul_f32 v133, v133, v43
    v_mul_f32 v134, v134, v43
    v_mul_f32 v135, v135, v43
    v_mul_f32 v136, v136, v43
    v_mul_f32 v137, v137, v43
    v_mul_f32 v138, v138, v43
    v_mul_f32 v139, v139, v43
    v_mul_f32 v140, v140, v43
    v_mul_f32 v141, v141, v43
    v_mul_f32 v142, v142, v43
    v_mul_f32 v143, v143, v43
    v_mul_f32 v144, v144, v43
    v_mul_f32 v145, v145, v43
    v_mul_f32 v146, v146, v43
    v_mul_f32 v147, v147, v43
    v_mul_f32 v148, v148, v43
    v_mul_f32 v149, v149, v43
    v_mul_f32 v150, v150, v43
    v_mul_f32 v151, v151, v43
    v_mul_f32 v152, v152, v43
    v_mul_f32 v153, v153, v43
    v_mul_f32 v154, v154, v43
    v_mul_f32 v155, v155, v43
    v_mul_f32 v156, v156, v43
    v_mul_f32 v157, v157, v43
    v_mul_f32 v158, v158, v43
    v_mul_f32 v159, v159, v43
    v_mul_f32 v160, v160, v43
    v_mul_f32 v161, v161, v43
    v_mul_f32 v162, v162, v43
    v_mul_f32 v163, v163, v43
    v_mul_f32 v164, v164, v43
    v_mul_f32 v165, v165, v43
    v_mul_f32 v166, v166, v43
    v_mul_f32 v167, v167, v43
    v_mul_f32 v168, v168, v43
    v_mul_f32 v169, v169, v43
    v_mul_f32 v170, v170, v43
    v_mul_f32 v171, v171, v43
    v_mul_f32 v172, v172, v43
    v_mul_f32 v173, v173, v43
    v_mul_f32 v174, v174, v43
    v_mul_f32 v175, v175, v43
    v_mul_f32 v176, v176, v43
    v_mul_f32 v177, v177, v43
    v_mul_f32 v178, v178, v43
    v_mul_f32 v179, v179, v43
    v_mul_f32 v180, v180, v43
    v_mul_f32 v181, v181, v43
    v_mul_f32 v182, v182, v43
    v_mul_f32 v183, v183, v43
    v_mul_f32 v184, v184, v43
    v_mul_f32 v185, v185, v43
    v_mul_f32 v186, v186, v43
    v_mul_f32 v187, v187, v43
    v_mul_f32 v188, v188, v43
    v_mul_f32 v189, v189, v43
    v_mul_f32 v190, v190, v43
    v_mul_f32 v191, v191, v43
    v_mul_f32 v192, v192, v43
    v_mul_f32 v193, v193, v43
    v_mul_f32 v194, v194, v43
    v_mul_f32 v195, v195, v43
    v_mul_f32 v196, v196, v43
    v_mul_f32 v197, v197, v43
    v_mul_f32 v198, v198, v43
    v_mul_f32 v199, v199, v43
    v_mul_f32 v200, v200, v43
    v_mul_f32 v201, v201, v43
    v_mul_f32 v202, v202, v43
    v_mul_f32 v203, v203, v43
    v_mul_f32 v204, v204, v43
    v_mul_f32 v205, v205, v43
    v_mul_f32 v206, v206, v43
    v_mul_f32 v207, v207, v43
    v_mul_f32 v208, v208, v43
    v_mul_f32 v209, v209, v43
    v_mul_f32 v210, v210, v43
    v_mul_f32 v211, v211, v43
    v_mul_f32 v212, v212, v43
    v_mul_f32 v213, v213, v43
    v_mul_f32 v214, v214, v43
    v_mul_f32 v215, v215, v43
    v_mul_f32 v216, v216, v43
    v_mul_f32 v217, v217, v43
    v_mul_f32 v218, v218, v43
    v_mul_f32 v219, v219, v43
    v_mul_f32 v220, v220, v43
    v_mul_f32 v221, v221, v43
    v_mul_f32 v222, v222, v43
    v_mul_f32 v223, v223, v43
    v_mul_f32 v224, v224, v43
    v_mul_f32 v225, v225, v43
    v_mul_f32 v226, v226, v43
    v_mul_f32 v227, v227, v43
    v_mul_f32 v228, v228, v43
    v_mul_f32 v229, v229, v43
    v_mul_f32 v230, v230, v43
    v_mul_f32 v231, v231, v43
    v_mul_f32 v232, v232, v43
    v_mul_f32 v233, v233, v43
    v_mul_f32 v234, v234, v43
    v_mul_f32 v235, v235, v43
    v_mul_f32 v236, v236, v43
    v_mul_f32 v237, v237, v43
    v_mul_f32 v238, v238, v43
    v_mul_f32 v239, v239, v43
    v_mul_f32 v240, v240, v43
    v_mul_f32 v241, v241, v43
    v_mul_f32 v242, v242, v43
    v_mul_f32 v243, v243, v43
    v_mul_f32 v244, v244, v43
    v_mul_f32 v245, v245, v43
    v_mul_f32 v246, v246, v43
    v_mul_f32 v247, v247, v43
    v_mul_f32 v248, v248, v43
    v_mul_f32 v249, v249, v43
    v_mul_f32 v250, v250, v43
    v_mul_f32 v251, v251, v43
    v_mul_f32 v252, v252, v43
    v_mul_f32 v253, v253, v43
    v_mul_f32 v254, v254, v43
    v_mul_f32 v255, v255, v43
LA_nr0:
    s_waitcnt lgkmcnt(15)
    v_mfma_f32_32x32x16_bf16 v[112:127], a[64:67], a[0:3], 0
    v_fma_f32 v96, v96, s55, -v40
    v_fma_f32 v97, v97, s55, -v40
    v_fma_f32 v98, v98, s55, -v40
    v_fma_f32 v99, v99, s55, -v40
    v_fma_f32 v100, v100, s55, -v40
    s_waitcnt lgkmcnt(14)
    v_mfma_f32_32x32x16_bf16 v[112:127], a[68:71], a[4:7], v[112:127]
    v_fma_f32 v101, v101, s55, -v40
    v_fma_f32 v102, v102, s55, -v40
    v_fma_f32 v103, v103, s55, -v40
    v_fma_f32 v104, v104, s55, -v40
    v_fma_f32 v105, v105, s55, -v40
    v_fma_f32 v106, v106, s55, -v40
    s_waitcnt lgkmcnt(13)
    v_mfma_f32_32x32x16_bf16 v[112:127], a[72:75], a[8:11], v[112:127]
    v_fma_f32 v107, v107, s55, -v40
    v_fma_f32 v108, v108, s55, -v40
    v_fma_f32 v109, v109, s55, -v40
    v_fma_f32 v110, v110, s55, -v40
    v_fma_f32 v111, v111, s55, -v40
    s_waitcnt lgkmcnt(12)
    v_mfma_f32_32x32x16_bf16 v[112:127], a[76:79], a[12:15], v[112:127]
    v_exp_f32 v96, v96
    ds_read_b64_tr_b16 a[128:129], v24 offset:0
    ds_read_b64_tr_b16 a[130:131], v24 offset:4096
    v_exp_f32 v97, v97
    ds_read_b64_tr_b16 a[132:133], v25 offset:0
    ds_read_b64_tr_b16 a[134:135], v25 offset:4096
    s_waitcnt lgkmcnt(15)
    v_mfma_f32_32x32x16_bf16 v[112:127], a[80:83], a[16:19], v[112:127]
    v_exp_f32 v98, v98
    ds_read_b64_tr_b16 a[136:137], v26 offset:0
    ds_read_b64_tr_b16 a[138:139], v26 offset:4096
    v_exp_f32 v99, v99
    ds_read_b64_tr_b16 a[140:141], v27 offset:0
    s_waitcnt lgkmcnt(15)
    v_mfma_f32_32x32x16_bf16 v[112:127], a[84:87], a[20:23], v[112:127]
    ds_read_b64_tr_b16 a[142:143], v27 offset:4096
    v_exp_f32 v100, v100
    ds_read_b64_tr_b16 a[144:145], v24 offset:256
    ds_read_b64_tr_b16 a[146:147], v24 offset:4352
    v_exp_f32 v101, v101
    ds_read_b64_tr_b16 a[148:149], v25 offset:256
    s_waitcnt lgkmcnt(15)
    v_mfma_f32_32x32x16_bf16 v[112:127], a[88:91], a[24:27], v[112:127]
    ds_read_b64_tr_b16 a[150:151], v25 offset:4352
    v_exp_f32 v102, v102
    ds_read_b64_tr_b16 a[152:153], v26 offset:256
    ds_read_b64_tr_b16 a[154:155], v26 offset:4352
    v_exp_f32 v103, v103
    s_waitcnt lgkmcnt(15)
    v_mfma_f32_32x32x16_bf16 v[112:127], a[92:95], a[28:31], v[112:127]
    ds_read_b64_tr_b16 a[156:157], v27 offset:256
    ds_read_b64_tr_b16 a[158:159], v27 offset:4352
    v_exp_f32 v104, v104
    ds_read_b64_tr_b16 a[160:161], v24 offset:8192
    ds_read_b64_tr_b16 a[162:163], v24 offset:12288
    v_exp_f32 v105, v105
    s_waitcnt lgkmcnt(15)
    v_mfma_f32_32x32x16_bf16 v[112:127], a[96:99], a[32:35], v[112:127]
    ds_read_b64_tr_b16 a[164:165], v25 offset:8192
    ds_read_b64_tr_b16 a[166:167], v25 offset:12288
    v_exp_f32 v106, v106
    ds_read_b64_tr_b16 a[168:169], v26 offset:8192
    ds_read_b64_tr_b16 a[170:171], v26 offset:12288
    s_waitcnt lgkmcnt(15)
    v_mfma_f32_32x32x16_bf16 v[112:127], a[100:103], a[36:39], v[112:127]
    v_exp_f32 v107, v107
    ds_read_b64_tr_b16 a[172:173], v27 offset:8192
    ds_read_b64_tr_b16 a[174:175], v27 offset:12288
    v_exp_f32 v108, v108
    ds_read_b64_tr_b16 a[176:177], v24 offset:8448
    ds_read_b64_tr_b16 a[178:179], v24 offset:12544
    s_waitcnt lgkmcnt(15)
    v_mfma_f32_32x32x16_bf16 v[112:127], a[104:107], a[40:43], v[112:127]
    v_exp_f32 v109, v109
    ds_read_b64_tr_b16 a[180:181], v25 offset:8448
    ds_read_b64_tr_b16 a[182:183], v25 offset:12544
    v_exp_f32 v110, v110
    ds_read_b64_tr_b16 a[184:185], v26 offset:8448
    s_waitcnt lgkmcnt(15)
    v_mfma_f32_32x32x16_bf16 v[112:127], a[108:111], a[44:47], v[112:127]
    ds_read_b64_tr_b16 a[186:187], v26 offset:12544
    v_exp_f32 v111, v111
    ds_read_b64_tr_b16 a[188:189], v27 offset:8448
    ds_read_b64_tr_b16 a[190:191], v27 offset:12544
    v_add_f32 v41, v41, v96
    v_add_f32 v41, v41, v97
    s_waitcnt lgkmcnt(15)
    v_mfma_f32_32x32x16_bf16 v[112:127], a[112:115], a[48:51], v[112:127]
    v_add_f32 v41, v41, v98
    v_add_f32 v41, v41, v99
    v_add_f32 v41, v41, v100
    v_add_f32 v41, v41, v101
    v_add_f32 v41, v41, v102
    s_waitcnt lgkmcnt(15)
    v_mfma_f32_32x32x16_bf16 v[112:127], a[116:119], a[52:55], v[112:127]
    v_add_f32 v41, v41, v103
    v_add_f32 v41, v41, v104
    v_add_f32 v41, v41, v105
    v_add_f32 v41, v41, v106
    v_add_f32 v41, v41, v107
    v_add_f32 v41, v41, v108
    s_waitcnt lgkmcnt(15)
    v_mfma_f32_32x32x16_bf16 v[112:127], a[120:123], a[56:59], v[112:127]
    v_add_f32 v41, v41, v109
    v_add_f32 v41, v41, v110
    v_add_f32 v41, v41, v111
    v_cvt_pk_bf16_f32 v48, v96, v97
    v_cvt_pk_bf16_f32 v49, v98, v99
    s_waitcnt lgkmcnt(15)
    v_mfma_f32_32x32x16_bf16 v[112:127], a[124:127], a[60:63], v[112:127]
    v_cvt_pk_bf16_f32 v50, v100, v101
    v_cvt_pk_bf16_f32 v51, v102, v103
    v_cvt_pk_bf16_f32 v52, v104, v105
    v_cvt_pk_bf16_f32 v53, v106, v107
    v_cvt_pk_bf16_f32 v54, v108, v109
    v_cvt_pk_bf16_f32 v55, v110, v111
    s_waitcnt vmcnt(12)
    s_barrier
    s_waitcnt lgkmcnt(0)
    v_mfma_f32_32x32x16_bf16 v[128:143], a[128:131], v[48:51], v[128:143]
    s_add_u32 m0, s56, 16384
    s_add_u32 s58, s57, 81920
    buffer_load_dwordx4 v28, s[24:27], s58 offen lds
    s_add_u32 m0, s56, 17408
    s_add_u32 s58, s57, 81920
    buffer_load_dwordx4 v29, s[24:27], s58 offen lds
    v_mfma_f32_32x32x16_bf16 v[144:159], a[132:135], v[48:51], v[144:159]
    s_add_u32 m0, s56, 18432
    s_add_u32 s58, s57, 81920
    buffer_load_dwordx4 v30, s[24:27], s58 offen lds
    s_add_u32 m0, s56, 19456
    s_add_u32 s58, s57, 81920
    buffer_load_dwordx4 v31, s[24:27], s58 offen lds
    v_mfma_f32_32x32x16_bf16 v[160:175], a[136:139], v[48:51], v[160:175]
    ds_read_b128 a[64:67], v16 offset:32768
    ds_read_b128 a[68:71], v17 offset:32768
    ds_read_b128 a[72:75], v18 offset:32768
    v_mfma_f32_32x32x16_bf16 v[176:191], a[140:143], v[48:51], v[176:191]
    ds_read_b128 a[76:79], v19 offset:32768
    ds_read_b128 a[80:83], v20 offset:32768
    v_mfma_f32_32x32x16_bf16 v[192:207], a[144:147], v[48:51], v[192:207]
    ds_read_b128 a[84:87], v21 offset:32768
    ds_read_b128 a[88:91], v22 offset:32768
    ds_read_b128 a[92:95], v23 offset:32768
    v_mfma_f32_32x32x16_bf16 v[208:223], a[148:151], v[48:51], v[208:223]
    ds_read_b128 a[96:99], v16 offset:33024
    ds_read_b128 a[100:103], v17 offset:33024
    v_mfma_f32_32x32x16_bf16 v[224:239], a[152:155], v[48:51], v[224:239]
    ds_read_b128 a[104:107], v18 offset:33024
    ds_read_b128 a[108:111], v19 offset:33024
    ds_read_b128 a[112:115], v20 offset:33024
    v_mfma_f32_32x32x16_bf16 v[240:255], a[156:159], v[48:51], v[240:255]
    ds_read_b128 a[116:119], v21 offset:33024
    ds_read_b128 a[120:123], v22 offset:33024
    v_mfma_f32_32x32x16_bf16 v[128:143], a[160:163], v[52:55], v[128:143]
    ds_read_b128 a[124:127], v23 offset:33024
    s_add_u32 m0, s56, 65536
    s_add_u32 s58, s59, 65536
    buffer_load_dwordx4 v36, s[28:31], s58 offen lds
    v_mfma_f32_32x32x16_bf16 v[144:159], a[164:167], v[52:55], v[144:159]
    s_add_u32 m0, s56, 66560
    s_add_u32 s58, s59, 66560
    buffer_load_dwordx4 v37, s[28:31], s58 offen lds
    s_add_u32 m0, s56, 67584
    s_add_u32 s58, s59, 67584
    buffer_load_dwordx4 v36, s[28:31], s58 offen lds
    s_add_u32 m0, s56, 68608
    s_add_u32 s58, s59, 68608
    buffer_load_dwordx4 v37, s[28:31], s58 offen lds
    v_mfma_f32_32x32x16_bf16 v[160:175], a[168:171], v[52:55], v[160:175]
    v_max3_f32 v42, v112, v113, v114
    v_max3_f32 v42, v42, v115, v116
    v_mfma_f32_32x32x16_bf16 v[176:191], a[172:175], v[52:55], v[176:191]
    v_max3_f32 v42, v42, v117, v118
    v_max3_f32 v42, v42, v119, v120
    v_max3_f32 v42, v42, v121, v122
    v_mfma_f32_32x32x16_bf16 v[192:207], a[176:179], v[52:55], v[192:207]
    v_max3_f32 v42, v42, v123, v124
    v_max3_f32 v42, v42, v125, v126
    v_mfma_f32_32x32x16_bf16 v[208:223], a[180:183], v[52:55], v[208:223]
    v_max_f32 v42, v42, v127
    v_mov_b32 v43, v42
    s_nop 1
    v_mfma_f32_32x32x16_bf16 v[224:239], a[184:187], v[52:55], v[224:239]
    v_permlane32_swap_b32 v42, v43
    v_max_f32 v42, v42, v43
    v_mfma_f32_32x32x16_bf16 v[240:255], a[188:191], v[52:55], v[240:255]
    v_mul_f32 v42, s55, v42
    v_sub_f32 v43, v42, v40
    v_cmp_gt_f32 vcc, v43, v39
    s_nop 4
    s_cbranch_vccz LA_nr1
    s_nop 15
    v_max_f32 v42, v40, v42
    v_sub_f32 v43, v40, v42
    v_exp_f32 v43, v43
    v_mov_b32 v40, v42
    s_nop 0
    v_mul_f32 v41, v41, v43
    v_mul_f32 v128, v128, v43
    v_mul_f32 v129, v129, v43
    v_mul_f32 v130, v130, v43
    v_mul_f32 v131, v131, v43
    v_mul_f32 v132, v132, v43
    v_mul_f32 v133, v133, v43
    v_mul_f32 v134, v134, v43
    v_mul_f32 v135, v135, v43
    v_mul_f32 v136, v136, v43
    v_mul_f32 v137, v137, v43
    v_mul_f32 v138, v138, v43
    v_mul_f32 v139, v139, v43
    v_mul_f32 v140, v140, v43
    v_mul_f32 v141, v141, v43
    v_mul_f32 v142, v142, v43
    v_mul_f32 v143, v143, v43
    v_mul_f32 v144, v144, v43
    v_mul_f32 v145, v145, v43
    v_mul_f32 v146, v146, v43
    v_mul_f32 v147, v147, v43
    v_mul_f32 v148, v148, v43
    v_mul_f32 v149, v149, v43
    v_mul_f32 v150, v150, v43
    v_mul_f32 v151, v151, v43
    v_mul_f32 v152, v152, v43
    v_mul_f32 v153, v153, v43
    v_mul_f32 v154, v154, v43
    v_mul_f32 v155, v155, v43
    v_mul_f32 v156, v156, v43
    v_mul_f32 v157, v157, v43
    v_mul_f32 v158, v158, v43
    v_mul_f32 v159, v159, v43
    v_mul_f32 v160, v160, v43
    v_mul_f32 v161, v161, v43
    v_mul_f32 v162, v162, v43
    v_mul_f32 v163, v163, v43
    v_mul_f32 v164, v164, v43
    v_mul_f32 v165, v165, v43
    v_mul_f32 v166, v166, v43
    v_mul_f32 v167, v167, v43
    v_mul_f32 v168, v168, v43
    v_mul_f32 v169, v169, v43
    v_mul_f32 v170, v170, v43
    v_mul_f32 v171, v171, v43
    v_mul_f32 v172, v172, v43
    v_mul_f32 v173, v173, v43
    v_mul_f32 v174, v174, v43
    v_mul_f32 v175, v175, v43
    v_mul_f32 v176, v176, v43
    v_mul_f32 v177, v177, v43
    v_mul_f32 v178, v178, v43
    v_mul_f32 v179, v179, v43
    v_mul_f32 v180, v180, v43
    v_mul_f32 v181, v181, v43
    v_mul_f32 v182, v182, v43
    v_mul_f32 v183, v183, v43
    v_mul_f32 v184, v184, v43
    v_mul_f32 v185, v185, v43
    v_mul_f32 v186, v186, v43
    v_mul_f32 v187, v187, v43
    v_mul_f32 v188, v188, v43
    v_mul_f32 v189, v189, v43
    v_mul_f32 v190, v190, v43
    v_mul_f32 v191, v191, v43
    v_mul_f32 v192, v192, v43
    v_mul_f32 v193, v193, v43
    v_mul_f32 v194, v194, v43
    v_mul_f32 v195, v195, v43
    v_mul_f32 v196, v196, v43
    v_mul_f32 v197, v197, v43
    v_mul_f32 v198, v198, v43
    v_mul_f32 v199, v199, v43
    v_mul_f32 v200, v200, v43
    v_mul_f32 v201, v201, v43
    v_mul_f32 v202, v202, v43
    v_mul_f32 v203, v203, v43
    v_mul_f32 v204, v204, v43
    v_mul_f32 v205, v205, v43
    v_mul_f32 v206, v206, v43
    v_mul_f32 v207, v207, v43
    v_mul_f32 v208, v208, v43
    v_mul_f32 v209, v209, v43
    v_mul_f32 v210, v210, v43
    v_mul_f32 v211, v211, v43
    v_mul_f32 v212, v212, v43
    v_mul_f32 v213, v213, v43
    v_mul_f32 v214, v214, v43
    v_mul_f32 v215, v215, v43
    v_mul_f32 v216, v216, v43
    v_mul_f32 v217, v217, v43
    v_mul_f32 v218, v218, v43
    v_mul_f32 v219, v219, v43
    v_mul_f32 v220, v220, v43
    v_mul_f32 v221, v221, v43
    v_mul_f32 v222, v222, v43
    v_mul_f32 v223, v223, v43
    v_mul_f32 v224, v224, v43
    v_mul_f32 v225, v225, v43
    v_mul_f32 v226, v226, v43
    v_mul_f32 v227, v227, v43
    v_mul_f32 v228, v228, v43
    v_mul_f32 v229, v229, v43
    v_mul_f32 v230, v230, v43
    v_mul_f32 v231, v231, v43
    v_mul_f32 v232, v232, v43
    v_mul_f32 v233, v233, v43
    v_mul_f32 v234, v234, v43
    v_mul_f32 v235, v235, v43
    v_mul_f32 v236, v236, v43
    v_mul_f32 v237, v237, v43
    v_mul_f32 v238, v238, v43
    v_mul_f32 v239, v239, v43
    v_mul_f32 v240, v240, v43
    v_mul_f32 v241, v241, v43
    v_mul_f32 v242, v242, v43
    v_mul_f32 v243, v243, v43
    v_mul_f32 v244, v244, v43
    v_mul_f32 v245, v245, v43
    v_mul_f32 v246, v246, v43
    v_mul_f32 v247, v247, v43
    v_mul_f32 v248, v248, v43
    v_mul_f32 v249, v249, v43
    v_mul_f32 v250, v250, v43
    v_mul_f32 v251, v251, v43
    v_mul_f32 v252, v252, v43
    v_mul_f32 v253, v253, v43
    v_mul_f32 v254, v254, v43
    v_mul_f32 v255, v255, v43
LA_nr1:
    s_waitcnt lgkmcnt(15)
    v_mfma_f32_32x32x16_bf16 v[96:111], a[64:67], a[0:3], 0
    v_fma_f32 v112, v112, s55, -v40
    v_fma_f32 v113, v113, s55, -v40
    v_fma_f32 v114, v114, s55, -v40
    v_fma_f32 v115, v115, s55, -v40
    v_fma_f32 v116, v116, s55, -v40
    s_waitcnt lgkmcnt(14)
    v_mfma_f32_32x32x16_bf16 v[96:111], a[68:71], a[4:7], v[96:111]
    v_fma_f32 v117, v117, s55, -v40
    v_fma_f32 v118, v118, s55, -v40
    v_fma_f32 v119, v119, s55, -v40
    v_fma_f32 v120, v120, s55, -v40
    v_fma_f32 v121, v121, s55, -v40
    v_fma_f32 v122, v122, s55, -v40
    s_waitcnt lgkmcnt(13)
    v_mfma_f32_32x32x16_bf16 v[96:111], a[72:75], a[8:11], v[96:111]
    v_fma_f32 v123, v123, s55, -v40
    v_fma_f32 v124, v124, s55, -v40
    v_fma_f32 v125, v125, s55, -v40
    v_fma_f32 v126, v126, s55, -v40
    v_fma_f32 v127, v127, s55, -v40
    s_waitcnt lgkmcnt(12)
    v_mfma_f32_32x32x16_bf16 v[96:111], a[76:79], a[12:15], v[96:111]
    v_exp_f32 v112, v112
    ds_read_b64_tr_b16 a[128:129], v24 offset:16384
    ds_read_b64_tr_b16 a[130:131], v24 offset:20480
    v_exp_f32 v113, v113
    ds_read_b64_tr_b16 a[132:133], v25 offset:16384
    ds_read_b64_tr_b16 a[134:135], v25 offset:20480
    s_waitcnt lgkmcnt(15)
    v_mfma_f32_32x32x16_bf16 v[96:111], a[80:83], a[16:19], v[96:111]
    v_exp_f32 v114, v114
    ds_read_b64_tr_b16 a[136:137], v26 offset:16384
    ds_read_b64_tr_b16 a[138:139], v26 offset:20480
    v_exp_f32 v115, v115
    ds_read_b64_tr_b16 a[140:141], v27 offset:16384
    s_waitcnt lgkmcnt(15)
    v_mfma_f32_32x32x16_bf16 v[96:111], a[84:87], a[20:23], v[96:111]
    ds_read_b64_tr_b16 a[142:143], v27 offset:20480
    v_exp_f32 v116, v116
    ds_read_b64_tr_b16 a[144:145], v24 offset:16640
    ds_read_b64_tr_b16 a[146:147], v24 offset:20736
    v_exp_f32 v117, v117
    ds_read_b64_tr_b16 a[148:149], v25 offset:16640
    s_waitcnt lgkmcnt(15)
    v_mfma_f32_32x32x16_bf16 v[96:111], a[88:91], a[24:27], v[96:111]
    ds_read_b64_tr_b16 a[150:151], v25 offset:20736
    v_exp_f32 v118, v118
    ds_read_b64_tr_b16 a[152:153], v26 offset:16640
    ds_read_b64_tr_b16 a[154:155], v26 offset:20736
    v_exp_f32 v119, v119
    s_waitcnt lgkmcnt(15)
    v_mfma_f32_32x32x16_bf16 v[96:111], a[92:95], a[28:31], v[96:111]
    ds_read_b64_tr_b16 a[156:157], v27 offset:16640
    ds_read_b64_tr_b16 a[158:159], v27 offset:20736
    v_exp_f32 v120, v120
    ds_read_b64_tr_b16 a[160:161], v24 offset:24576
    ds_read_b64_tr_b16 a[162:163], v24 offset:28672
    v_exp_f32 v121, v121
    s_waitcnt lgkmcnt(15)
    v_mfma_f32_32x32x16_bf16 v[96:111], a[96:99], a[32:35], v[96:111]
    ds_read_b64_tr_b16 a[164:165], v25 offset:24576
    ds_read_b64_tr_b16 a[166:167], v25 offset:28672
    v_exp_f32 v122, v122
    ds_read_b64_tr_b16 a[168:169], v26 offset:24576
    ds_read_b64_tr_b16 a[170:171], v26 offset:28672
    s_waitcnt lgkmcnt(15)
    v_mfma_f32_32x32x16_bf16 v[96:111], a[100:103], a[36:39], v[96:111]
    v_exp_f32 v123, v123
    ds_read_b64_tr_b16 a[172:173], v27 offset:24576
    ds_read_b64_tr_b16 a[174:175], v27 offset:28672
    v_exp_f32 v124, v124
    ds_read_b64_tr_b16 a[176:177], v24 offset:24832
    ds_read_b64_tr_b16 a[178:179], v24 offset:28928
    s_waitcnt lgkmcnt(15)
    v_mfma_f32_32x32x16_bf16 v[96:111], a[104:107], a[40:43], v[96:111]
    v_exp_f32 v125, v125
    ds_read_b64_tr_b16 a[180:181], v25 offset:24832
    ds_read_b64_tr_b16 a[182:183], v25 offset:28928
    v_exp_f32 v126, v126
    ds_read_b64_tr_b16 a[184:185], v26 offset:24832
    s_waitcnt lgkmcnt(15)
    v_mfma_f32_32x32x16_bf16 v[96:111], a[108:111], a[44:47], v[96:111]
    ds_read_b64_tr_b16 a[186:187], v26 offset:28928
    v_exp_f32 v127, v127
    ds_read_b64_tr_b16 a[188:189], v27 offset:24832
    ds_read_b64_tr_b16 a[190:191], v27 offset:28928
    v_add_f32 v41, v41, v112
    v_add_f32 v41, v41, v113
    s_waitcnt lgkmcnt(15)
    v_mfma_f32_32x32x16_bf16 v[96:111], a[112:115], a[48:51], v[96:111]
    v_add_f32 v41, v41, v114
    v_add_f32 v41, v41, v115
    v_add_f32 v41, v41, v116
    v_add_f32 v41, v41, v117
    v_add_f32 v41, v41, v118
    s_waitcnt lgkmcnt(15)
    v_mfma_f32_32x32x16_bf16 v[96:111], a[116:119], a[52:55], v[96:111]
    v_add_f32 v41, v41, v119
    v_add_f32 v41, v41, v120
    v_add_f32 v41, v41, v121
    v_add_f32 v41, v41, v122
    v_add_f32 v41, v41, v123
    v_add_f32 v41, v41, v124
    s_waitcnt lgkmcnt(15)
    v_mfma_f32_32x32x16_bf16 v[96:111], a[120:123], a[56:59], v[96:111]
    v_add_f32 v41, v41, v125
    v_add_f32 v41, v41, v126
    v_add_f32 v41, v41, v127
    v_cvt_pk_bf16_f32 v48, v112, v113
    v_cvt_pk_bf16_f32 v49, v114, v115
    s_waitcnt lgkmcnt(15)
    v_mfma_f32_32x32x16_bf16 v[96:111], a[124:127], a[60:63], v[96:111]
    v_cvt_pk_bf16_f32 v50, v116, v117
    v_cvt_pk_bf16_f32 v51, v118, v119
    v_cvt_pk_bf16_f32 v52, v120, v121
    v_cvt_pk_bf16_f32 v53, v122, v123
    v_cvt_pk_bf16_f32 v54, v124, v125
    v_cvt_pk_bf16_f32 v55, v126, v127
    s_waitcnt vmcnt(16)
    s_barrier
    s_waitcnt lgkmcnt(0)
    v_mfma_f32_32x32x16_bf16 v[128:143], a[128:131], v[48:51], v[128:143]
    s_add_u32 m0, s56, 32768
    s_add_u32 s58, s57, 98304
    buffer_load_dwordx4 v28, s[24:27], s58 offen lds
    s_add_u32 m0, s56, 33792
    s_add_u32 s58, s57, 98304
    buffer_load_dwordx4 v29, s[24:27], s58 offen lds
    v_mfma_f32_32x32x16_bf16 v[144:159], a[132:135], v[48:51], v[144:159]
    s_add_u32 m0, s56, 34816
    s_add_u32 s58, s57, 98304
    buffer_load_dwordx4 v30, s[24:27], s58 offen lds
    s_add_u32 m0, s56, 35840
    s_add_u32 s58, s57, 98304
    buffer_load_dwordx4 v31, s[24:27], s58 offen lds
    v_mfma_f32_32x32x16_bf16 v[160:175], a[136:139], v[48:51], v[160:175]
    ds_read_b128 a[64:67], v16 offset:49152
    ds_read_b128 a[68:71], v17 offset:49152
    ds_read_b128 a[72:75], v18 offset:49152
    v_mfma_f32_32x32x16_bf16 v[176:191], a[140:143], v[48:51], v[176:191]
    ds_read_b128 a[76:79], v19 offset:49152
    ds_read_b128 a[80:83], v20 offset:49152
    v_mfma_f32_32x32x16_bf16 v[192:207], a[144:147], v[48:51], v[192:207]
    ds_read_b128 a[84:87], v21 offset:49152
    ds_read_b128 a[88:91], v22 offset:49152
    ds_read_b128 a[92:95], v23 offset:49152
    v_mfma_f32_32x32x16_bf16 v[208:223], a[148:151], v[48:51], v[208:223]
    ds_read_b128 a[96:99], v16 offset:49408
    ds_read_b128 a[100:103], v17 offset:49408
    v_mfma_f32_32x32x16_bf16 v[224:239], a[152:155], v[48:51], v[224:239]
    ds_read_b128 a[104:107], v18 offset:49408
    ds_read_b128 a[108:111], v19 offset:49408
    ds_read_b128 a[112:115], v20 offset:49408
    v_mfma_f32_32x32x16_bf16 v[240:255], a[156:159], v[48:51], v[240:255]
    ds_read_b128 a[116:119], v21 offset:49408
    ds_read_b128 a[120:123], v22 offset:49408
    v_mfma_f32_32x32x16_bf16 v[128:143], a[160:163], v[52:55], v[128:143]
    ds_read_b128 a[124:127], v23 offset:49408
    s_add_u32 m0, s56, 81920
    s_add_u32 s58, s59, 81920
    buffer_load_dwordx4 v36, s[28:31], s58 offen lds
    v_mfma_f32_32x32x16_bf16 v[144:159], a[164:167], v[52:55], v[144:159]
    s_add_u32 m0, s56, 82944
    s_add_u32 s58, s59, 82944
    buffer_load_dwordx4 v37, s[28:31], s58 offen lds
    s_add_u32 m0, s56, 83968
    s_add_u32 s58, s59, 83968
    buffer_load_dwordx4 v36, s[28:31], s58 offen lds
    s_add_u32 m0, s56, 84992
    s_add_u32 s58, s59, 84992
    buffer_load_dwordx4 v37, s[28:31], s58 offen lds
    v_mfma_f32_32x32x16_bf16 v[160:175], a[168:171], v[52:55], v[160:175]
    v_max3_f32 v42, v96, v97, v98
    v_max3_f32 v42, v42, v99, v100
    v_mfma_f32_32x32x16_bf16 v[176:191], a[172:175], v[52:55], v[176:191]
    v_max3_f32 v42, v42, v101, v102
    v_max3_f32 v42, v42, v103, v104
    v_max3_f32 v42, v42, v105, v106
    v_mfma_f32_32x32x16_bf16 v[192:207], a[176:179], v[52:55], v[192:207]
    v_max3_f32 v42, v42, v107, v108
    v_max3_f32 v42, v42, v109, v110
    v_mfma_f32_32x32x16_bf16 v[208:223], a[180:183], v[52:55], v[208:223]
    v_max_f32 v42, v42, v111
    v_mov_b32 v43, v42
    s_nop 1
    v_mfma_f32_32x32x16_bf16 v[224:239], a[184:187], v[52:55], v[224:239]
    v_permlane32_swap_b32 v42, v43
    v_max_f32 v42, v42, v43
    v_mfma_f32_32x32x16_bf16 v[240:255], a[188:191], v[52:55], v[240:255]
    v_mul_f32 v42, s55, v42
    v_sub_f32 v43, v42, v40
    v_cmp_gt_f32 vcc, v43, v39
    s_nop 4
    s_cbranch_vccz LA_nr2
    s_nop 15
    v_max_f32 v42, v40, v42
    v_sub_f32 v43, v40, v42
    v_exp_f32 v43, v43
    v_mov_b32 v40, v42
    s_nop 0
    v_mul_f32 v41, v41, v43
    v_mul_f32 v128, v128, v43
    v_mul_f32 v129, v129, v43
    v_mul_f32 v130, v130, v43
    v_mul_f32 v131, v131, v43
    v_mul_f32 v132, v132, v43
    v_mul_f32 v133, v133, v43
    v_mul_f32 v134, v134, v43
    v_mul_f32 v135, v135, v43
    v_mul_f32 v136, v136, v43
    v_mul_f32 v137, v137, v43
    v_mul_f32 v138, v138, v43
    v_mul_f32 v139, v139, v43
    v_mul_f32 v140, v140, v43
    v_mul_f32 v141, v141, v43
    v_mul_f32 v142, v142, v43
    v_mul_f32 v143, v143, v43
    v_mul_f32 v144, v144, v43
    v_mul_f32 v145, v145, v43
    v_mul_f32 v146, v146, v43
    v_mul_f32 v147, v147, v43
    v_mul_f32 v148, v148, v43
    v_mul_f32 v149, v149, v43
    v_mul_f32 v150, v150, v43
    v_mul_f32 v151, v151, v43
    v_mul_f32 v152, v152, v43
    v_mul_f32 v153, v153, v43
    v_mul_f32 v154, v154, v43
    v_mul_f32 v155, v155, v43
    v_mul_f32 v156, v156, v43
    v_mul_f32 v157, v157, v43
    v_mul_f32 v158, v158, v43
    v_mul_f32 v159, v159, v43
    v_mul_f32 v160, v160, v43
    v_mul_f32 v161, v161, v43
    v_mul_f32 v162, v162, v43
    v_mul_f32 v163, v163, v43
    v_mul_f32 v164, v164, v43
    v_mul_f32 v165, v165, v43
    v_mul_f32 v166, v166, v43
    v_mul_f32 v167, v167, v43
    v_mul_f32 v168, v168, v43
    v_mul_f32 v169, v169, v43
    v_mul_f32 v170, v170, v43
    v_mul_f32 v171, v171, v43
    v_mul_f32 v172, v172, v43
    v_mul_f32 v173, v173, v43
    v_mul_f32 v174, v174, v43
    v_mul_f32 v175, v175, v43
    v_mul_f32 v176, v176, v43
    v_mul_f32 v177, v177, v43
    v_mul_f32 v178, v178, v43
    v_mul_f32 v179, v179, v43
    v_mul_f32 v180, v180, v43
    v_mul_f32 v181, v181, v43
    v_mul_f32 v182, v182, v43
    v_mul_f32 v183, v183, v43
    v_mul_f32 v184, v184, v43
    v_mul_f32 v185, v185, v43
    v_mul_f32 v186, v186, v43
    v_mul_f32 v187, v187, v43
    v_mul_f32 v188, v188, v43
    v_mul_f32 v189, v189, v43
    v_mul_f32 v190, v190, v43
    v_mul_f32 v191, v191, v43
    v_mul_f32 v192, v192, v43
    v_mul_f32 v193, v193, v43
    v_mul_f32 v194, v194, v43
    v_mul_f32 v195, v195, v43
    v_mul_f32 v196, v196, v43
    v_mul_f32 v197, v197, v43
    v_mul_f32 v198, v198, v43
    v_mul_f32 v199, v199, v43
    v_mul_f32 v200, v200, v43
    v_mul_f32 v201, v201, v43
    v_mul_f32 v202, v202, v43
    v_mul_f32 v203, v203, v43
    v_mul_f32 v204, v204, v43
    v_mul_f32 v205, v205, v43
    v_mul_f32 v206, v206, v43
    v_mul_f32 v207, v207, v43
    v_mul_f32 v208, v208, v43
    v_mul_f32 v209, v209, v43
    v_mul_f32 v210, v210, v43
    v_mul_f32 v211, v211, v43
    v_mul_f32 v212, v212, v43
    v_mul_f32 v213, v213, v43
    v_mul_f32 v214, v214, v43
    v_mul_f32 v215, v215, v43
    v_mul_f32 v216, v216, v43
    v_mul_f32 v217, v217, v43
    v_mul_f32 v218, v218, v43
    v_mul_f32 v219, v219, v43
    v_mul_f32 v220, v220, v43
    v_mul_f32 v221, v221, v43
    v_mul_f32 v222, v222, v43
    v_mul_f32 v223, v223, v43
    v_mul_f32 v224, v224, v43
    v_mul_f32 v225, v225, v43
    v_mul_f32 v226, v226, v43
    v_mul_f32 v227, v227, v43
    v_mul_f32 v228, v228, v43
    v_mul_f32 v229, v229, v43
    v_mul_f32 v230, v230, v43
    v_mul_f32 v231, v231, v43
    v_mul_f32 v232, v232, v43
    v_mul_f32 v233, v233, v43
    v_mul_f32 v234, v234, v43
    v_mul_f32 v235, v235, v43
    v_mul_f32 v236, v236, v43
    v_mul_f32 v237, v237, v43
    v_mul_f32 v238, v238, v43
    v_mul_f32 v239, v239, v43
    v_mul_f32 v240, v240, v43
    v_mul_f32 v241, v241, v43
    v_mul_f32 v242, v242, v43
    v_mul_f32 v243, v243, v43
    v_mul_f32 v244, v244, v43
    v_mul_f32 v245, v245, v43
    v_mul_f32 v246, v246, v43
    v_mul_f32 v247, v247, v43
    v_mul_f32 v248, v248, v43
    v_mul_f32 v249, v249, v43
    v_mul_f32 v250, v250, v43
    v_mul_f32 v251, v251, v43
    v_mul_f32 v252, v252, v43
    v_mul_f32 v253, v253, v43
    v_mul_f32 v254, v254, v43
    v_mul_f32 v255, v255, v43
LA_nr2:
    s_waitcnt lgkmcnt(15)
    v_mfma_f32_32x32x16_bf16 v[112:127], a[64:67], a[0:3], 0
    v_fma_f32 v96, v96, s55, -v40
    v_fma_f32 v97, v97, s55, -v40
    v_fma_f32 v98, v98, s55, -v40
    v_fma_f32 v99, v99, s55, -v40
    v_fma_f32 v100, v100, s55, -v40
    s_waitcnt lgkmcnt(14)
    v_mfma_f32_32x32x16_bf16 v[112:127], a[68:71], a[4:7], v[112:127]
    v_fma_f32 v101, v101, s55, -v40
    v_fma_f32 v102, v102, s55, -v40
    v_fma_f32 v103, v103, s55, -v40
    v_fma_f32 v104, v104, s55, -v40
    v_fma_f32 v105, v105, s55, -v40
    v_fma_f32 v106, v106, s55, -v40
    s_waitcnt lgkmcnt(13)
    v_mfma_f32_32x32x16_bf16 v[112:127], a[72:75], a[8:11], v[112:127]
    v_fma_f32 v107, v107, s55, -v40
    v_fma_f32 v108, v108, s55, -v40
    v_fma_f32 v109, v109, s55, -v40
    v_fma_f32 v110, v110, s55, -v40
    v_fma_f32 v111, v111, s55, -v40
    s_waitcnt lgkmcnt(12)
    v_mfma_f32_32x32x16_bf16 v[112:127], a[76:79], a[12:15], v[112:127]
    v_exp_f32 v96, v96
    ds_read_b64_tr_b16 a[128:129], v24 offset:32768
    ds_read_b64_tr_b16 a[130:131], v24 offset:36864
    v_exp_f32 v97, v97
    ds_read_b64_tr_b16 a[132:133], v25 offset:32768
    ds_read_b64_tr_b16 a[134:135], v25 offset:36864
    s_waitcnt lgkmcnt(15)
    v_mfma_f32_32x32x16_bf16 v[112:127], a[80:83], a[16:19], v[112:127]
    v_exp_f32 v98, v98
    ds_read_b64_tr_b16 a[136:137], v26 offset:32768
    ds_read_b64_tr_b16 a[138:139], v26 offset:36864
    v_exp_f32 v99, v99
    ds_read_b64_tr_b16 a[140:141], v27 offset:32768
    s_waitcnt lgkmcnt(15)
    v_mfma_f32_32x32x16_bf16 v[112:127], a[84:87], a[20:23], v[112:127]
    ds_read_b64_tr_b16 a[142:143], v27 offset:36864
    v_exp_f32 v100, v100
    ds_read_b64_tr_b16 a[144:145], v24 offset:33024
    ds_read_b64_tr_b16 a[146:147], v24 offset:37120
    v_exp_f32 v101, v101
    ds_read_b64_tr_b16 a[148:149], v25 offset:33024
    s_waitcnt lgkmcnt(15)
    v_mfma_f32_32x32x16_bf16 v[112:127], a[88:91], a[24:27], v[112:127]
    ds_read_b64_tr_b16 a[150:151], v25 offset:37120
    v_exp_f32 v102, v102
    ds_read_b64_tr_b16 a[152:153], v26 offset:33024
    ds_read_b64_tr_b16 a[154:155], v26 offset:37120
    v_exp_f32 v103, v103
    s_waitcnt lgkmcnt(15)
    v_mfma_f32_32x32x16_bf16 v[112:127], a[92:95], a[28:31], v[112:127]
    ds_read_b64_tr_b16 a[156:157], v27 offset:33024
    ds_read_b64_tr_b16 a[158:159], v27 offset:37120
    v_exp_f32 v104, v104
    ds_read_b64_tr_b16 a[160:161], v24 offset:40960
    ds_read_b64_tr_b16 a[162:163], v24 offset:45056
    v_exp_f32 v105, v105
    s_waitcnt lgkmcnt(15)
    v_mfma_f32_32x32x16_bf16 v[112:127], a[96:99], a[32:35], v[112:127]
    ds_read_b64_tr_b16 a[164:165], v25 offset:40960
    ds_read_b64_tr_b16 a[166:167], v25 offset:45056
    v_exp_f32 v106, v106
    ds_read_b64_tr_b16 a[168:169], v26 offset:40960
    ds_read_b64_tr_b16 a[170:171], v26 offset:45056
    s_waitcnt lgkmcnt(15)
    v_mfma_f32_32x32x16_bf16 v[112:127], a[100:103], a[36:39], v[112:127]
    v_exp_f32 v107, v107
    ds_read_b64_tr_b16 a[172:173], v27 offset:40960
    ds_read_b64_tr_b16 a[174:175], v27 offset:45056
    v_exp_f32 v108, v108
    ds_read_b64_tr_b16 a[176:177], v24 offset:41216
    ds_read_b64_tr_b16 a[178:179], v24 offset:45312
    s_waitcnt lgkmcnt(15)
    v_mfma_f32_32x32x16_bf16 v[112:127], a[104:107], a[40:43], v[112:127]
    v_exp_f32 v109, v109
    ds_read_b64_tr_b16 a[180:181], v25 offset:41216
    ds_read_b64_tr_b16 a[182:183], v25 offset:45312
    v_exp_f32 v110, v110
    ds_read_b64_tr_b16 a[184:185], v26 offset:41216
    s_waitcnt lgkmcnt(15)
    v_mfma_f32_32x32x16_bf16 v[112:127], a[108:111], a[44:47], v[112:127]
    ds_read_b64_tr_b16 a[186:187], v26 offset:45312
    v_exp_f32 v111, v111
    ds_read_b64_tr_b16 a[188:189], v27 offset:41216
    ds_read_b64_tr_b16 a[190:191], v27 offset:45312
    v_add_f32 v41, v41, v96
    v_add_f32 v41, v41, v97
    s_waitcnt lgkmcnt(15)
    v_mfma_f32_32x32x16_bf16 v[112:127], a[112:115], a[48:51], v[112:127]
    v_add_f32 v41, v41, v98
    v_add_f32 v41, v41, v99
    v_add_f32 v41, v41, v100
    v_add_f32 v41, v41, v101
    v_add_f32 v41, v41, v102
    s_waitcnt lgkmcnt(15)
    v_mfma_f32_32x32x16_bf16 v[112:127], a[116:119], a[52:55], v[112:127]
    v_add_f32 v41, v41, v103
    v_add_f32 v41, v41, v104
    v_add_f32 v41, v41, v105
    v_add_f32 v41, v41, v106
    v_add_f32 v41, v41, v107
    v_add_f32 v41, v41, v108
    s_waitcnt lgkmcnt(15)
    v_mfma_f32_32x32x16_bf16 v[112:127], a[120:123], a[56:59], v[112:127]
    v_add_f32 v41, v41, v109
    v_add_f32 v41, v41, v110
    v_add_f32 v41, v41, v111
    v_cvt_pk_bf16_f32 v48, v96, v97
    v_cvt_pk_bf16_f32 v49, v98, v99
    s_waitcnt lgkmcnt(15)
    v_mfma_f32_32x32x16_bf16 v[112:127], a[124:127], a[60:63], v[112:127]
    v_cvt_pk_bf16_f32 v50, v100, v101
    v_cvt_pk_bf16_f32 v51, v102, v103
    v_cvt_pk_bf16_f32 v52, v104, v105
    v_cvt_pk_bf16_f32 v53, v106, v107
    v_cvt_pk_bf16_f32 v54, v108, v109
    v_cvt_pk_bf16_f32 v55, v110, v111
    s_waitcnt vmcnt(20)
    s_waitcnt vmcnt(16)
    s_barrier
    s_waitcnt lgkmcnt(0)
    v_mfma_f32_32x32x16_bf16 v[128:143], a[128:131], v[48:51], v[128:143]
    s_add_u32 m0, s56, 49152
    s_add_u32 s58, s57, 114688
    buffer_load_dwordx4 v28, s[24:27], s58 offen lds
    s_add_u32 m0, s56, 50176
    s_add_u32 s58, s57, 114688
    buffer_load_dwordx4 v29, s[24:27], s58 offen lds
    v_mfma_f32_32x32x16_bf16 v[144:159], a[132:135], v[48:51], v[144:159]
    s_add_u32 m0, s56, 51200
    s_add_u32 s58, s57, 114688
    buffer_load_dwordx4 v30, s[24:27], s58 offen lds
    s_add_u32 m0, s56, 52224
    s_add_u32 s58, s57, 114688
    buffer_load_dwordx4 v31, s[24:27], s58 offen lds
    v_mfma_f32_32x32x16_bf16 v[160:175], a[136:139], v[48:51], v[160:175]
    ds_read_b128 a[64:67], v16 offset:0
    ds_read_b128 a[68:71], v17 offset:0
    ds_read_b128 a[72:75], v18 offset:0
    v_mfma_f32_32x32x16_bf16 v[176:191], a[140:143], v[48:51], v[176:191]
    ds_read_b128 a[76:79], v19 offset:0
    ds_read_b128 a[80:83], v20 offset:0
    v_mfma_f32_32x32x16_bf16 v[192:207], a[144:147], v[48:51], v[192:207]
    ds_read_b128 a[84:87], v21 offset:0
    ds_read_b128 a[88:91], v22 offset:0
    ds_read_b128 a[92:95], v23 offset:0
    v_mfma_f32_32x32x16_bf16 v[208:223], a[148:151], v[48:51], v[208:223]
    ds_read_b128 a[96:99], v16 offset:256
    ds_read_b128 a[100:103], v17 offset:256
    v_mfma_f32_32x32x16_bf16 v[224:239], a[152:155], v[48:51], v[224:239]
    ds_read_b128 a[104:107], v18 offset:256
    ds_read_b128 a[108:111], v19 offset:256
    ds_read_b128 a[112:115], v20 offset:256
    v_mfma_f32_32x32x16_bf16 v[240:255], a[156:159], v[48:51], v[240:255]
    ds_read_b128 a[116:119], v21 offset:256
    ds_read_b128 a[120:123], v22 offset:256
    v_mfma_f32_32x32x16_bf16 v[128:143], a[160:163], v[52:55], v[128:143]
    ds_read_b128 a[124:127], v23 offset:256
    s_add_u32 m0, s56, 98304
    s_add_u32 s58, s59, 98304
    buffer_load_dwordx4 v36, s[28:31], s58 offen lds
    v_mfma_f32_32x32x16_bf16 v[144:159], a[164:167], v[52:55], v[144:159]
    s_add_u32 m0, s56, 99328
    s_add_u32 s58, s59, 99328
    buffer_load_dwordx4 v37, s[28:31], s58 offen lds
    s_add_u32 m0, s56, 100352
    s_add_u32 s58, s59, 100352
    buffer_load_dwordx4 v36, s[28:31], s58 offen lds
    s_add_u32 m0, s56, 101376
    s_add_u32 s58, s59, 101376
    buffer_load_dwordx4 v37, s[28:31], s58 offen lds
    v_mfma_f32_32x32x16_bf16 v[160:175], a[168:171], v[52:55], v[160:175]
    v_max3_f32 v42, v112, v113, v114
    v_max3_f32 v42, v42, v115, v116
    v_mfma_f32_32x32x16_bf16 v[176:191], a[172:175], v[52:55], v[176:191]
    v_max3_f32 v42, v42, v117, v118
    v_max3_f32 v42, v42, v119, v120
    v_max3_f32 v42, v42, v121, v122
    v_mfma_f32_32x32x16_bf16 v[192:207], a[176:179], v[52:55], v[192:207]
    v_max3_f32 v42, v42, v123, v124
    v_max3_f32 v42, v42, v125, v126
    v_mfma_f32_32x32x16_bf16 v[208:223], a[180:183], v[52:55], v[208:223]
    v_max_f32 v42, v42, v127
    v_mov_b32 v43, v42
    s_nop 1
    v_mfma_f32_32x32x16_bf16 v[224:239], a[184:187], v[52:55], v[224:239]
    v_permlane32_swap_b32 v42, v43
    v_max_f32 v42, v42, v43
    v_mfma_f32_32x32x16_bf16 v[240:255], a[188:191], v[52:55], v[240:255]
    v_mul_f32 v42, s55, v42
    v_sub_f32 v43, v42, v40
    v_cmp_gt_f32 vcc, v43, v39
    s_nop 4
    s_cbranch_vccz LA_nr3
    s_nop 15
    v_max_f32 v42, v40, v42
    v_sub_f32 v43, v40, v42
    v_exp_f32 v43, v43
    v_mov_b32 v40, v42
    s_nop 0
    v_mul_f32 v41, v41, v43
    v_mul_f32 v128, v128, v43
    v_mul_f32 v129, v129, v43
    v_mul_f32 v130, v130, v43
    v_mul_f32 v131, v131, v43
    v_mul_f32 v132, v132, v43
    v_mul_f32 v133, v133, v43
    v_mul_f32 v134, v134, v43
    v_mul_f32 v135, v135, v43
    v_mul_f32 v136, v136, v43
    v_mul_f32 v137, v137, v43
    v_mul_f32 v138, v138, v43
    v_mul_f32 v139, v139, v43
    v_mul_f32 v140, v140, v43
    v_mul_f32 v141, v141, v43
    v_mul_f32 v142, v142, v43
    v_mul_f32 v143, v143, v43
    v_mul_f32 v144, v144, v43
    v_mul_f32 v145, v145, v43
    v_mul_f32 v146, v146, v43
    v_mul_f32 v147, v147, v43
    v_mul_f32 v148, v148, v43
    v_mul_f32 v149, v149, v43
    v_mul_f32 v150, v150, v43
    v_mul_f32 v151, v151, v43
    v_mul_f32 v152, v152, v43
    v_mul_f32 v153, v153, v43
    v_mul_f32 v154, v154, v43
    v_mul_f32 v155, v155, v43
    v_mul_f32 v156, v156, v43
    v_mul_f32 v157, v157, v43
    v_mul_f32 v158, v158, v43
    v_mul_f32 v159, v159, v43
    v_mul_f32 v160, v160, v43
    v_mul_f32 v161, v161, v43
    v_mul_f32 v162, v162, v43
    v_mul_f32 v163, v163, v43
    v_mul_f32 v164, v164, v43
    v_mul_f32 v165, v165, v43
    v_mul_f32 v166, v166, v43
    v_mul_f32 v167, v167, v43
    v_mul_f32 v168, v168, v43
    v_mul_f32 v169, v169, v43
    v_mul_f32 v170, v170, v43
    v_mul_f32 v171, v171, v43
    v_mul_f32 v172, v172, v43
    v_mul_f32 v173, v173, v43
    v_mul_f32 v174, v174, v43
    v_mul_f32 v175, v175, v43
    v_mul_f32 v176, v176, v43
    v_mul_f32 v177, v177, v43
    v_mul_f32 v178, v178, v43
    v_mul_f32 v179, v179, v43
    v_mul_f32 v180, v180, v43
    v_mul_f32 v181, v181, v43
    v_mul_f32 v182, v182, v43
    v_mul_f32 v183, v183, v43
    v_mul_f32 v184, v184, v43
    v_mul_f32 v185, v185, v43
    v_mul_f32 v186, v186, v43
    v_mul_f32 v187, v187, v43
    v_mul_f32 v188, v188, v43
    v_mul_f32 v189, v189, v43
    v_mul_f32 v190, v190, v43
    v_mul_f32 v191, v191, v43
    v_mul_f32 v192, v192, v43
    v_mul_f32 v193, v193, v43
    v_mul_f32 v194, v194, v43
    v_mul_f32 v195, v195, v43
    v_mul_f32 v196, v196, v43
    v_mul_f32 v197, v197, v43
    v_mul_f32 v198, v198, v43
    v_mul_f32 v199, v199, v43
    v_mul_f32 v200, v200, v43
    v_mul_f32 v201, v201, v43
    v_mul_f32 v202, v202, v43
    v_mul_f32 v203, v203, v43
    v_mul_f32 v204, v204, v43
    v_mul_f32 v205, v205, v43
    v_mul_f32 v206, v206, v43
    v_mul_f32 v207, v207, v43
    v_mul_f32 v208, v208, v43
    v_mul_f32 v209, v209, v43
    v_mul_f32 v210, v210, v43
    v_mul_f32 v211, v211, v43
    v_mul_f32 v212, v212, v43
    v_mul_f32 v213, v213, v43
    v_mul_f32 v214, v214, v43
    v_mul_f32 v215, v215, v43
    v_mul_f32 v216, v216, v43
    v_mul_f32 v217, v217, v43
    v_mul_f32 v218, v218, v43
    v_mul_f32 v219, v219, v43
    v_mul_f32 v220, v220, v43
    v_mul_f32 v221, v221, v43
    v_mul_f32 v222, v222, v43
    v_mul_f32 v223, v223, v43
    v_mul_f32 v224, v224, v43
    v_mul_f32 v225, v225, v43
    v_mul_f32 v226, v226, v43
    v_mul_f32 v227, v227, v43
    v_mul_f32 v228, v228, v43
    v_mul_f32 v229, v229, v43
    v_mul_f32 v230, v230, v43
    v_mul_f32 v231, v231, v43
    v_mul_f32 v232, v232, v43
    v_mul_f32 v233, v233, v43
    v_mul_f32 v234, v234, v43
    v_mul_f32 v235, v235, v43
    v_mul_f32 v236, v236, v43
    v_mul_f32 v237, v237, v43
    v_mul_f32 v238, v238, v43
    v_mul_f32 v239, v239, v43
    v_mul_f32 v240, v240, v43
    v_mul_f32 v241, v241, v43
    v_mul_f32 v242, v242, v43
    v_mul_f32 v243, v243, v43
    v_mul_f32 v244, v244, v43
    v_mul_f32 v245, v245, v43
    v_mul_f32 v246, v246, v43
    v_mul_f32 v247, v247, v43
    v_mul_f32 v248, v248, v43
    v_mul_f32 v249, v249, v43
    v_mul_f32 v250, v250, v43
    v_mul_f32 v251, v251, v43
    v_mul_f32 v252, v252, v43
    v_mul_f32 v253, v253, v43
    v_mul_f32 v254, v254, v43
    v_mul_f32 v255, v255, v43
LA_nr3:
    s_waitcnt lgkmcnt(15)
    v_mfma_f32_32x32x16_bf16 v[96:111], a[64:67], a[0:3], 0
    v_fma_f32 v112, v112, s55, -v40
    v_fma_f32 v113, v113, s55, -v40
    v_fma_f32 v114, v114, s55, -v40
    v_fma_f32 v115, v115, s55, -v40
    v_fma_f32 v116, v116, s55, -v40
    s_waitcnt lgkmcnt(14)
    v_mfma_f32_32x32x16_bf16 v[96:111], a[68:71], a[4:7], v[96:111]
    v_fma_f32 v117, v117, s55, -v40
    v_fma_f32 v118, v118, s55, -v40
    v_fma_f32 v119, v119, s55, -v40
    v_fma_f32 v120, v120, s55, -v40
    v_fma_f32 v121, v121, s55, -v40
    v_fma_f32 v122, v122, s55, -v40
    s_waitcnt lgkmcnt(13)
    v_mfma_f32_32x32x16_bf16 v[96:111], a[72:75], a[8:11], v[96:111]
    v_fma_f32 v123, v123, s55, -v40
    v_fma_f32 v124, v124, s55, -v40
    v_fma_f32 v125, v125, s55, -v40
    v_fma_f32 v126, v126, s55, -v40
    v_fma_f32 v127, v127, s55, -v40
    s_waitcnt lgkmcnt(12)
    v_mfma_f32_32x32x16_bf16 v[96:111], a[76:79], a[12:15], v[96:111]
    v_exp_f32 v112, v112
    ds_read_b64_tr_b16 a[128:129], v24 offset:49152
    ds_read_b64_tr_b16 a[130:131], v24 offset:53248
    v_exp_f32 v113, v113
    ds_read_b64_tr_b16 a[132:133], v25 offset:49152
    ds_read_b64_tr_b16 a[134:135], v25 offset:53248
    s_waitcnt lgkmcnt(15)
    v_mfma_f32_32x32x16_bf16 v[96:111], a[80:83], a[16:19], v[96:111]
    v_exp_f32 v114, v114
    ds_read_b64_tr_b16 a[136:137], v26 offset:49152
    ds_read_b64_tr_b16 a[138:139], v26 offset:53248
    v_exp_f32 v115, v115
    ds_read_b64_tr_b16 a[140:141], v27 offset:49152
    s_waitcnt lgkmcnt(15)
    v_mfma_f32_32x32x16_bf16 v[96:111], a[84:87], a[20:23], v[96:111]
    ds_read_b64_tr_b16 a[142:143], v27 offset:53248
    v_exp_f32 v116, v116
    ds_read_b64_tr_b16 a[144:145], v24 offset:49408
    ds_read_b64_tr_b16 a[146:147], v24 offset:53504
    v_exp_f32 v117, v117
    ds_read_b64_tr_b16 a[148:149], v25 offset:49408
    s_waitcnt lgkmcnt(15)
    v_mfma_f32_32x32x16_bf16 v[96:111], a[88:91], a[24:27], v[96:111]
    ds_read_b64_tr_b16 a[150:151], v25 offset:53504
    v_exp_f32 v118, v118
    ds_read_b64_tr_b16 a[152:153], v26 offset:49408
    ds_read_b64_tr_b16 a[154:155], v26 offset:53504
    v_exp_f32 v119, v119
    s_waitcnt lgkmcnt(15)
    v_mfma_f32_32x32x16_bf16 v[96:111], a[92:95], a[28:31], v[96:111]
    ds_read_b64_tr_b16 a[156:157], v27 offset:49408
    ds_read_b64_tr_b16 a[158:159], v27 offset:53504
    v_exp_f32 v120, v120
    ds_read_b64_tr_b16 a[160:161], v24 offset:57344
    ds_read_b64_tr_b16 a[162:163], v24 offset:61440
    v_exp_f32 v121, v121
    s_waitcnt lgkmcnt(15)
    v_mfma_f32_32x32x16_bf16 v[96:111], a[96:99], a[32:35], v[96:111]
    ds_read_b64_tr_b16 a[164:165], v25 offset:57344
    ds_read_b64_tr_b16 a[166:167], v25 offset:61440
    v_exp_f32 v122, v122
    ds_read_b64_tr_b16 a[168:169], v26 offset:57344
    ds_read_b64_tr_b16 a[170:171], v26 offset:61440
    s_waitcnt lgkmcnt(15)
    v_mfma_f32_32x32x16_bf16 v[96:111], a[100:103], a[36:39], v[96:111]
    v_exp_f32 v123, v123
    ds_read_b64_tr_b16 a[172:173], v27 offset:57344
    ds_read_b64_tr_b16 a[174:175], v27 offset:61440
    v_exp_f32 v124, v124
    ds_read_b64_tr_b16 a[176:177], v24 offset:57600
    ds_read_b64_tr_b16 a[178:179], v24 offset:61696
    s_waitcnt lgkmcnt(15)
    v_mfma_f32_32x32x16_bf16 v[96:111], a[104:107], a[40:43], v[96:111]
    v_exp_f32 v125, v125
    ds_read_b64_tr_b16 a[180:181], v25 offset:57600
    ds_read_b64_tr_b16 a[182:183], v25 offset:61696
    v_exp_f32 v126, v126
    ds_read_b64_tr_b16 a[184:185], v26 offset:57600
    s_waitcnt lgkmcnt(15)
    v_mfma_f32_32x32x16_bf16 v[96:111], a[108:111], a[44:47], v[96:111]
    ds_read_b64_tr_b16 a[186:187], v26 offset:61696
    v_exp_f32 v127, v127
    ds_read_b64_tr_b16 a[188:189], v27 offset:57600
    ds_read_b64_tr_b16 a[190:191], v27 offset:61696
    v_add_f32 v41, v41, v112
    v_add_f32 v41, v41, v113
    s_waitcnt lgkmcnt(15)
    v_mfma_f32_32x32x16_bf16 v[96:111], a[112:115], a[48:51], v[96:111]
    v_add_f32 v41, v41, v114
    v_add_f32 v41, v41, v115
    v_add_f32 v41, v41, v116
    v_add_f32 v41, v41, v117
    v_add_f32 v41, v41, v118
    s_waitcnt lgkmcnt(15)
    v_mfma_f32_32x32x16_bf16 v[96:111], a[116:119], a[52:55], v[96:111]
    v_add_f32 v41, v41, v119
    v_add_f32 v41, v41, v120
    v_add_f32 v41, v41, v121
    v_add_f32 v41, v41, v122
    v_add_f32 v41, v41, v123
    v_add_f32 v41, v41, v124
    s_waitcnt lgkmcnt(15)
    v_mfma_f32_32x32x16_bf16 v[96:111], a[120:123], a[56:59], v[96:111]
    v_add_f32 v41, v41, v125
    v_add_f32 v41, v41, v126
    v_add_f32 v41, v41, v127
    v_cvt_pk_bf16_f32 v48, v112, v113
    v_cvt_pk_bf16_f32 v49, v114, v115
    s_waitcnt lgkmcnt(15)
    v_mfma_f32_32x32x16_bf16 v[96:111], a[124:127], a[60:63], v[96:111]
    v_cvt_pk_bf16_f32 v50, v116, v117
    v_cvt_pk_bf16_f32 v51, v118, v119
    v_cvt_pk_bf16_f32 v52, v120, v121
    v_cvt_pk_bf16_f32 v53, v122, v123
    v_cvt_pk_bf16_f32 v54, v124, v125
    v_cvt_pk_bf16_f32 v55, v126, v127
    s_mov_b32 s43, 0
LA_loop:
    s_waitcnt vmcnt(20)
    s_waitcnt vmcnt(16)
    s_barrier
    s_waitcnt lgkmcnt(0)
    v_mfma_f32_32x32x16_bf16 v[128:143], a[128:131], v[48:51], v[128:143]
    s_add_u32 m0, s56, 0
    s_add_u32 s58, s57, 131072
    buffer_load_dwordx4 v28, s[24:27], s58 offen lds
    s_add_u32 m0, s56, 1024
    s_add_u32 s58, s57, 131072
    buffer_load_dwordx4 v29, s[24:27], s58 offen lds
    v_mfma_f32_32x32x16_bf16 v[144:159], a[132:135], v[48:51], v[144:159]
    s_add_u32 m0, s56, 2048
    s_add_u32 s58, s57, 131072
    buffer_load_dwordx4 v30, s[24:27], s58 offen lds
    s_add_u32 m0, s56, 3072
    s_add_u32 s58, s57, 131072
    buffer_load_dwordx4 v31, s[24:27], s58 offen lds
    v_mfma_f32_32x32x16_bf16 v[160:175], a[136:139], v[48:51], v[160:175]
    ds_read_b128 a[64:67], v16 offset:16384
    ds_read_b128 a[68:71], v17 offset:16384
    ds_read_b128 a[72:75], v18 offset:16384
    v_mfma_f32_32x32x16_bf16 v[176:191], a[140:143], v[48:51], v[176:191]
    ds_read_b128 a[76:79], v19 offset:16384
    ds_read_b128 a[80:83], v20 offset:16384
    v_mfma_f32_32x32x16_bf16 v[192:207], a[144:147], v[48:51], v[192:207]
    ds_read_b128 a[84:87], v21 offset:16384
    ds_read_b128 a[88:91], v22 offset:16384
    ds_read_b128 a[92:95], v23 offset:16384
    v_mfma_f32_32x32x16_bf16 v[208:223], a[148:151], v[48:51], v[208:223]
    ds_read_b128 a[96:99], v16 offset:16640
    ds_read_b128 a[100:103], v17 offset:16640
    v_mfma_f32_32x32x16_bf16 v[224:239], a[152:155], v[48:51], v[224:239]
    ds_read_b128 a[104:107], v18 offset:16640
    ds_read_b128 a[108:111], v19 offset:16640
    ds_read_b128 a[112:115], v20 offset:16640
    v_mfma_f32_32x32x16_bf16 v[240:255], a[156:159], v[48:51], v[240:255]
    ds_read_b128 a[116:119], v21 offset:16640
    ds_read_b128 a[120:123], v22 offset:16640
    v_mfma_f32_32x32x16_bf16 v[128:143], a[160:163], v[52:55], v[128:143]
    ds_read_b128 a[124:127], v23 offset:16640
    s_add_u32 m0, s56, 114688
    s_add_u32 s58, s59, 114688
    buffer_load_dwordx4 v36, s[28:31], s58 offen lds
    v_mfma_f32_32x32x16_bf16 v[144:159], a[164:167], v[52:55], v[144:159]
    s_add_u32 m0, s56, 115712
    s_add_u32 s58, s59, 115712
    buffer_load_dwordx4 v37, s[28:31], s58 offen lds
    s_add_u32 m0, s56, 116736
    s_add_u32 s58, s59, 116736
    buffer_load_dwordx4 v36, s[28:31], s58 offen lds
    s_add_u32 m0, s56, 117760
    s_add_u32 s58, s59, 117760
    buffer_load_dwordx4 v37, s[28:31], s58 offen lds
    v_mfma_f32_32x32x16_bf16 v[160:175], a[168:171], v[52:55], v[160:175]
    v_max3_f32 v42, v96, v97, v98
    v_max3_f32 v42, v42, v99, v100
    v_mfma_f32_32x32x16_bf16 v[176:191], a[172:175], v[52:55], v[176:191]
    v_max3_f32 v42, v42, v101, v102
    v_max3_f32 v42, v42, v103, v104
    v_max3_f32 v42, v42, v105, v106
    v_mfma_f32_32x32x16_bf16 v[192:207], a[176:179], v[52:55], v[192:207]
    v_max3_f32 v42, v42, v107, v108
    v_max3_f32 v42, v42, v109, v110
    v_mfma_f32_32x32x16_bf16 v[208:223], a[180:183], v[52:55], v[208:223]
    v_max_f32 v42, v42, v111
    v_mov_b32 v43, v42
    s_nop 1
    v_mfma_f32_32x32x16_bf16 v[224:239], a[184:187], v[52:55], v[224:239]
    v_permlane32_swap_b32 v42, v43
    v_max_f32 v42, v42, v43
    v_mfma_f32_32x32x16_bf16 v[240:255], a[188:191], v[52:55], v[240:255]
    v_mul_f32 v42, s55, v42
    v_sub_f32 v43, v42, v40
    v_cmp_gt_f32 vcc, v43, v39
    s_nop 4
    s_cbranch_vccz LA_nr4
    s_nop 15
    v_max_f32 v42, v40, v42
    v_sub_f32 v43, v40, v42
    v_exp_f32 v43, v43
    v_mov_b32 v40, v42
    s_nop 0
    v_mul_f32 v41, v41, v43
    v_mul_f32 v128, v128, v43
    v_mul_f32 v129, v129, v43
    v_mul_f32 v130, v130, v43
    v_mul_f32 v131, v131, v43
    v_mul_f32 v132, v132, v43
    v_mul_f32 v133, v133, v43
    v_mul_f32 v134, v134, v43
    v_mul_f32 v135, v135, v43
    v_mul_f32 v136, v136, v43
    v_mul_f32 v137, v137, v43
    v_mul_f32 v138, v138, v43
    v_mul_f32 v139, v139, v43
    v_mul_f32 v140, v140, v43
    v_mul_f32 v141, v141, v43
    v_mul_f32 v142, v142, v43
    v_mul_f32 v143, v143, v43
    v_mul_f32 v144, v144, v43
    v_mul_f32 v145, v145, v43
    v_mul_f32 v146, v146, v43
    v_mul_f32 v147, v147, v43
    v_mul_f32 v148, v148, v43
    v_mul_f32 v149, v149, v43
    v_mul_f32 v150, v150, v43
    v_mul_f32 v151, v151, v43
    v_mul_f32 v152, v152, v43
    v_mul_f32 v153, v153, v43
    v_mul_f32 v154, v154, v43
    v_mul_f32 v155, v155, v43
    v_mul_f32 v156, v156, v43
    v_mul_f32 v157, v157, v43
    v_mul_f32 v158, v158, v43
    v_mul_f32 v159, v159, v43
    v_mul_f32 v160, v160, v43
    v_mul_f32 v161, v161, v43
    v_mul_f32 v162, v162, v43
    v_mul_f32 v163, v163, v43
    v_mul_f32 v164, v164, v43
    v_mul_f32 v165, v165, v43
    v_mul_f32 v166, v166, v43
    v_mul_f32 v167, v167, v43
    v_mul_f32 v168, v168, v43
    v_mul_f32 v169, v169, v43
    v_mul_f32 v170, v170, v43
    v_mul_f32 v171, v171, v43
    v_mul_f32 v172, v172, v43
    v_mul_f32 v173, v173, v43
    v_mul_f32 v174, v174, v43
    v_mul_f32 v175, v175, v43
    v_mul_f32 v176, v176, v43
    v_mul_f32 v177, v177, v43
    v_mul_f32 v178, v178, v43
    v_mul_f32 v179, v179, v43
    v_mul_f32 v180, v180, v43
    v_mul_f32 v181, v181, v43
    v_mul_f32 v182, v182, v43
    v_mul_f32 v183, v183, v43
    v_mul_f32 v184, v184, v43
    v_mul_f32 v185, v185, v43
    v_mul_f32 v186, v186, v43
    v_mul_f32 v187, v187, v43
    v_mul_f32 v188, v188, v43
    v_mul_f32 v189, v189, v43
    v_mul_f32 v190, v190, v43
    v_mul_f32 v191, v191, v43
    v_mul_f32 v192, v192, v43
    v_mul_f32 v193, v193, v43
    v_mul_f32 v194, v194, v43
    v_mul_f32 v195, v195, v43
    v_mul_f32 v196, v196, v43
    v_mul_f32 v197, v197, v43
    v_mul_f32 v198, v198, v43
    v_mul_f32 v199, v199, v43
    v_mul_f32 v200, v200, v43
    v_mul_f32 v201, v201, v43
    v_mul_f32 v202, v202, v43
    v_mul_f32 v203, v203, v43
    v_mul_f32 v204, v204, v43
    v_mul_f32 v205, v205, v43
    v_mul_f32 v206, v206, v43
    v_mul_f32 v207, v207, v43
    v_mul_f32 v208, v208, v43
    v_mul_f32 v209, v209, v43
    v_mul_f32 v210, v210, v43
    v_mul_f32 v211, v211, v43
    v_mul_f32 v212, v212, v43
    v_mul_f32 v213, v213, v43
    v_mul_f32 v214, v214, v43
    v_mul_f32 v215, v215, v43
    v_mul_f32 v216, v216, v43
    v_mul_f32 v217, v217, v43
    v_mul_f32 v218, v218, v43
    v_mul_f32 v219, v219, v43
    v_mul_f32 v220, v220, v43
    v_mul_f32 v221, v221, v43
    v_mul_f32 v222, v222, v43
    v_mul_f32 v223, v223, v43
    v_mul_f32 v224, v224, v43
    v_mul_f32 v225, v225, v43
    v_mul_f32 v226, v226, v43
    v_mul_f32 v227, v227, v43
    v_mul_f32 v228, v228, v43
    v_mul_f32 v229, v229, v43
    v_mul_f32 v230, v230, v43
    v_mul_f32 v231, v231, v43
    v_mul_f32 v232, v232, v43
    v_mul_f32 v233, v233, v43
    v_mul_f32 v234, v234, v43
    v_mul_f32 v235, v235, v43
    v_mul_f32 v236, v236, v43
    v_mul_f32 v237, v237, v43
    v_mul_f32 v238, v238, v43
    v_mul_f32 v239, v239, v43
    v_mul_f32 v240, v240, v43
    v_mul_f32 v241, v241, v43
    v_mul_f32 v242, v242, v43
    v_mul_f32 v243, v243, v43
    v_mul_f32 v244, v244, v43
    v_mul_f32 v245, v245, v43
    v_mul_f32 v246, v246, v43
    v_mul_f32 v247, v247, v43
    v_mul_f32 v248, v248, v43
    v_mul_f32 v249, v249, v43
    v_mul_f32 v250, v250, v43
    v_mul_f32 v251, v251, v43
    v_mul_f32 v252, v252, v43
    v_mul_f32 v253, v253, v43
    v_mul_f32 v254, v254, v43
    v_mul_f32 v255, v255, v43
LA_nr4:
    s_waitcnt lgkmcnt(15)
    v_mfma_f32_32x32x16_bf16 v[112:127], a[64:67], a[0:3], 0
    v_fma_f32 v96, v96, s55, -v40
    v_fma_f32 v97, v97, s55, -v40
    v_fma_f32 v98, v98, s55, -v40
    v_fma_f32 v99, v99, s55, -v40
    v_fma_f32 v100, v100, s55, -v40
    s_waitcnt lgkmcnt(14)
    v_mfma_f32_32x32x16_bf16 v[112:127], a[68:71], a[4:7], v[112:127]
    v_fma_f32 v101, v101, s55, -v40
    v_fma_f32 v102, v102, s55, -v40
    v_fma_f32 v103, v103, s55, -v40
    v_fma_f32 v104, v104, s55, -v40
    v_fma_f32 v105, v105, s55, -v40
    v_fma_f32 v106, v106, s55, -v40
    s_waitcnt lgkmcnt(13)
    v_mfma_f32_32x32x16_bf16 v[112:127], a[72:75], a[8:11], v[112:127]
    v_fma_f32 v107, v107, s55, -v40
    v_fma_f32 v108, v108, s55, -v40
    v_fma_f32 v109, v109, s55, -v40
    v_fma_f32 v110, v110, s55, -v40
    v_fma_f32 v111, v111, s55, -v40
    s_waitcnt lgkmcnt(12)
    v_mfma_f32_32x32x16_bf16 v[112:127], a[76:79], a[12:15], v[112:127]
    v_exp_f32 v96, v96
    ds_read_b64_tr_b16 a[128:129], v24 offset:0
    ds_read_b64_tr_b16 a[130:131], v24 offset:4096
    v_exp_f32 v97, v97
    ds_read_b64_tr_b16 a[132:133], v25 offset:0
    ds_read_b64_tr_b16 a[134:135], v25 offset:4096
    s_waitcnt lgkmcnt(15)
    v_mfma_f32_32x32x16_bf16 v[112:127], a[80:83], a[16:19], v[112:127]
    v_exp_f32 v98, v98
    ds_read_b64_tr_b16 a[136:137], v26 offset:0
    ds_read_b64_tr_b16 a[138:139], v26 offset:4096
    v_exp_f32 v99, v99
    ds_read_b64_tr_b16 a[140:141], v27 offset:0
    s_waitcnt lgkmcnt(15)
    v_mfma_f32_32x32x16_bf16 v[112:127], a[84:87], a[20:23], v[112:127]
    ds_read_b64_tr_b16 a[142:143], v27 offset:4096
    v_exp_f32 v100, v100
    ds_read_b64_tr_b16 a[144:145], v24 offset:256
    ds_read_b64_tr_b16 a[146:147], v24 offset:4352
    v_exp_f32 v101, v101
    ds_read_b64_tr_b16 a[148:149], v25 offset:256
    s_waitcnt lgkmcnt(15)
    v_mfma_f32_32x32x16_bf16 v[112:127], a[88:91], a[24:27], v[112:127]
    ds_read_b64_tr_b16 a[150:151], v25 offset:4352
    v_exp_f32 v102, v102
    ds_read_b64_tr_b16 a[152:153], v26 offset:256
    ds_read_b64_tr_b16 a[154:155], v26 offset:4352
    v_exp_f32 v103, v103
    s_waitcnt lgkmcnt(15)
    v_mfma_f32_32x32x16_bf16 v[112:127], a[92:95], a[28:31], v[112:127]
    ds_read_b64_tr_b16 a[156:157], v27 offset:256
    ds_read_b64_tr_b16 a[158:159], v27 offset:4352
    v_exp_f32 v104, v104
    ds_read_b64_tr_b16 a[160:161], v24 offset:8192
    ds_read_b64_tr_b16 a[162:163], v24 offset:12288
    v_exp_f32 v105, v105
    s_waitcnt lgkmcnt(15)
    v_mfma_f32_32x32x16_bf16 v[112:127], a[96:99], a[32:35], v[112:127]
    ds_read_b64_tr_b16 a[164:165], v25 offset:8192
    ds_read_b64_tr_b16 a[166:167], v25 offset:12288
    v_exp_f32 v106, v106
    ds_read_b64_tr_b16 a[168:169], v26 offset:8192
    ds_read_b64_tr_b16 a[170:171], v26 offset:12288
    s_waitcnt lgkmcnt(15)
    v_mfma_f32_32x32x16_bf16 v[112:127], a[100:103], a[36:39], v[112:127]
    v_exp_f32 v107, v107
    ds_read_b64_tr_b16 a[172:173], v27 offset:8192
    ds_read_b64_tr_b16 a[174:175], v27 offset:12288
    v_exp_f32 v108, v108
    ds_read_b64_tr_b16 a[176:177], v24 offset:8448
    ds_read_b64_tr_b16 a[178:179], v24 offset:12544
    s_waitcnt lgkmcnt(15)
    v_mfma_f32_32x32x16_bf16 v[112:127], a[104:107], a[40:43], v[112:127]
    v_exp_f32 v109, v109
    ds_read_b64_tr_b16 a[180:181], v25 offset:8448
    ds_read_b64_tr_b16 a[182:183], v25 offset:12544
    v_exp_f32 v110, v110
    ds_read_b64_tr_b16 a[184:185], v26 offset:8448
    s_waitcnt lgkmcnt(15)
    v_mfma_f32_32x32x16_bf16 v[112:127], a[108:111], a[44:47], v[112:127]
    ds_read_b64_tr_b16 a[186:187], v26 offset:12544
    v_exp_f32 v111, v111
    ds_read_b64_tr_b16 a[188:189], v27 offset:8448
    ds_read_b64_tr_b16 a[190:191], v27 offset:12544
    v_add_f32 v41, v41, v96
    v_add_f32 v41, v41, v97
    s_waitcnt lgkmcnt(15)
    v_mfma_f32_32x32x16_bf16 v[112:127], a[112:115], a[48:51], v[112:127]
    v_add_f32 v41, v41, v98
    v_add_f32 v41, v41, v99
    v_add_f32 v41, v41, v100
    v_add_f32 v41, v41, v101
    v_add_f32 v41, v41, v102
    s_waitcnt lgkmcnt(15)
    v_mfma_f32_32x32x16_bf16 v[112:127], a[116:119], a[52:55], v[112:127]
    v_add_f32 v41, v41, v103
    v_add_f32 v41, v41, v104
    v_add_f32 v41, v41, v105
    v_add_f32 v41, v41, v106
    v_add_f32 v41, v41, v107
    v_add_f32 v41, v41, v108
    s_waitcnt lgkmcnt(15)
    v_mfma_f32_32x32x16_bf16 v[112:127], a[120:123], a[56:59], v[112:127]
    v_add_f32 v41, v41, v109
    v_add_f32 v41, v41, v110
    v_add_f32 v41, v41, v111
    v_cvt_pk_bf16_f32 v48, v96, v97
    v_cvt_pk_bf16_f32 v49, v98, v99
    s_waitcnt lgkmcnt(15)
    v_mfma_f32_32x32x16_bf16 v[112:127], a[124:127], a[60:63], v[112:127]
    v_cvt_pk_bf16_f32 v50, v100, v101
    v_cvt_pk_bf16_f32 v51, v102, v103
    v_cvt_pk_bf16_f32 v52, v104, v105
    v_cvt_pk_bf16_f32 v53, v106, v107
    v_cvt_pk_bf16_f32 v54, v108, v109
    v_cvt_pk_bf16_f32 v55, v110, v111
    s_waitcnt vmcnt(20)
    s_waitcnt vmcnt(16)
    s_barrier
    s_waitcnt lgkmcnt(0)
    v_mfma_f32_32x32x16_bf16 v[128:143], a[128:131], v[48:51], v[128:143]
    s_add_u32 m0, s56, 16384
    s_add_u32 s58, s57, 147456
    buffer_load_dwordx4 v28, s[24:27], s58 offen lds
    s_add_u32 m0, s56, 17408
    s_add_u32 s58, s57, 147456
    buffer_load_dwordx4 v29, s[24:27], s58 offen lds
    v_mfma_f32_32x32x16_bf16 v[144:159], a[132:135], v[48:51], v[144:159]
    s_add_u32 m0, s56, 18432
    s_add_u32 s58, s57, 147456
    buffer_load_dwordx4 v30, s[24:27], s58 offen lds
    s_add_u32 m0, s56, 19456
    s_add_u32 s58, s57, 147456
    buffer_load_dwordx4 v31, s[24:27], s58 offen lds
    v_mfma_f32_32x32x16_bf16 v[160:175], a[136:139], v[48:51], v[160:175]
    ds_read_b128 a[64:67], v16 offset:32768
    ds_read_b128 a[68:71], v17 offset:32768
    ds_read_b128 a[72:75], v18 offset:32768
    v_mfma_f32_32x32x16_bf16 v[176:191], a[140:143], v[48:51], v[176:191]
    ds_read_b128 a[76:79], v19 offset:32768
    ds_read_b128 a[80:83], v20 offset:32768
    v_mfma_f32_32x32x16_bf16 v[192:207], a[144:147], v[48:51], v[192:207]
    ds_read_b128 a[84:87], v21 offset:32768
    ds_read_b128 a[88:91], v22 offset:32768
    ds_read_b128 a[92:95], v23 offset:32768
    v_mfma_f32_32x32x16_bf16 v[208:223], a[148:151], v[48:51], v[208:223]
    ds_read_b128 a[96:99], v16 offset:33024
    ds_read_b128 a[100:103], v17 offset:33024
    v_mfma_f32_32x32x16_bf16 v[224:239], a[152:155], v[48:51], v[224:239]
    ds_read_b128 a[104:107], v18 offset:33024
    ds_read_b128 a[108:111], v19 offset:33024
    ds_read_b128 a[112:115], v20 offset:33024
    v_mfma_f32_32x32x16_bf16 v[240:255], a[156:159], v[48:51], v[240:255]
    ds_read_b128 a[116:119], v21 offset:33024
    ds_read_b128 a[120:123], v22 offset:33024
    v_mfma_f32_32x32x16_bf16 v[128:143], a[160:163], v[52:55], v[128:143]
    ds_read_b128 a[124:127], v23 offset:33024
    s_add_u32 m0, s56, 65536
    s_add_u32 s58, s59, 131072
    buffer_load_dwordx4 v36, s[28:31], s58 offen lds
    v_mfma_f32_32x32x16_bf16 v[144:159], a[164:167], v[52:55], v[144:159]
    s_add_u32 m0, s56, 66560
    s_add_u32 s58, s59, 132096
    buffer_load_dwordx4 v37, s[28:31], s58 offen lds
    s_add_u32 m0, s56, 67584
    s_add_u32 s58, s59, 133120
    buffer_load_dwordx4 v36, s[28:31], s58 offen lds
    s_add_u32 m0, s56, 68608
    s_add_u32 s58, s59, 134144
    buffer_load_dwordx4 v37, s[28:31], s58 offen lds
    v_mfma_f32_32x32x16_bf16 v[160:175], a[168:171], v[52:55], v[160:175]
    v_max3_f32 v42, v112, v113, v114
    v_max3_f32 v42, v42, v115, v116
    v_mfma_f32_32x32x16_bf16 v[176:191], a[172:175], v[52:55], v[176:191]
    v_max3_f32 v42, v42, v117, v118
    v_max3_f32 v42, v42, v119, v120
    v_max3_f32 v42, v42, v121, v122
    v_mfma_f32_32x32x16_bf16 v[192:207], a[176:179], v[52:55], v[192:207]
    v_max3_f32 v42, v42, v123, v124
    v_max3_f32 v42, v42, v125, v126
    v_mfma_f32_32x32x16_bf16 v[208:223], a[180:183], v[52:55], v[208:223]
    v_max_f32 v42, v42, v127
    v_mov_b32 v43, v42
    s_nop 1
    v_mfma_f32_32x32x16_bf16 v[224:239], a[184:187], v[52:55], v[224:239]
    v_permlane32_swap_b32 v42, v43
    v_max_f32 v42, v42, v43
    v_mfma_f32_32x32x16_bf16 v[240:255], a[188:191], v[52:55], v[240:255]
    v_mul_f32 v42, s55, v42
    v_sub_f32 v43, v42, v40
    v_cmp_gt_f32 vcc, v43, v39
    s_nop 4
    s_cbranch_vccz LA_nr5
    s_nop 15
    v_max_f32 v42, v40, v42
    v_sub_f32 v43, v40, v42
    v_exp_f32 v43, v43
    v_mov_b32 v40, v42
    s_nop 0
    v_mul_f32 v41, v41, v43
    v_mul_f32 v128, v128, v43
    v_mul_f32 v129, v129, v43
    v_mul_f32 v130, v130, v43
    v_mul_f32 v131, v131, v43
    v_mul_f32 v132, v132, v43
    v_mul_f32 v133, v133, v43
    v_mul_f32 v134, v134, v43
    v_mul_f32 v135, v135, v43
    v_mul_f32 v136, v136, v43
    v_mul_f32 v137, v137, v43
    v_mul_f32 v138, v138, v43
    v_mul_f32 v139, v139, v43
    v_mul_f32 v140, v140, v43
    v_mul_f32 v141, v141, v43
    v_mul_f32 v142, v142, v43
    v_mul_f32 v143, v143, v43
    v_mul_f32 v144, v144, v43
    v_mul_f32 v145, v145, v43
    v_mul_f32 v146, v146, v43
    v_mul_f32 v147, v147, v43
    v_mul_f32 v148, v148, v43
    v_mul_f32 v149, v149, v43
    v_mul_f32 v150, v150, v43
    v_mul_f32 v151, v151, v43
    v_mul_f32 v152, v152, v43
    v_mul_f32 v153, v153, v43
    v_mul_f32 v154, v154, v43
    v_mul_f32 v155, v155, v43
    v_mul_f32 v156, v156, v43
    v_mul_f32 v157, v157, v43
    v_mul_f32 v158, v158, v43
    v_mul_f32 v159, v159, v43
    v_mul_f32 v160, v160, v43
    v_mul_f32 v161, v161, v43
    v_mul_f32 v162, v162, v43
    v_mul_f32 v163, v163, v43
    v_mul_f32 v164, v164, v43
    v_mul_f32 v165, v165, v43
    v_mul_f32 v166, v166, v43
    v_mul_f32 v167, v167, v43
    v_mul_f32 v168, v168, v43
    v_mul_f32 v169, v169, v43
    v_mul_f32 v170, v170, v43
    v_mul_f32 v171, v171, v43
    v_mul_f32 v172, v172, v43
    v_mul_f32 v173, v173, v43
    v_mul_f32 v174, v174, v43
    v_mul_f32 v175, v175, v43
    v_mul_f32 v176, v176, v43
    v_mul_f32 v177, v177, v43
    v_mul_f32 v178, v178, v43
    v_mul_f32 v179, v179, v43
    v_mul_f32 v180, v180, v43
    v_mul_f32 v181, v181, v43
    v_mul_f32 v182, v182, v43
    v_mul_f32 v183, v183, v43
    v_mul_f32 v184, v184, v43
    v_mul_f32 v185, v185, v43
    v_mul_f32 v186, v186, v43
    v_mul_f32 v187, v187, v43
    v_mul_f32 v188, v188, v43
    v_mul_f32 v189, v189, v43
    v_mul_f32 v190, v190, v43
    v_mul_f32 v191, v191, v43
    v_mul_f32 v192, v192, v43
    v_mul_f32 v193, v193, v43
    v_mul_f32 v194, v194, v43
    v_mul_f32 v195, v195, v43
    v_mul_f32 v196, v196, v43
    v_mul_f32 v197, v197, v43
    v_mul_f32 v198, v198, v43
    v_mul_f32 v199, v199, v43
    v_mul_f32 v200, v200, v43
    v_mul_f32 v201, v201, v43
    v_mul_f32 v202, v202, v43
    v_mul_f32 v203, v203, v43
    v_mul_f32 v204, v204, v43
    v_mul_f32 v205, v205, v43
    v_mul_f32 v206, v206, v43
    v_mul_f32 v207, v207, v43
    v_mul_f32 v208, v208, v43
    v_mul_f32 v209, v209, v43
    v_mul_f32 v210, v210, v43
    v_mul_f32 v211, v211, v43
    v_mul_f32 v212, v212, v43
    v_mul_f32 v213, v213, v43
    v_mul_f32 v214, v214, v43
    v_mul_f32 v215, v215, v43
    v_mul_f32 v216, v216, v43
    v_mul_f32 v217, v217, v43
    v_mul_f32 v218, v218, v43
    v_mul_f32 v219, v219, v43
    v_mul_f32 v220, v220, v43
    v_mul_f32 v221, v221, v43
    v_mul_f32 v222, v222, v43
    v_mul_f32 v223, v223, v43
    v_mul_f32 v224, v224, v43
    v_mul_f32 v225, v225, v43
    v_mul_f32 v226, v226, v43
    v_mul_f32 v227, v227, v43
    v_mul_f32 v228, v228, v43
    v_mul_f32 v229, v229, v43
    v_mul_f32 v230, v230, v43
    v_mul_f32 v231, v231, v43
    v_mul_f32 v232, v232, v43
    v_mul_f32 v233, v233, v43
    v_mul_f32 v234, v234, v43
    v_mul_f32 v235, v235, v43
    v_mul_f32 v236, v236, v43
    v_mul_f32 v237, v237, v43
    v_mul_f32 v238, v238, v43
    v_mul_f32 v239, v239, v43
    v_mul_f32 v240, v240, v43
    v_mul_f32 v241, v241, v43
    v_mul_f32 v242, v242, v43
    v_mul_f32 v243, v243, v43
    v_mul_f32 v244, v244, v43
    v_mul_f32 v245, v245, v43
    v_mul_f32 v246, v246, v43
    v_mul_f32 v247, v247, v43
    v_mul_f32 v248, v248, v43
    v_mul_f32 v249, v249, v43
    v_mul_f32 v250, v250, v43
    v_mul_f32 v251, v251, v43
    v_mul_f32 v252, v252, v43
    v_mul_f32 v253, v253, v43
    v_mul_f32 v254, v254, v43
    v_mul_f32 v255, v255, v43
LA_nr5:
    s_waitcnt lgkmcnt(15)
    v_mfma_f32_32x32x16_bf16 v[96:111], a[64:67], a[0:3], 0
    v_fma_f32 v112, v112, s55, -v40
    v_fma_f32 v113, v113, s55, -v40
    v_fma_f32 v114, v114, s55, -v40
    v_fma_f32 v115, v115, s55, -v40
    v_fma_f32 v116, v116, s55, -v40
    s_waitcnt lgkmcnt(14)
    v_mfma_f32_32x32x16_bf16 v[96:111], a[68:71], a[4:7], v[96:111]
    v_fma_f32 v117, v117, s55, -v40
    v_fma_f32 v118, v118, s55, -v40
    v_fma_f32 v119, v119, s55, -v40
    v_fma_f32 v120, v120, s55, -v40
    v_fma_f32 v121, v121, s55, -v40
    v_fma_f32 v122, v122, s55, -v40
    s_waitcnt lgkmcnt(13)
    v_mfma_f32_32x32x16_bf16 v[96:111], a[72:75], a[8:11], v[96:111]
    v_fma_f32 v123, v123, s55, -v40
    v_fma_f32 v124, v124, s55, -v40
    v_fma_f32 v125, v125, s55, -v40
    v_fma_f32 v126, v126, s55, -v40
    v_fma_f32 v127, v127, s55, -v40
    s_waitcnt lgkmcnt(12)
    v_mfma_f32_32x32x16_bf16 v[96:111], a[76:79], a[12:15], v[96:111]
    v_exp_f32 v112, v112
    ds_read_b64_tr_b16 a[128:129], v24 offset:16384
    ds_read_b64_tr_b16 a[130:131], v24 offset:20480
    v_exp_f32 v113, v113
    ds_read_b64_tr_b16 a[132:133], v25 offset:16384
    ds_read_b64_tr_b16 a[134:135], v25 offset:20480
    s_waitcnt lgkmcnt(15)
    v_mfma_f32_32x32x16_bf16 v[96:111], a[80:83], a[16:19], v[96:111]
    v_exp_f32 v114, v114
    ds_read_b64_tr_b16 a[136:137], v26 offset:16384
    ds_read_b64_tr_b16 a[138:139], v26 offset:20480
    v_exp_f32 v115, v115
    ds_read_b64_tr_b16 a[140:141], v27 offset:16384
    s_waitcnt lgkmcnt(15)
    v_mfma_f32_32x32x16_bf16 v[96:111], a[84:87], a[20:23], v[96:111]
    ds_read_b64_tr_b16 a[142:143], v27 offset:20480
    v_exp_f32 v116, v116
    ds_read_b64_tr_b16 a[144:145], v24 offset:16640
    ds_read_b64_tr_b16 a[146:147], v24 offset:20736
    v_exp_f32 v117, v117
    ds_read_b64_tr_b16 a[148:149], v25 offset:16640
    s_waitcnt lgkmcnt(15)
    v_mfma_f32_32x32x16_bf16 v[96:111], a[88:91], a[24:27], v[96:111]
    ds_read_b64_tr_b16 a[150:151], v25 offset:20736
    v_exp_f32 v118, v118
    ds_read_b64_tr_b16 a[152:153], v26 offset:16640
    ds_read_b64_tr_b16 a[154:155], v26 offset:20736
    v_exp_f32 v119, v119
    s_waitcnt lgkmcnt(15)
    v_mfma_f32_32x32x16_bf16 v[96:111], a[92:95], a[28:31], v[96:111]
    ds_read_b64_tr_b16 a[156:157], v27 offset:16640
    ds_read_b64_tr_b16 a[158:159], v27 offset:20736
    v_exp_f32 v120, v120
    ds_read_b64_tr_b16 a[160:161], v24 offset:24576
    ds_read_b64_tr_b16 a[162:163], v24 offset:28672
    v_exp_f32 v121, v121
    s_waitcnt lgkmcnt(15)
    v_mfma_f32_32x32x16_bf16 v[96:111], a[96:99], a[32:35], v[96:111]
    ds_read_b64_tr_b16 a[164:165], v25 offset:24576
    ds_read_b64_tr_b16 a[166:167], v25 offset:28672
    v_exp_f32 v122, v122
    ds_read_b64_tr_b16 a[168:169], v26 offset:24576
    ds_read_b64_tr_b16 a[170:171], v26 offset:28672
    s_waitcnt lgkmcnt(15)
    v_mfma_f32_32x32x16_bf16 v[96:111], a[100:103], a[36:39], v[96:111]
    v_exp_f32 v123, v123
    ds_read_b64_tr_b16 a[172:173], v27 offset:24576
    ds_read_b64_tr_b16 a[174:175], v27 offset:28672
    v_exp_f32 v124, v124
    ds_read_b64_tr_b16 a[176:177], v24 offset:24832
    ds_read_b64_tr_b16 a[178:179], v24 offset:28928
    s_waitcnt lgkmcnt(15)
    v_mfma_f32_32x32x16_bf16 v[96:111], a[104:107], a[40:43], v[96:111]
    v_exp_f32 v125, v125
    ds_read_b64_tr_b16 a[180:181], v25 offset:24832
    ds_read_b64_tr_b16 a[182:183], v25 offset:28928
    v_exp_f32 v126, v126
    ds_read_b64_tr_b16 a[184:185], v26 offset:24832
    s_waitcnt lgkmcnt(15)
    v_mfma_f32_32x32x16_bf16 v[96:111], a[108:111], a[44:47], v[96:111]
    ds_read_b64_tr_b16 a[186:187], v26 offset:28928
    v_exp_f32 v127, v127
    ds_read_b64_tr_b16 a[188:189], v27 offset:24832
    ds_read_b64_tr_b16 a[190:191], v27 offset:28928
    v_add_f32 v41, v41, v112
    v_add_f32 v41, v41, v113
    s_waitcnt lgkmcnt(15)
    v_mfma_f32_32x32x16_bf16 v[96:111], a[112:115], a[48:51], v[96:111]
    v_add_f32 v41, v41, v114
    v_add_f32 v41, v41, v115
    v_add_f32 v41, v41, v116
    v_add_f32 v41, v41, v117
    v_add_f32 v41, v41, v118
    s_waitcnt lgkmcnt(15)
    v_mfma_f32_32x32x16_bf16 v[96:111], a[116:119], a[52:55], v[96:111]
    v_add_f32 v41, v41, v119
    v_add_f32 v41, v41, v120
    v_add_f32 v41, v41, v121
    v_add_f32 v41, v41, v122
    v_add_f32 v41, v41, v123
    v_add_f32 v41, v41, v124
    s_waitcnt lgkmcnt(15)
    v_mfma_f32_32x32x16_bf16 v[96:111], a[120:123], a[56:59], v[96:111]
    v_add_f32 v41, v41, v125
    v_add_f32 v41, v41, v126
    v_add_f32 v41, v41, v127
    v_cvt_pk_bf16_f32 v48, v112, v113
    v_cvt_pk_bf16_f32 v49, v114, v115
    s_waitcnt lgkmcnt(15)
    v_mfma_f32_32x32x16_bf16 v[96:111], a[124:127], a[60:63], v[96:111]
    v_cvt_pk_bf16_f32 v50, v116, v117
    v_cvt_pk_bf16_f32 v51, v118, v119
    v_cvt_pk_bf16_f32 v52, v120, v121
    v_cvt_pk_bf16_f32 v53, v122, v123
    v_cvt_pk_bf16_f32 v54, v124, v125
    v_cvt_pk_bf16_f32 v55, v126, v127
    s_waitcnt vmcnt(20)
    s_waitcnt vmcnt(16)
    s_barrier
    s_waitcnt lgkmcnt(0)
    v_mfma_f32_32x32x16_bf16 v[128:143], a[128:131], v[48:51], v[128:143]
    s_add_u32 m0, s56, 32768
    s_add_u32 s58, s57, 163840
    buffer_load_dwordx4 v28, s[24:27], s58 offen lds
    s_add_u32 m0, s56, 33792
    s_add_u32 s58, s57, 163840
    buffer_load_dwordx4 v29, s[24:27], s58 offen lds
    v_mfma_f32_32x32x16_bf16 v[144:159], a[132:135], v[48:51], v[144:159]
    s_add_u32 m0, s56, 34816
    s_add_u32 s58, s57, 163840
    buffer_load_dwordx4 v30, s[24:27], s58 offen lds
    s_add_u32 m0, s56, 35840
    s_add_u32 s58, s57, 163840
    buffer_load_dwordx4 v31, s[24:27], s58 offen lds
    v_mfma_f32_32x32x16_bf16 v[160:175], a[136:139], v[48:51], v[160:175]
    ds_read_b128 a[64:67], v16 offset:49152
    ds_read_b128 a[68:71], v17 offset:49152
    ds_read_b128 a[72:75], v18 offset:49152
    v_mfma_f32_32x32x16_bf16 v[176:191], a[140:143], v[48:51], v[176:191]
    ds_read_b128 a[76:79], v19 offset:49152
    ds_read_b128 a[80:83], v20 offset:49152
    v_mfma_f32_32x32x16_bf16 v[192:207], a[144:147], v[48:51], v[192:207]
    ds_read_b128 a[84:87], v21 offset:49152
    ds_read_b128 a[88:91], v22 offset:49152
    ds_read_b128 a[92:95], v23 offset:49152
    v_mfma_f32_32x32x16_bf16 v[208:223], a[148:151], v[48:51], v[208:223]
    ds_read_b128 a[96:99], v16 offset:49408
    ds_read_b128 a[100:103], v17 offset:49408
    v_mfma_f32_32x32x16_bf16 v[224:239], a[152:155], v[48:51], v[224:239]
    ds_read_b128 a[104:107], v18 offset:49408
    ds_read_b128 a[108:111], v19 offset:49408
    ds_read_b128 a[112:115], v20 offset:49408
    v_mfma_f32_32x32x16_bf16 v[240:255], a[156:159], v[48:51], v[240:255]
    ds_read_b128 a[116:119], v21 offset:49408
    ds_read_b128 a[120:123], v22 offset:49408
    v_mfma_f32_32x32x16_bf16 v[128:143], a[160:163], v[52:55], v[128:143]
    ds_read_b128 a[124:127], v23 offset:49408
    s_add_u32 m0, s56, 81920
    s_add_u32 s58, s59, 147456
    buffer_load_dwordx4 v36, s[28:31], s58 offen lds
    v_mfma_f32_32x32x16_bf16 v[144:159], a[164:167], v[52:55], v[144:159]
    s_add_u32 m0, s56, 82944
    s_add_u32 s58, s59, 148480
    buffer_load_dwordx4 v37, s[28:31], s58 offen lds
    s_add_u32 m0, s56, 83968
    s_add_u32 s58, s59, 149504
    buffer_load_dwordx4 v36, s[28:31], s58 offen lds
    s_add_u32 m0, s56, 84992
    s_add_u32 s58, s59, 150528
    buffer_load_dwordx4 v37, s[28:31], s58 offen lds
    v_mfma_f32_32x32x16_bf16 v[160:175], a[168:171], v[52:55], v[160:175]
    v_max3_f32 v42, v96, v97, v98
    v_max3_f32 v42, v42, v99, v100
    v_mfma_f32_32x32x16_bf16 v[176:191], a[172:175], v[52:55], v[176:191]
    v_max3_f32 v42, v42, v101, v102
    v_max3_f32 v42, v42, v103, v104
    v_max3_f32 v42, v42, v105, v106
    v_mfma_f32_32x32x16_bf16 v[192:207], a[176:179], v[52:55], v[192:207]
    v_max3_f32 v42, v42, v107, v108
    v_max3_f32 v42, v42, v109, v110
    v_mfma_f32_32x32x16_bf16 v[208:223], a[180:183], v[52:55], v[208:223]
    v_max_f32 v42, v42, v111
    v_mov_b32 v43, v42
    s_nop 1
    v_mfma_f32_32x32x16_bf16 v[224:239], a[184:187], v[52:55], v[224:239]
    v_permlane32_swap_b32 v42, v43
    v_max_f32 v42, v42, v43
    v_mfma_f32_32x32x16_bf16 v[240:255], a[188:191], v[52:55], v[240:255]
    v_mul_f32 v42, s55, v42
    v_sub_f32 v43, v42, v40
    v_cmp_gt_f32 vcc, v43, v39
    s_nop 4
    s_cbranch_vccz LA_nr6
    s_nop 15
    v_max_f32 v42, v40, v42
    v_sub_f32 v43, v40, v42
    v_exp_f32 v43, v43
    v_mov_b32 v40, v42
    s_nop 0
    v_mul_f32 v41, v41, v43
    v_mul_f32 v128, v128, v43
    v_mul_f32 v129, v129, v43
    v_mul_f32 v130, v130, v43
    v_mul_f32 v131, v131, v43
    v_mul_f32 v132, v132, v43
    v_mul_f32 v133, v133, v43
    v_mul_f32 v134, v134, v43
    v_mul_f32 v135, v135, v43
    v_mul_f32 v136, v136, v43
    v_mul_f32 v137, v137, v43
    v_mul_f32 v138, v138, v43
    v_mul_f32 v139, v139, v43
    v_mul_f32 v140, v140, v43
    v_mul_f32 v141, v141, v43
    v_mul_f32 v142, v142, v43
    v_mul_f32 v143, v143, v43
    v_mul_f32 v144, v144, v43
    v_mul_f32 v145, v145, v43
    v_mul_f32 v146, v146, v43
    v_mul_f32 v147, v147, v43
    v_mul_f32 v148, v148, v43
    v_mul_f32 v149, v149, v43
    v_mul_f32 v150, v150, v43
    v_mul_f32 v151, v151, v43
    v_mul_f32 v152, v152, v43
    v_mul_f32 v153, v153, v43
    v_mul_f32 v154, v154, v43
    v_mul_f32 v155, v155, v43
    v_mul_f32 v156, v156, v43
    v_mul_f32 v157, v157, v43
    v_mul_f32 v158, v158, v43
    v_mul_f32 v159, v159, v43
    v_mul_f32 v160, v160, v43
    v_mul_f32 v161, v161, v43
    v_mul_f32 v162, v162, v43
    v_mul_f32 v163, v163, v43
    v_mul_f32 v164, v164, v43
    v_mul_f32 v165, v165, v43
    v_mul_f32 v166, v166, v43
    v_mul_f32 v167, v167, v43
    v_mul_f32 v168, v168, v43
    v_mul_f32 v169, v169, v43
    v_mul_f32 v170, v170, v43
    v_mul_f32 v171, v171, v43
    v_mul_f32 v172, v172, v43
    v_mul_f32 v173, v173, v43
    v_mul_f32 v174, v174, v43
    v_mul_f32 v175, v175, v43
    v_mul_f32 v176, v176, v43
    v_mul_f32 v177, v177, v43
    v_mul_f32 v178, v178, v43
    v_mul_f32 v179, v179, v43
    v_mul_f32 v180, v180, v43
    v_mul_f32 v181, v181, v43
    v_mul_f32 v182, v182, v43
    v_mul_f32 v183, v183, v43
    v_mul_f32 v184, v184, v43
    v_mul_f32 v185, v185, v43
    v_mul_f32 v186, v186, v43
    v_mul_f32 v187, v187, v43
    v_mul_f32 v188, v188, v43
    v_mul_f32 v189, v189, v43
    v_mul_f32 v190, v190, v43
    v_mul_f32 v191, v191, v43
    v_mul_f32 v192, v192, v43
    v_mul_f32 v193, v193, v43
    v_mul_f32 v194, v194, v43
    v_mul_f32 v195, v195, v43
    v_mul_f32 v196, v196, v43
    v_mul_f32 v197, v197, v43
    v_mul_f32 v198, v198, v43
    v_mul_f32 v199, v199, v43
    v_mul_f32 v200, v200, v43
    v_mul_f32 v201, v201, v43
    v_mul_f32 v202, v202, v43
    v_mul_f32 v203, v203, v43
    v_mul_f32 v204, v204, v43
    v_mul_f32 v205, v205, v43
    v_mul_f32 v206, v206, v43
    v_mul_f32 v207, v207, v43
    v_mul_f32 v208, v208, v43
    v_mul_f32 v209, v209, v43
    v_mul_f32 v210, v210, v43
    v_mul_f32 v211, v211, v43
    v_mul_f32 v212, v212, v43
    v_mul_f32 v213, v213, v43
    v_mul_f32 v214, v214, v43
    v_mul_f32 v215, v215, v43
    v_mul_f32 v216, v216, v43
    v_mul_f32 v217, v217, v43
    v_mul_f32 v218, v218, v43
    v_mul_f32 v219, v219, v43
    v_mul_f32 v220, v220, v43
    v_mul_f32 v221, v221, v43
    v_mul_f32 v222, v222, v43
    v_mul_f32 v223, v223, v43
    v_mul_f32 v224, v224, v43
    v_mul_f32 v225, v225, v43
    v_mul_f32 v226, v226, v43
    v_mul_f32 v227, v227, v43
    v_mul_f32 v228, v228, v43
    v_mul_f32 v229, v229, v43
    v_mul_f32 v230, v230, v43
    v_mul_f32 v231, v231, v43
    v_mul_f32 v232, v232, v43
    v_mul_f32 v233, v233, v43
    v_mul_f32 v234, v234, v43
    v_mul_f32 v235, v235, v43
    v_mul_f32 v236, v236, v43
    v_mul_f32 v237, v237, v43
    v_mul_f32 v238, v238, v43
    v_mul_f32 v239, v239, v43
    v_mul_f32 v240, v240, v43
    v_mul_f32 v241, v241, v43
    v_mul_f32 v242, v242, v43
    v_mul_f32 v243, v243, v43
    v_mul_f32 v244, v244, v43
    v_mul_f32 v245, v245, v43
    v_mul_f32 v246, v246, v43
    v_mul_f32 v247, v247, v43
    v_mul_f32 v248, v248, v43
    v_mul_f32 v249, v249, v43
    v_mul_f32 v250, v250, v43
    v_mul_f32 v251, v251, v43
    v_mul_f32 v252, v252, v43
    v_mul_f32 v253, v253, v43
    v_mul_f32 v254, v254, v43
    v_mul_f32 v255, v255, v43
LA_nr6:
    s_waitcnt lgkmcnt(15)
    v_mfma_f32_32x32x16_bf16 v[112:127], a[64:67], a[0:3], 0
    v_fma_f32 v96, v96, s55, -v40
    v_fma_f32 v97, v97, s55, -v40
    v_fma_f32 v98, v98, s55, -v40
    v_fma_f32 v99, v99, s55, -v40
    v_fma_f32 v100, v100, s55, -v40
    s_waitcnt lgkmcnt(14)
    v_mfma_f32_32x32x16_bf16 v[112:127], a[68:71], a[4:7], v[112:127]
    v_fma_f32 v101, v101, s55, -v40
    v_fma_f32 v102, v102, s55, -v40
    v_fma_f32 v103, v103, s55, -v40
    v_fma_f32 v104, v104, s55, -v40
    v_fma_f32 v105, v105, s55, -v40
    v_fma_f32 v106, v106, s55, -v40
    s_waitcnt lgkmcnt(13)
    v_mfma_f32_32x32x16_bf16 v[112:127], a[72:75], a[8:11], v[112:127]
    v_fma_f32 v107, v107, s55, -v40
    v_fma_f32 v108, v108, s55, -v40
    v_fma_f32 v109, v109, s55, -v40
    v_fma_f32 v110, v110, s55, -v40
    v_fma_f32 v111, v111, s55, -v40
    s_waitcnt lgkmcnt(12)
    v_mfma_f32_32x32x16_bf16 v[112:127], a[76:79], a[12:15], v[112:127]
    v_exp_f32 v96, v96
    ds_read_b64_tr_b16 a[128:129], v24 offset:32768
    ds_read_b64_tr_b16 a[130:131], v24 offset:36864
    v_exp_f32 v97, v97
    ds_read_b64_tr_b16 a[132:133], v25 offset:32768
    ds_read_b64_tr_b16 a[134:135], v25 offset:36864
    s_waitcnt lgkmcnt(15)
    v_mfma_f32_32x32x16_bf16 v[112:127], a[80:83], a[16:19], v[112:127]
    v_exp_f32 v98, v98
    ds_read_b64_tr_b16 a[136:137], v26 offset:32768
    ds_read_b64_tr_b16 a[138:139], v26 offset:36864
    v_exp_f32 v99, v99
    ds_read_b64_tr_b16 a[140:141], v27 offset:32768
    s_waitcnt lgkmcnt(15)
    v_mfma_f32_32x32x16_bf16 v[112:127], a[84:87], a[20:23], v[112:127]
    ds_read_b64_tr_b16 a[142:143], v27 offset:36864
    v_exp_f32 v100, v100
    ds_read_b64_tr_b16 a[144:145], v24 offset:33024
    ds_read_b64_tr_b16 a[146:147], v24 offset:37120
    v_exp_f32 v101, v101
    ds_read_b64_tr_b16 a[148:149], v25 offset:33024
    s_waitcnt lgkmcnt(15)
    v_mfma_f32_32x32x16_bf16 v[112:127], a[88:91], a[24:27], v[112:127]
    ds_read_b64_tr_b16 a[150:151], v25 offset:37120
    v_exp_f32 v102, v102
    ds_read_b64_tr_b16 a[152:153], v26 offset:33024
    ds_read_b64_tr_b16 a[154:155], v26 offset:37120
    v_exp_f32 v103, v103
    s_waitcnt lgkmcnt(15)
    v_mfma_f32_32x32x16_bf16 v[112:127], a[92:95], a[28:31], v[112:127]
    ds_read_b64_tr_b16 a[156:157], v27 offset:33024
    ds_read_b64_tr_b16 a[158:159], v27 offset:37120
    v_exp_f32 v104, v104
    ds_read_b64_tr_b16 a[160:161], v24 offset:40960
    ds_read_b64_tr_b16 a[162:163], v24 offset:45056
    v_exp_f32 v105, v105
    s_waitcnt lgkmcnt(15)
    v_mfma_f32_32x32x16_bf16 v[112:127], a[96:99], a[32:35], v[112:127]
    ds_read_b64_tr_b16 a[164:165], v25 offset:40960
    ds_read_b64_tr_b16 a[166:167], v25 offset:45056
    v_exp_f32 v106, v106
    ds_read_b64_tr_b16 a[168:169], v26 offset:40960
    ds_read_b64_tr_b16 a[170:171], v26 offset:45056
    s_waitcnt lgkmcnt(15)
    v_mfma_f32_32x32x16_bf16 v[112:127], a[100:103], a[36:39], v[112:127]
    v_exp_f32 v107, v107
    ds_read_b64_tr_b16 a[172:173], v27 offset:40960
    ds_read_b64_tr_b16 a[174:175], v27 offset:45056
    v_exp_f32 v108, v108
    ds_read_b64_tr_b16 a[176:177], v24 offset:41216
    ds_read_b64_tr_b16 a[178:179], v24 offset:45312
    s_waitcnt lgkmcnt(15)
    v_mfma_f32_32x32x16_bf16 v[112:127], a[104:107], a[40:43], v[112:127]
    v_exp_f32 v109, v109
    ds_read_b64_tr_b16 a[180:181], v25 offset:41216
    ds_read_b64_tr_b16 a[182:183], v25 offset:45312
    v_exp_f32 v110, v110
    ds_read_b64_tr_b16 a[184:185], v26 offset:41216
    s_waitcnt lgkmcnt(15)
    v_mfma_f32_32x32x16_bf16 v[112:127], a[108:111], a[44:47], v[112:127]
    ds_read_b64_tr_b16 a[186:187], v26 offset:45312
    v_exp_f32 v111, v111
    ds_read_b64_tr_b16 a[188:189], v27 offset:41216
    ds_read_b64_tr_b16 a[190:191], v27 offset:45312
    v_add_f32 v41, v41, v96
    v_add_f32 v41, v41, v97
    s_waitcnt lgkmcnt(15)
    v_mfma_f32_32x32x16_bf16 v[112:127], a[112:115], a[48:51], v[112:127]
    v_add_f32 v41, v41, v98
    v_add_f32 v41, v41, v99
    v_add_f32 v41, v41, v100
    v_add_f32 v41, v41, v101
    v_add_f32 v41, v41, v102
    s_waitcnt lgkmcnt(15)
    v_mfma_f32_32x32x16_bf16 v[112:127], a[116:119], a[52:55], v[112:127]
    v_add_f32 v41, v41, v103
    v_add_f32 v41, v41, v104
    v_add_f32 v41, v41, v105
    v_add_f32 v41, v41, v106
    v_add_f32 v41, v41, v107
    v_add_f32 v41, v41, v108
    s_waitcnt lgkmcnt(15)
    v_mfma_f32_32x32x16_bf16 v[112:127], a[120:123], a[56:59], v[112:127]
    v_add_f32 v41, v41, v109
    v_add_f32 v41, v41, v110
    v_add_f32 v41, v41, v111
    v_cvt_pk_bf16_f32 v48, v96, v97
    v_cvt_pk_bf16_f32 v49, v98, v99
    s_waitcnt lgkmcnt(15)
    v_mfma_f32_32x32x16_bf16 v[112:127], a[124:127], a[60:63], v[112:127]
    v_cvt_pk_bf16_f32 v50, v100, v101
    v_cvt_pk_bf16_f32 v51, v102, v103
    v_cvt_pk_bf16_f32 v52, v104, v105
    v_cvt_pk_bf16_f32 v53, v106, v107
    v_cvt_pk_bf16_f32 v54, v108, v109
    v_cvt_pk_bf16_f32 v55, v110, v111
    s_waitcnt vmcnt(20)
    s_waitcnt vmcnt(16)
    s_barrier
    s_waitcnt lgkmcnt(0)
    v_mfma_f32_32x32x16_bf16 v[128:143], a[128:131], v[48:51], v[128:143]
    s_add_u32 m0, s56, 49152
    s_add_u32 s58, s57, 180224
    buffer_load_dwordx4 v28, s[24:27], s58 offen lds
    s_add_u32 m0, s56, 50176
    s_add_u32 s58, s57, 180224
    buffer_load_dwordx4 v29, s[24:27], s58 offen lds
    v_mfma_f32_32x32x16_bf16 v[144:159], a[132:135], v[48:51], v[144:159]
    s_add_u32 m0, s56, 51200
    s_add_u32 s58, s57, 180224
    buffer_load_dwordx4 v30, s[24:27], s58 offen lds
    s_add_u32 m0, s56, 52224
    s_add_u32 s58, s57, 180224
    buffer_load_dwordx4 v31, s[24:27], s58 offen lds
    v_mfma_f32_32x32x16_bf16 v[160:175], a[136:139], v[48:51], v[160:175]
    ds_read_b128 a[64:67], v16 offset:0
    ds_read_b128 a[68:71], v17 offset:0
    ds_read_b128 a[72:75], v18 offset:0
    v_mfma_f32_32x32x16_bf16 v[176:191], a[140:143], v[48:51], v[176:191]
    ds_read_b128 a[76:79], v19 offset:0
    ds_read_b128 a[80:83], v20 offset:0
    v_mfma_f32_32x32x16_bf16 v[192:207], a[144:147], v[48:51], v[192:207]
    ds_read_b128 a[84:87], v21 offset:0
    ds_read_b128 a[88:91], v22 offset:0
    ds_read_b128 a[92:95], v23 offset:0
    v_mfma_f32_32x32x16_bf16 v[208:223], a[148:151], v[48:51], v[208:223]
    ds_read_b128 a[96:99], v16 offset:256
    ds_read_b128 a[100:103], v17 offset:256
    v_mfma_f32_32x32x16_bf16 v[224:239], a[152:155], v[48:51], v[224:239]
    ds_read_b128 a[104:107], v18 offset:256
    ds_read_b128 a[108:111], v19 offset:256
    ds_read_b128 a[112:115], v20 offset:256
    v_mfma_f32_32x32x16_bf16 v[240:255], a[156:159], v[48:51], v[240:255]
    ds_read_b128 a[116:119], v21 offset:256
    ds_read_b128 a[120:123], v22 offset:256
    v_mfma_f32_32x32x16_bf16 v[128:143], a[160:163], v[52:55], v[128:143]
    ds_read_b128 a[124:127], v23 offset:256
    s_add_u32 m0, s56, 98304
    s_add_u32 s58, s59, 163840
    buffer_load_dwordx4 v36, s[28:31], s58 offen lds
    v_mfma_f32_32x32x16_bf16 v[144:159], a[164:167], v[52:55], v[144:159]
    s_add_u32 m0, s56, 99328
    s_add_u32 s58, s59, 164864
    buffer_load_dwordx4 v37, s[28:31], s58 offen lds
    s_add_u32 m0, s56, 100352
    s_add_u32 s58, s59, 165888
    buffer_load_dwordx4 v36, s[28:31], s58 offen lds
    s_add_u32 m0, s56, 101376
    s_add_u32 s58, s59, 166912
    buffer_load_dwordx4 v37, s[28:31], s58 offen lds
    v_mfma_f32_32x32x16_bf16 v[160:175], a[168:171], v[52:55], v[160:175]
    v_max3_f32 v42, v112, v113, v114
    v_max3_f32 v42, v42, v115, v116
    v_mfma_f32_32x32x16_bf16 v[176:191], a[172:175], v[52:55], v[176:191]
    v_max3_f32 v42, v42, v117, v118
    v_max3_f32 v42, v42, v119, v120
    v_max3_f32 v42, v42, v121, v122
    v_mfma_f32_32x32x16_bf16 v[192:207], a[176:179], v[52:55], v[192:207]
    v_max3_f32 v42, v42, v123, v124
    v_max3_f32 v42, v42, v125, v126
    v_mfma_f32_32x32x16_bf16 v[208:223], a[180:183], v[52:55], v[208:223]
    v_max_f32 v42, v42, v127
    v_mov_b32 v43, v42
    s_nop 1
    v_mfma_f32_32x32x16_bf16 v[224:239], a[184:187], v[52:55], v[224:239]
    v_permlane32_swap_b32 v42, v43
    v_max_f32 v42, v42, v43
    v_mfma_f32_32x32x16_bf16 v[240:255], a[188:191], v[52:55], v[240:255]
    v_mul_f32 v42, s55, v42
    v_sub_f32 v43, v42, v40
    v_cmp_gt_f32 vcc, v43, v39
    s_nop 4
    s_cbranch_vccz LA_nr7
    s_nop 15
    v_max_f32 v42, v40, v42
    v_sub_f32 v43, v40, v42
    v_exp_f32 v43, v43
    v_mov_b32 v40, v42
    s_nop 0
    v_mul_f32 v41, v41, v43
    v_mul_f32 v128, v128, v43
    v_mul_f32 v129, v129, v43
    v_mul_f32 v130, v130, v43
    v_mul_f32 v131, v131, v43
    v_mul_f32 v132, v132, v43
    v_mul_f32 v133, v133, v43
    v_mul_f32 v134, v134, v43
    v_mul_f32 v135, v135, v43
    v_mul_f32 v136, v136, v43
    v_mul_f32 v137, v137, v43
    v_mul_f32 v138, v138, v43
    v_mul_f32 v139, v139, v43
    v_mul_f32 v140, v140, v43
    v_mul_f32 v141, v141, v43
    v_mul_f32 v142, v142, v43
    v_mul_f32 v143, v143, v43
    v_mul_f32 v144, v144, v43
    v_mul_f32 v145, v145, v43
    v_mul_f32 v146, v146, v43
    v_mul_f32 v147, v147, v43
    v_mul_f32 v148, v148, v43
    v_mul_f32 v149, v149, v43
    v_mul_f32 v150, v150, v43
    v_mul_f32 v151, v151, v43
    v_mul_f32 v152, v152, v43
    v_mul_f32 v153, v153, v43
    v_mul_f32 v154, v154, v43
    v_mul_f32 v155, v155, v43
    v_mul_f32 v156, v156, v43
    v_mul_f32 v157, v157, v43
    v_mul_f32 v158, v158, v43
    v_mul_f32 v159, v159, v43
    v_mul_f32 v160, v160, v43
    v_mul_f32 v161, v161, v43
    v_mul_f32 v162, v162, v43
    v_mul_f32 v163, v163, v43
    v_mul_f32 v164, v164, v43
    v_mul_f32 v165, v165, v43
    v_mul_f32 v166, v166, v43
    v_mul_f32 v167, v167, v43
    v_mul_f32 v168, v168, v43
    v_mul_f32 v169, v169, v43
    v_mul_f32 v170, v170, v43
    v_mul_f32 v171, v171, v43
    v_mul_f32 v172, v172, v43
    v_mul_f32 v173, v173, v43
    v_mul_f32 v174, v174, v43
    v_mul_f32 v175, v175, v43
    v_mul_f32 v176, v176, v43
    v_mul_f32 v177, v177, v43
    v_mul_f32 v178, v178, v43
    v_mul_f32 v179, v179, v43
    v_mul_f32 v180, v180, v43
    v_mul_f32 v181, v181, v43
    v_mul_f32 v182, v182, v43
    v_mul_f32 v183, v183, v43
    v_mul_f32 v184, v184, v43
    v_mul_f32 v185, v185, v43
    v_mul_f32 v186, v186, v43
    v_mul_f32 v187, v187, v43
    v_mul_f32 v188, v188, v43
    v_mul_f32 v189, v189, v43
    v_mul_f32 v190, v190, v43
    v_mul_f32 v191, v191, v43
    v_mul_f32 v192, v192, v43
    v_mul_f32 v193, v193, v43
    v_mul_f32 v194, v194, v43
    v_mul_f32 v195, v195, v43
    v_mul_f32 v196, v196, v43
    v_mul_f32 v197, v197, v43
    v_mul_f32 v198, v198, v43
    v_mul_f32 v199, v199, v43
    v_mul_f32 v200, v200, v43
    v_mul_f32 v201, v201, v43
    v_mul_f32 v202, v202, v43
    v_mul_f32 v203, v203, v43
    v_mul_f32 v204, v204, v43
    v_mul_f32 v205, v205, v43
    v_mul_f32 v206, v206, v43
    v_mul_f32 v207, v207, v43
    v_mul_f32 v208, v208, v43
    v_mul_f32 v209, v209, v43
    v_mul_f32 v210, v210, v43
    v_mul_f32 v211, v211, v43
    v_mul_f32 v212, v212, v43
    v_mul_f32 v213, v213, v43
    v_mul_f32 v214, v214, v43
    v_mul_f32 v215, v215, v43
    v_mul_f32 v216, v216, v43
    v_mul_f32 v217, v217, v43
    v_mul_f32 v218, v218, v43
    v_mul_f32 v219, v219, v43
    v_mul_f32 v220, v220, v43
    v_mul_f32 v221, v221, v43
    v_mul_f32 v222, v222, v43
    v_mul_f32 v223, v223, v43
    v_mul_f32 v224, v224, v43
    v_mul_f32 v225, v225, v43
    v_mul_f32 v226, v226, v43
    v_mul_f32 v227, v227, v43
    v_mul_f32 v228, v228, v43
    v_mul_f32 v229, v229, v43
    v_mul_f32 v230, v230, v43
    v_mul_f32 v231, v231, v43
    v_mul_f32 v232, v232, v43
    v_mul_f32 v233, v233, v43
    v_mul_f32 v234, v234, v43
    v_mul_f32 v235, v235, v43
    v_mul_f32 v236, v236, v43
    v_mul_f32 v237, v237, v43
    v_mul_f32 v238, v238, v43
    v_mul_f32 v239, v239, v43
    v_mul_f32 v240, v240, v43
    v_mul_f32 v241, v241, v43
    v_mul_f32 v242, v242, v43
    v_mul_f32 v243, v243, v43
    v_mul_f32 v244, v244, v43
    v_mul_f32 v245, v245, v43
    v_mul_f32 v246, v246, v43
    v_mul_f32 v247, v247, v43
    v_mul_f32 v248, v248, v43
    v_mul_f32 v249, v249, v43
    v_mul_f32 v250, v250, v43
    v_mul_f32 v251, v251, v43
    v_mul_f32 v252, v252, v43
    v_mul_f32 v253, v253, v43
    v_mul_f32 v254, v254, v43
    v_mul_f32 v255, v255, v43
LA_nr7:
    s_waitcnt lgkmcnt(15)
    v_mfma_f32_32x32x16_bf16 v[96:111], a[64:67], a[0:3], 0
    v_fma_f32 v112, v112, s55, -v40
    v_fma_f32 v113, v113, s55, -v40
    v_fma_f32 v114, v114, s55, -v40
    v_fma_f32 v115, v115, s55, -v40
    v_fma_f32 v116, v116, s55, -v40
    s_waitcnt lgkmcnt(14)
    v_mfma_f32_32x32x16_bf16 v[96:111], a[68:71], a[4:7], v[96:111]
    v_fma_f32 v117, v117, s55, -v40
    v_fma_f32 v118, v118, s55, -v40
    v_fma_f32 v119, v119, s55, -v40
    v_fma_f32 v120, v120, s55, -v40
    v_fma_f32 v121, v121, s55, -v40
    v_fma_f32 v122, v122, s55, -v40
    s_waitcnt lgkmcnt(13)
    v_mfma_f32_32x32x16_bf16 v[96:111], a[72:75], a[8:11], v[96:111]
    v_fma_f32 v123, v123, s55, -v40
    v_fma_f32 v124, v124, s55, -v40
    v_fma_f32 v125, v125, s55, -v40
    v_fma_f32 v126, v126, s55, -v40
    v_fma_f32 v127, v127, s55, -v40
    s_waitcnt lgkmcnt(12)
    v_mfma_f32_32x32x16_bf16 v[96:111], a[76:79], a[12:15], v[96:111]
    v_exp_f32 v112, v112
    ds_read_b64_tr_b16 a[128:129], v24 offset:49152
    ds_read_b64_tr_b16 a[130:131], v24 offset:53248
    v_exp_f32 v113, v113
    ds_read_b64_tr_b16 a[132:133], v25 offset:49152
    ds_read_b64_tr_b16 a[134:135], v25 offset:53248
    s_waitcnt lgkmcnt(15)
    v_mfma_f32_32x32x16_bf16 v[96:111], a[80:83], a[16:19], v[96:111]
    v_exp_f32 v114, v114
    ds_read_b64_tr_b16 a[136:137], v26 offset:49152
    ds_read_b64_tr_b16 a[138:139], v26 offset:53248
    v_exp_f32 v115, v115
    ds_read_b64_tr_b16 a[140:141], v27 offset:49152
    s_waitcnt lgkmcnt(15)
    v_mfma_f32_32x32x16_bf16 v[96:111], a[84:87], a[20:23], v[96:111]
    ds_read_b64_tr_b16 a[142:143], v27 offset:53248
    v_exp_f32 v116, v116
    ds_read_b64_tr_b16 a[144:145], v24 offset:49408
    ds_read_b64_tr_b16 a[146:147], v24 offset:53504
    v_exp_f32 v117, v117
    ds_read_b64_tr_b16 a[148:149], v25 offset:49408
    s_waitcnt lgkmcnt(15)
    v_mfma_f32_32x32x16_bf16 v[96:111], a[88:91], a[24:27], v[96:111]
    ds_read_b64_tr_b16 a[150:151], v25 offset:53504
    v_exp_f32 v118, v118
    ds_read_b64_tr_b16 a[152:153], v26 offset:49408
    ds_read_b64_tr_b16 a[154:155], v26 offset:53504
    v_exp_f32 v119, v119
    s_waitcnt lgkmcnt(15)
    v_mfma_f32_32x32x16_bf16 v[96:111], a[92:95], a[28:31], v[96:111]
    ds_read_b64_tr_b16 a[156:157], v27 offset:49408
    ds_read_b64_tr_b16 a[158:159], v27 offset:53504
    v_exp_f32 v120, v120
    ds_read_b64_tr_b16 a[160:161], v24 offset:57344
    ds_read_b64_tr_b16 a[162:163], v24 offset:61440
    v_exp_f32 v121, v121
    s_waitcnt lgkmcnt(15)
    v_mfma_f32_32x32x16_bf16 v[96:111], a[96:99], a[32:35], v[96:111]
    ds_read_b64_tr_b16 a[164:165], v25 offset:57344
    ds_read_b64_tr_b16 a[166:167], v25 offset:61440
    v_exp_f32 v122, v122
    ds_read_b64_tr_b16 a[168:169], v26 offset:57344
    ds_read_b64_tr_b16 a[170:171], v26 offset:61440
    s_waitcnt lgkmcnt(15)
    v_mfma_f32_32x32x16_bf16 v[96:111], a[100:103], a[36:39], v[96:111]
    v_exp_f32 v123, v123
    ds_read_b64_tr_b16 a[172:173], v27 offset:57344
    ds_read_b64_tr_b16 a[174:175], v27 offset:61440
    v_exp_f32 v124, v124
    ds_read_b64_tr_b16 a[176:177], v24 offset:57600
    ds_read_b64_tr_b16 a[178:179], v24 offset:61696
    s_waitcnt lgkmcnt(15)
    v_mfma_f32_32x32x16_bf16 v[96:111], a[104:107], a[40:43], v[96:111]
    v_exp_f32 v125, v125
    ds_read_b64_tr_b16 a[180:181], v25 offset:57600
    ds_read_b64_tr_b16 a[182:183], v25 offset:61696
    v_exp_f32 v126, v126
    ds_read_b64_tr_b16 a[184:185], v26 offset:57600
    s_waitcnt lgkmcnt(15)
    v_mfma_f32_32x32x16_bf16 v[96:111], a[108:111], a[44:47], v[96:111]
    ds_read_b64_tr_b16 a[186:187], v26 offset:61696
    v_exp_f32 v127, v127
    ds_read_b64_tr_b16 a[188:189], v27 offset:57600
    ds_read_b64_tr_b16 a[190:191], v27 offset:61696
    v_add_f32 v41, v41, v112
    v_add_f32 v41, v41, v113
    s_waitcnt lgkmcnt(15)
    v_mfma_f32_32x32x16_bf16 v[96:111], a[112:115], a[48:51], v[96:111]
    v_add_f32 v41, v41, v114
    v_add_f32 v41, v41, v115
    v_add_f32 v41, v41, v116
    v_add_f32 v41, v41, v117
    v_add_f32 v41, v41, v118
    s_waitcnt lgkmcnt(15)
    v_mfma_f32_32x32x16_bf16 v[96:111], a[116:119], a[52:55], v[96:111]
    v_add_f32 v41, v41, v119
    v_add_f32 v41, v41, v120
    v_add_f32 v41, v41, v121
    v_add_f32 v41, v41, v122
    v_add_f32 v41, v41, v123
    v_add_f32 v41, v41, v124
    s_waitcnt lgkmcnt(15)
    v_mfma_f32_32x32x16_bf16 v[96:111], a[120:123], a[56:59], v[96:111]
    v_add_f32 v41, v41, v125
    v_add_f32 v41, v41, v126
    v_add_f32 v41, v41, v127
    v_cvt_pk_bf16_f32 v48, v112, v113
    v_cvt_pk_bf16_f32 v49, v114, v115
    s_waitcnt lgkmcnt(15)
    v_mfma_f32_32x32x16_bf16 v[96:111], a[124:127], a[60:63], v[96:111]
    v_cvt_pk_bf16_f32 v50, v116, v117
    v_cvt_pk_bf16_f32 v51, v118, v119
    v_cvt_pk_bf16_f32 v52, v120, v121
    v_cvt_pk_bf16_f32 v53, v122, v123
    v_cvt_pk_bf16_f32 v54, v124, v125
    v_cvt_pk_bf16_f32 v55, v126, v127
    s_add_u32 s57, s57, 65536
    s_add_u32 s59, s59, 65536
    s_add_u32 s43, s43, 1
    s_cmp_lt_u32 s43, 2
    s_cbranch_scc1 LA_loop
    s_waitcnt vmcnt(20)
    s_waitcnt vmcnt(16)
    s_barrier
    s_waitcnt lgkmcnt(0)
    v_mfma_f32_32x32x16_bf16 v[128:143], a[128:131], v[48:51], v[128:143]
    ds_read_b128 a[64:67], v16 offset:16384
    ds_read_b128 a[68:71], v17 offset:16384
    v_mfma_f32_32x32x16_bf16 v[144:159], a[132:135], v[48:51], v[144:159]
    ds_read_b128 a[72:75], v18 offset:16384
    ds_read_b128 a[76:79], v19 offset:16384
    v_mfma_f32_32x32x16_bf16 v[160:175], a[136:139], v[48:51], v[160:175]
    ds_read_b128 a[80:83], v20 offset:16384
    ds_read_b128 a[84:87], v21 offset:16384
    v_mfma_f32_32x32x16_bf16 v[176:191], a[140:143], v[48:51], v[176:191]
    ds_read_b128 a[88:91], v22 offset:16384
    ds_read_b128 a[92:95], v23 offset:16384
    v_mfma_f32_32x32x16_bf16 v[192:207], a[144:147], v[48:51], v[192:207]
    ds_read_b128 a[96:99], v16 offset:16640
    ds_read_b128 a[100:103], v17 offset:16640
    v_mfma_f32_32x32x16_bf16 v[208:223], a[148:151], v[48:51], v[208:223]
    ds_read_b128 a[104:107], v18 offset:16640
    ds_read_b128 a[108:111], v19 offset:16640
    ds_read_b128 a[112:115], v20 offset:16640
    v_mfma_f32_32x32x16_bf16 v[224:239], a[152:155], v[48:51], v[224:239]
    ds_read_b128 a[116:119], v21 offset:16640
    ds_read_b128 a[120:123], v22 offset:16640
    v_mfma_f32_32x32x16_bf16 v[240:255], a[156:159], v[48:51], v[240:255]
    ds_read_b128 a[124:127], v23 offset:16640
    s_add_u32 m0, s56, 114688
    s_add_u32 s58, s59, 114688
    buffer_load_dwordx4 v36, s[28:31], s58 offen lds
    v_mfma_f32_32x32x16_bf16 v[128:143], a[160:163], v[52:55], v[128:143]
    s_add_u32 m0, s56, 115712
    s_add_u32 s58, s59, 115712
    buffer_load_dwordx4 v37, s[28:31], s58 offen lds
    s_add_u32 m0, s56, 116736
    s_add_u32 s58, s59, 116736
    buffer_load_dwordx4 v36, s[28:31], s58 offen lds
    v_mfma_f32_32x32x16_bf16 v[144:159], a[164:167], v[52:55], v[144:159]
    s_add_u32 m0, s56, 117760
    s_add_u32 s58, s59, 117760
    buffer_load_dwordx4 v37, s[28:31], s58 offen lds
    v_max3_f32 v42, v96, v97, v98
    v_mfma_f32_32x32x16_bf16 v[160:175], a[168:171], v[52:55], v[160:175]
    v_max3_f32 v42, v42, v99, v100
    v_max3_f32 v42, v42, v101, v102
    v_max3_f32 v42, v42, v103, v104
    v_mfma_f32_32x32x16_bf16 v[176:191], a[172:175], v[52:55], v[176:191]
    v_max3_f32 v42, v42, v105, v106
    v_max3_f32 v42, v42, v107, v108
    v_mfma_f32_32x32x16_bf16 v[192:207], a[176:179], v[52:55], v[192:207]
    v_max3_f32 v42, v42, v109, v110
    v_max_f32 v42, v42, v111
    v_mfma_f32_32x32x16_bf16 v[208:223], a[180:183], v[52:55], v[208:223]
    v_mov_b32 v43, v42
    s_nop 1
    v_mfma_f32_32x32x16_bf16 v[224:239], a[184:187], v[52:55], v[224:239]
    v_permlane32_swap_b32 v42, v43
    v_max_f32 v42, v42, v43
    v_mfma_f32_32x32x16_bf16 v[240:255], a[188:191], v[52:55], v[240:255]
    v_mul_f32 v42, s55, v42
    v_sub_f32 v43, v42, v40
    v_cmp_gt_f32 vcc, v43, v39
    s_nop 4
    s_cbranch_vccz LA_nr12
    s_nop 15
    v_max_f32 v42, v40, v42
    v_sub_f32 v43, v40, v42
    v_exp_f32 v43, v43
    v_mov_b32 v40, v42
    s_nop 0
    v_mul_f32 v41, v41, v43
    v_mul_f32 v128, v128, v43
    v_mul_f32 v129, v129, v43
    v_mul_f32 v130, v130, v43
    v_mul_f32 v131, v131, v43
    v_mul_f32 v132, v132, v43
    v_mul_f32 v133, v133, v43
    v_mul_f32 v134, v134, v43
    v_mul_f32 v135, v135, v43
    v_mul_f32 v136, v136, v43
    v_mul_f32 v137, v137, v43
    v_mul_f32 v138, v138, v43
    v_mul_f32 v139, v139, v43
    v_mul_f32 v140, v140, v43
    v_mul_f32 v141, v141, v43
    v_mul_f32 v142, v142, v43
    v_mul_f32 v143, v143, v43
    v_mul_f32 v144, v144, v43
    v_mul_f32 v145, v145, v43
    v_mul_f32 v146, v146, v43
    v_mul_f32 v147, v147, v43
    v_mul_f32 v148, v148, v43
    v_mul_f32 v149, v149, v43
    v_mul_f32 v150, v150, v43
    v_mul_f32 v151, v151, v43
    v_mul_f32 v152, v152, v43
    v_mul_f32 v153, v153, v43
    v_mul_f32 v154, v154, v43
    v_mul_f32 v155, v155, v43
    v_mul_f32 v156, v156, v43
    v_mul_f32 v157, v157, v43
    v_mul_f32 v158, v158, v43
    v_mul_f32 v159, v159, v43
    v_mul_f32 v160, v160, v43
    v_mul_f32 v161, v161, v43
    v_mul_f32 v162, v162, v43
    v_mul_f32 v163, v163, v43
    v_mul_f32 v164, v164, v43
    v_mul_f32 v165, v165, v43
    v_mul_f32 v166, v166, v43
    v_mul_f32 v167, v167, v43
    v_mul_f32 v168, v168, v43
    v_mul_f32 v169, v169, v43
    v_mul_f32 v170, v170, v43
    v_mul_f32 v171, v171, v43
    v_mul_f32 v172, v172, v43
    v_mul_f32 v173, v173, v43
    v_mul_f32 v174, v174, v43
    v_mul_f32 v175, v175, v43
    v_mul_f32 v176, v176, v43
    v_mul_f32 v177, v177, v43
    v_mul_f32 v178, v178, v43
    v_mul_f32 v179, v179, v43
    v_mul_f32 v180, v180, v43
    v_mul_f32 v181, v181, v43
    v_mul_f32 v182, v182, v43
    v_mul_f32 v183, v183, v43
    v_mul_f32 v184, v184, v43
    v_mul_f32 v185, v185, v43
    v_mul_f32 v186, v186, v43
    v_mul_f32 v187, v187, v43
    v_mul_f32 v188, v188, v43
    v_mul_f32 v189, v189, v43
    v_mul_f32 v190, v190, v43
    v_mul_f32 v191, v191, v43
    v_mul_f32 v192, v192, v43
    v_mul_f32 v193, v193, v43
    v_mul_f32 v194, v194, v43
    v_mul_f32 v195, v195, v43
    v_mul_f32 v196, v196, v43
    v_mul_f32 v197, v197, v43
    v_mul_f32 v198, v198, v43
    v_mul_f32 v199, v199, v43
    v_mul_f32 v200, v200, v43
    v_mul_f32 v201, v201, v43
    v_mul_f32 v202, v202, v43
    v_mul_f32 v203, v203, v43
    v_mul_f32 v204, v204, v43
    v_mul_f32 v205, v205, v43
    v_mul_f32 v206, v206, v43
    v_mul_f32 v207, v207, v43
    v_mul_f32 v208, v208, v43
    v_mul_f32 v209, v209, v43
    v_mul_f32 v210, v210, v43
    v_mul_f32 v211, v211, v43
    v_mul_f32 v212, v212, v43
    v_mul_f32 v213, v213, v43
    v_mul_f32 v214, v214, v43
    v_mul_f32 v215, v215, v43
    v_mul_f32 v216, v216, v43
    v_mul_f32 v217, v217, v43
    v_mul_f32 v218, v218, v43
    v_mul_f32 v219, v219, v43
    v_mul_f32 v220, v220, v43
    v_mul_f32 v221, v221, v43
    v_mul_f32 v222, v222, v43
    v_mul_f32 v223, v223, v43
    v_mul_f32 v224, v224, v43
    v_mul_f32 v225, v225, v43
    v_mul_f32 v226, v226, v43
    v_mul_f32 v227, v227, v43
    v_mul_f32 v228, v228, v43
    v_mul_f32 v229, v229, v43
    v_mul_f32 v230, v230, v43
    v_mul_f32 v231, v231, v43
    v_mul_f32 v232, v232, v43
    v_mul_f32 v233, v233, v43
    v_mul_f32 v234, v234, v43
    v_mul_f32 v235, v235, v43
    v_mul_f32 v236, v236, v43
    v_mul_f32 v237, v237, v43
    v_mul_f32 v238, v238, v43
    v_mul_f32 v239, v239, v43
    v_mul_f32 v240, v240, v43
    v_mul_f32 v241, v241, v43
    v_mul_f32 v242, v242, v43
    v_mul_f32 v243, v243, v43
    v_mul_f32 v244, v244, v43
    v_mul_f32 v245, v245, v43
    v_mul_f32 v246, v246, v43
    v_mul_f32 v247, v247, v43
    v_mul_f32 v248, v248, v43
    v_mul_f32 v249, v249, v43
    v_mul_f32 v250, v250, v43
    v_mul_f32 v251, v251, v43
    v_mul_f32 v252, v252, v43
    v_mul_f32 v253, v253, v43
    v_mul_f32 v254, v254, v43
    v_mul_f32 v255, v255, v43
LA_nr12:
    s_waitcnt lgkmcnt(15)
    v_mfma_f32_32x32x16_bf16 v[112:127], a[64:67], a[0:3], 0
    v_fma_f32 v96, v96, s55, -v40
    v_fma_f32 v97, v97, s55, -v40
    v_fma_f32 v98, v98, s55, -v40
    v_fma_f32 v99, v99, s55, -v40
    v_fma_f32 v100, v100, s55, -v40
    s_waitcnt lgkmcnt(14)
    v_mfma_f32_32x32x16_bf16 v[112:127], a[68:71], a[4:7], v[112:127]
    v_fma_f32 v101, v101, s55, -v40
    v_fma_f32 v102, v102, s55, -v40
    v_fma_f32 v103, v103, s55, -v40
    v_fma_f32 v104, v104, s55, -v40
    v_fma_f32 v105, v105, s55, -v40
    v_fma_f32 v106, v106, s55, -v40
    s_waitcnt lgkmcnt(13)
    v_mfma_f32_32x32x16_bf16 v[112:127], a[72:75], a[8:11], v[112:127]
    v_fma_f32 v107, v107, s55, -v40
    v_fma_f32 v108, v108, s55, -v40
    v_fma_f32 v109, v109, s55, -v40
    v_fma_f32 v110, v110, s55, -v40
    v_fma_f32 v111, v111, s55, -v40
    s_waitcnt lgkmcnt(12)
    v_mfma_f32_32x32x16_bf16 v[112:127], a[76:79], a[12:15], v[112:127]
    v_exp_f32 v96, v96
    ds_read_b64_tr_b16 a[128:129], v24 offset:0
    ds_read_b64_tr_b16 a[130:131], v24 offset:4096
    v_exp_f32 v97, v97
    ds_read_b64_tr_b16 a[132:133], v25 offset:0
    ds_read_b64_tr_b16 a[134:135], v25 offset:4096
    s_waitcnt lgkmcnt(15)
    v_mfma_f32_32x32x16_bf16 v[112:127], a[80:83], a[16:19], v[112:127]
    v_exp_f32 v98, v98
    ds_read_b64_tr_b16 a[136:137], v26 offset:0
    ds_read_b64_tr_b16 a[138:139], v26 offset:4096
    v_exp_f32 v99, v99
    ds_read_b64_tr_b16 a[140:141], v27 offset:0
    s_waitcnt lgkmcnt(15)
    v_mfma_f32_32x32x16_bf16 v[112:127], a[84:87], a[20:23], v[112:127]
    ds_read_b64_tr_b16 a[142:143], v27 offset:4096
    v_exp_f32 v100, v100
    ds_read_b64_tr_b16 a[144:145], v24 offset:256
    ds_read_b64_tr_b16 a[146:147], v24 offset:4352
    v_exp_f32 v101, v101
    ds_read_b64_tr_b16 a[148:149], v25 offset:256
    s_waitcnt lgkmcnt(15)
    v_mfma_f32_32x32x16_bf16 v[112:127], a[88:91], a[24:27], v[112:127]
    ds_read_b64_tr_b16 a[150:151], v25 offset:4352
    v_exp_f32 v102, v102
    ds_read_b64_tr_b16 a[152:153], v26 offset:256
    ds_read_b64_tr_b16 a[154:155], v26 offset:4352
    v_exp_f32 v103, v103
    s_waitcnt lgkmcnt(15)
    v_mfma_f32_32x32x16_bf16 v[112:127], a[92:95], a[28:31], v[112:127]
    ds_read_b64_tr_b16 a[156:157], v27 offset:256
    ds_read_b64_tr_b16 a[158:159], v27 offset:4352
    v_exp_f32 v104, v104
    ds_read_b64_tr_b16 a[160:161], v24 offset:8192
    ds_read_b64_tr_b16 a[162:163], v24 offset:12288
    v_exp_f32 v105, v105
    s_waitcnt lgkmcnt(15)
    v_mfma_f32_32x32x16_bf16 v[112:127], a[96:99], a[32:35], v[112:127]
    ds_read_b64_tr_b16 a[164:165], v25 offset:8192
    ds_read_b64_tr_b16 a[166:167], v25 offset:12288
    v_exp_f32 v106, v106
    ds_read_b64_tr_b16 a[168:169], v26 offset:8192
    ds_read_b64_tr_b16 a[170:171], v26 offset:12288
    s_waitcnt lgkmcnt(15)
    v_mfma_f32_32x32x16_bf16 v[112:127], a[100:103], a[36:39], v[112:127]
    v_exp_f32 v107, v107
    ds_read_b64_tr_b16 a[172:173], v27 offset:8192
    ds_read_b64_tr_b16 a[174:175], v27 offset:12288
    v_exp_f32 v108, v108
    ds_read_b64_tr_b16 a[176:177], v24 offset:8448
    ds_read_b64_tr_b16 a[178:179], v24 offset:12544
    s_waitcnt lgkmcnt(15)
    v_mfma_f32_32x32x16_bf16 v[112:127], a[104:107], a[40:43], v[112:127]
    v_exp_f32 v109, v109
    ds_read_b64_tr_b16 a[180:181], v25 offset:8448
    ds_read_b64_tr_b16 a[182:183], v25 offset:12544
    v_exp_f32 v110, v110
    ds_read_b64_tr_b16 a[184:185], v26 offset:8448
    s_waitcnt lgkmcnt(15)
    v_mfma_f32_32x32x16_bf16 v[112:127], a[108:111], a[44:47], v[112:127]
    ds_read_b64_tr_b16 a[186:187], v26 offset:12544
    v_exp_f32 v111, v111
    ds_read_b64_tr_b16 a[188:189], v27 offset:8448
    ds_read_b64_tr_b16 a[190:191], v27 offset:12544
    v_add_f32 v41, v41, v96
    v_add_f32 v41, v41, v97
    s_waitcnt lgkmcnt(15)
    v_mfma_f32_32x32x16_bf16 v[112:127], a[112:115], a[48:51], v[112:127]
    v_add_f32 v41, v41, v98
    v_add_f32 v41, v41, v99
    v_add_f32 v41, v41, v100
    v_add_f32 v41, v41, v101
    v_add_f32 v41, v41, v102
    s_waitcnt lgkmcnt(15)
    v_mfma_f32_32x32x16_bf16 v[112:127], a[116:119], a[52:55], v[112:127]
    v_add_f32 v41, v41, v103
    v_add_f32 v41, v41, v104
    v_add_f32 v41, v41, v105
    v_add_f32 v41, v41, v106
    v_add_f32 v41, v41, v107
    v_add_f32 v41, v41, v108
    s_waitcnt lgkmcnt(15)
    v_mfma_f32_32x32x16_bf16 v[112:127], a[120:123], a[56:59], v[112:127]
    v_add_f32 v41, v41, v109
    v_add_f32 v41, v41, v110
    v_add_f32 v41, v41, v111
    v_cvt_pk_bf16_f32 v48, v96, v97
    v_cvt_pk_bf16_f32 v49, v98, v99
    s_waitcnt lgkmcnt(15)
    v_mfma_f32_32x32x16_bf16 v[112:127], a[124:127], a[60:63], v[112:127]
    v_cvt_pk_bf16_f32 v50, v100, v101
    v_cvt_pk_bf16_f32 v51, v102, v103
    v_cvt_pk_bf16_f32 v52, v104, v105
    v_cvt_pk_bf16_f32 v53, v106, v107
    v_cvt_pk_bf16_f32 v54, v108, v109
    v_cvt_pk_bf16_f32 v55, v110, v111
    s_waitcnt vmcnt(16)
    s_waitcnt vmcnt(12)
    s_barrier
    s_waitcnt lgkmcnt(0)
    v_mfma_f32_32x32x16_bf16 v[128:143], a[128:131], v[48:51], v[128:143]
    ds_read_b128 a[64:67], v16 offset:32768
    v_mfma_f32_32x32x16_bf16 v[144:159], a[132:135], v[48:51], v[144:159]
    ds_read_b128 a[68:71], v17 offset:32768
    ds_read_b128 a[72:75], v18 offset:32768
    v_mfma_f32_32x32x16_bf16 v[160:175], a[136:139], v[48:51], v[160:175]
    ds_read_b128 a[76:79], v19 offset:32768
    ds_read_b128 a[80:83], v20 offset:32768
    v_mfma_f32_32x32x16_bf16 v[176:191], a[140:143], v[48:51], v[176:191]
    ds_read_b128 a[84:87], v21 offset:32768
    ds_read_b128 a[88:91], v22 offset:32768
    v_mfma_f32_32x32x16_bf16 v[192:207], a[144:147], v[48:51], v[192:207]
    ds_read_b128 a[92:95], v23 offset:32768
    ds_read_b128 a[96:99], v16 offset:33024
    v_mfma_f32_32x32x16_bf16 v[208:223], a[148:151], v[48:51], v[208:223]
    ds_read_b128 a[100:103], v17 offset:33024
    ds_read_b128 a[104:107], v18 offset:33024
    v_mfma_f32_32x32x16_bf16 v[224:239], a[152:155], v[48:51], v[224:239]
    ds_read_b128 a[108:111], v19 offset:33024
    ds_read_b128 a[112:115], v20 offset:33024
    v_mfma_f32_32x32x16_bf16 v[240:255], a[156:159], v[48:51], v[240:255]
    ds_read_b128 a[116:119], v21 offset:33024
    ds_read_b128 a[120:123], v22 offset:33024
    v_mfma_f32_32x32x16_bf16 v[128:143], a[160:163], v[52:55], v[128:143]
    ds_read_b128 a[124:127], v23 offset:33024
    v_max3_f32 v42, v112, v113, v114
    v_mfma_f32_32x32x16_bf16 v[144:159], a[164:167], v[52:55], v[144:159]
    v_max3_f32 v42, v42, v115, v116
    v_max3_f32 v42, v42, v117, v118
    v_mfma_f32_32x32x16_bf16 v[160:175], a[168:171], v[52:55], v[160:175]
    v_max3_f32 v42, v42, v119, v120
    v_max3_f32 v42, v42, v121, v122
    v_mfma_f32_32x32x16_bf16 v[176:191], a[172:175], v[52:55], v[176:191]
    v_max3_f32 v42, v42, v123, v124
    v_max3_f32 v42, v42, v125, v126
    v_mfma_f32_32x32x16_bf16 v[192:207], a[176:179], v[52:55], v[192:207]
    v_max_f32 v42, v42, v127
    v_mov_b32 v43, v42
    v_mfma_f32_32x32x16_bf16 v[208:223], a[180:183], v[52:55], v[208:223]
    s_nop 1
    v_permlane32_swap_b32 v42, v43
    v_mfma_f32_32x32x16_bf16 v[224:239], a[184:187], v[52:55], v[224:239]
    v_max_f32 v42, v42, v43
    v_mul_f32 v42, s55, v42
    v_mfma_f32_32x32x16_bf16 v[240:255], a[188:191], v[52:55], v[240:255]
    v_sub_f32 v43, v42, v40
    v_cmp_gt_f32 vcc, v43, v39
    s_nop 4
    s_cbranch_vccz LA_nr13
    s_nop 15
    v_max_f32 v42, v40, v42
    v_sub_f32 v43, v40, v42
    v_exp_f32 v43, v43
    v_mov_b32 v40, v42
    s_nop 0
    v_mul_f32 v41, v41, v43
    v_mul_f32 v128, v128, v43
    v_mul_f32 v129, v129, v43
    v_mul_f32 v130, v130, v43
    v_mul_f32 v131, v131, v43
    v_mul_f32 v132, v132, v43
    v_mul_f32 v133, v133, v43
    v_mul_f32 v134, v134, v43
    v_mul_f32 v135, v135, v43
    v_mul_f32 v136, v136, v43
    v_mul_f32 v137, v137, v43
    v_mul_f32 v138, v138, v43
    v_mul_f32 v139, v139, v43
    v_mul_f32 v140, v140, v43
    v_mul_f32 v141, v141, v43
    v_mul_f32 v142, v142, v43
    v_mul_f32 v143, v143, v43
    v_mul_f32 v144, v144, v43
    v_mul_f32 v145, v145, v43
    v_mul_f32 v146, v146, v43
    v_mul_f32 v147, v147, v43
    v_mul_f32 v148, v148, v43
    v_mul_f32 v149, v149, v43
    v_mul_f32 v150, v150, v43
    v_mul_f32 v151, v151, v43
    v_mul_f32 v152, v152, v43
    v_mul_f32 v153, v153, v43
    v_mul_f32 v154, v154, v43
    v_mul_f32 v155, v155, v43
    v_mul_f32 v156, v156, v43
    v_mul_f32 v157, v157, v43
    v_mul_f32 v158, v158, v43
    v_mul_f32 v159, v159, v43
    v_mul_f32 v160, v160, v43
    v_mul_f32 v161, v161, v43
    v_mul_f32 v162, v162, v43
    v_mul_f32 v163, v163, v43
    v_mul_f32 v164, v164, v43
    v_mul_f32 v165, v165, v43
    v_mul_f32 v166, v166, v43
    v_mul_f32 v167, v167, v43
    v_mul_f32 v168, v168, v43
    v_mul_f32 v169, v169, v43
    v_mul_f32 v170, v170, v43
    v_mul_f32 v171, v171, v43
    v_mul_f32 v172, v172, v43
    v_mul_f32 v173, v173, v43
    v_mul_f32 v174, v174, v43
    v_mul_f32 v175, v175, v43
    v_mul_f32 v176, v176, v43
    v_mul_f32 v177, v177, v43
    v_mul_f32 v178, v178, v43
    v_mul_f32 v179, v179, v43
    v_mul_f32 v180, v180, v43
    v_mul_f32 v181, v181, v43
    v_mul_f32 v182, v182, v43
    v_mul_f32 v183, v183, v43
    v_mul_f32 v184, v184, v43
    v_mul_f32 v185, v185, v43
    v_mul_f32 v186, v186, v43
    v_mul_f32 v187, v187, v43
    v_mul_f32 v188, v188, v43
    v_mul_f32 v189, v189, v43
    v_mul_f32 v190, v190, v43
    v_mul_f32 v191, v191, v43
    v_mul_f32 v192, v192, v43
    v_mul_f32 v193, v193, v43
    v_mul_f32 v194, v194, v43
    v_mul_f32 v195, v195, v43
    v_mul_f32 v196, v196, v43
    v_mul_f32 v197, v197, v43
    v_mul_f32 v198, v198, v43
    v_mul_f32 v199, v199, v43
    v_mul_f32 v200, v200, v43
    v_mul_f32 v201, v201, v43
    v_mul_f32 v202, v202, v43
    v_mul_f32 v203, v203, v43
    v_mul_f32 v204, v204, v43
    v_mul_f32 v205, v205, v43
    v_mul_f32 v206, v206, v43
    v_mul_f32 v207, v207, v43
    v_mul_f32 v208, v208, v43
    v_mul_f32 v209, v209, v43
    v_mul_f32 v210, v210, v43
    v_mul_f32 v211, v211, v43
    v_mul_f32 v212, v212, v43
    v_mul_f32 v213, v213, v43
    v_mul_f32 v214, v214, v43
    v_mul_f32 v215, v215, v43
    v_mul_f32 v216, v216, v43
    v_mul_f32 v217, v217, v43
    v_mul_f32 v218, v218, v43
    v_mul_f32 v219, v219, v43
    v_mul_f32 v220, v220, v43
    v_mul_f32 v221, v221, v43
    v_mul_f32 v222, v222, v43
    v_mul_f32 v223, v223, v43
    v_mul_f32 v224, v224, v43
    v_mul_f32 v225, v225, v43
    v_mul_f32 v226, v226, v43
    v_mul_f32 v227, v227, v43
    v_mul_f32 v228, v228, v43
    v_mul_f32 v229, v229, v43
    v_mul_f32 v230, v230, v43
    v_mul_f32 v231, v231, v43
    v_mul_f32 v232, v232, v43
    v_mul_f32 v233, v233, v43
    v_mul_f32 v234, v234, v43
    v_mul_f32 v235, v235, v43
    v_mul_f32 v236, v236, v43
    v_mul_f32 v237, v237, v43
    v_mul_f32 v238, v238, v43
    v_mul_f32 v239, v239, v43
    v_mul_f32 v240, v240, v43
    v_mul_f32 v241, v241, v43
    v_mul_f32 v242, v242, v43
    v_mul_f32 v243, v243, v43
    v_mul_f32 v244, v244, v43
    v_mul_f32 v245, v245, v43
    v_mul_f32 v246, v246, v43
    v_mul_f32 v247, v247, v43
    v_mul_f32 v248, v248, v43
    v_mul_f32 v249, v249, v43
    v_mul_f32 v250, v250, v43
    v_mul_f32 v251, v251, v43
    v_mul_f32 v252, v252, v43
    v_mul_f32 v253, v253, v43
    v_mul_f32 v254, v254, v43
    v_mul_f32 v255, v255, v43
LA_nr13:
    s_waitcnt lgkmcnt(15)
    v_mfma_f32_32x32x16_bf16 v[96:111], a[64:67], a[0:3], 0
    v_fma_f32 v112, v112, s55, -v40
    v_fma_f32 v113, v113, s55, -v40
    v_fma_f32 v114, v114, s55, -v40
    v_fma_f32 v115, v115, s55, -v40
    v_fma_f32 v116, v116, s55, -v40
    s_waitcnt lgkmcnt(14)
    v_mfma_f32_32x32x16_bf16 v[96:111], a[68:71], a[4:7], v[96:111]
    v_fma_f32 v117, v117, s55, -v40
    v_fma_f32 v118, v118, s55, -v40
    v_fma_f32 v119, v119, s55, -v40
    v_fma_f32 v120, v120, s55, -v40
    v_fma_f32 v121, v121, s55, -v40
    v_fma_f32 v122, v122, s55, -v40
    s_waitcnt lgkmcnt(13)
    v_mfma_f32_32x32x16_bf16 v[96:111], a[72:75], a[8:11], v[96:111]
    v_fma_f32 v123, v123, s55, -v40
    v_fma_f32 v124, v124, s55, -v40
    v_fma_f32 v125, v125, s55, -v40
    v_fma_f32 v126, v126, s55, -v40
    v_fma_f32 v127, v127, s55, -v40
    s_waitcnt lgkmcnt(12)
    v_mfma_f32_32x32x16_bf16 v[96:111], a[76:79], a[12:15], v[96:111]
    v_exp_f32 v112, v112
    ds_read_b64_tr_b16 a[128:129], v24 offset:16384
    ds_read_b64_tr_b16 a[130:131], v24 offset:20480
    v_exp_f32 v113, v113
    ds_read_b64_tr_b16 a[132:133], v25 offset:16384
    ds_read_b64_tr_b16 a[134:135], v25 offset:20480
    s_waitcnt lgkmcnt(15)
    v_mfma_f32_32x32x16_bf16 v[96:111], a[80:83], a[16:19], v[96:111]
    v_exp_f32 v114, v114
    ds_read_b64_tr_b16 a[136:137], v26 offset:16384
    ds_read_b64_tr_b16 a[138:139], v26 offset:20480
    v_exp_f32 v115, v115
    ds_read_b64_tr_b16 a[140:141], v27 offset:16384
    s_waitcnt lgkmcnt(15)
    v_mfma_f32_32x32x16_bf16 v[96:111], a[84:87], a[20:23], v[96:111]
    ds_read_b64_tr_b16 a[142:143], v27 offset:20480
    v_exp_f32 v116, v116
    ds_read_b64_tr_b16 a[144:145], v24 offset:16640
    ds_read_b64_tr_b16 a[146:147], v24 offset:20736
    v_exp_f32 v117, v117
    ds_read_b64_tr_b16 a[148:149], v25 offset:16640
    s_waitcnt lgkmcnt(15)
    v_mfma_f32_32x32x16_bf16 v[96:111], a[88:91], a[24:27], v[96:111]
    ds_read_b64_tr_b16 a[150:151], v25 offset:20736
    v_exp_f32 v118, v118
    ds_read_b64_tr_b16 a[152:153], v26 offset:16640
    ds_read_b64_tr_b16 a[154:155], v26 offset:20736
    v_exp_f32 v119, v119
    s_waitcnt lgkmcnt(15)
    v_mfma_f32_32x32x16_bf16 v[96:111], a[92:95], a[28:31], v[96:111]
    ds_read_b64_tr_b16 a[156:157], v27 offset:16640
    ds_read_b64_tr_b16 a[158:159], v27 offset:20736
    v_exp_f32 v120, v120
    ds_read_b64_tr_b16 a[160:161], v24 offset:24576
    ds_read_b64_tr_b16 a[162:163], v24 offset:28672
    v_exp_f32 v121, v121
    s_waitcnt lgkmcnt(15)
    v_mfma_f32_32x32x16_bf16 v[96:111], a[96:99], a[32:35], v[96:111]
    ds_read_b64_tr_b16 a[164:165], v25 offset:24576
    ds_read_b64_tr_b16 a[166:167], v25 offset:28672
    v_exp_f32 v122, v122
    ds_read_b64_tr_b16 a[168:169], v26 offset:24576
    ds_read_b64_tr_b16 a[170:171], v26 offset:28672
    s_waitcnt lgkmcnt(15)
    v_mfma_f32_32x32x16_bf16 v[96:111], a[100:103], a[36:39], v[96:111]
    v_exp_f32 v123, v123
    ds_read_b64_tr_b16 a[172:173], v27 offset:24576
    ds_read_b64_tr_b16 a[174:175], v27 offset:28672
    v_exp_f32 v124, v124
    ds_read_b64_tr_b16 a[176:177], v24 offset:24832
    ds_read_b64_tr_b16 a[178:179], v24 offset:28928
    s_waitcnt lgkmcnt(15)
    v_mfma_f32_32x32x16_bf16 v[96:111], a[104:107], a[40:43], v[96:111]
    v_exp_f32 v125, v125
    ds_read_b64_tr_b16 a[180:181], v25 offset:24832
    ds_read_b64_tr_b16 a[182:183], v25 offset:28928
    v_exp_f32 v126, v126
    ds_read_b64_tr_b16 a[184:185], v26 offset:24832
    s_waitcnt lgkmcnt(15)
    v_mfma_f32_32x32x16_bf16 v[96:111], a[108:111], a[44:47], v[96:111]
    ds_read_b64_tr_b16 a[186:187], v26 offset:28928
    v_exp_f32 v127, v127
    ds_read_b64_tr_b16 a[188:189], v27 offset:24832
    ds_read_b64_tr_b16 a[190:191], v27 offset:28928
    v_add_f32 v41, v41, v112
    v_add_f32 v41, v41, v113
    s_waitcnt lgkmcnt(15)
    v_mfma_f32_32x32x16_bf16 v[96:111], a[112:115], a[48:51], v[96:111]
    v_add_f32 v41, v41, v114
    v_add_f32 v41, v41, v115
    v_add_f32 v41, v41, v116
    v_add_f32 v41, v41, v117
    v_add_f32 v41, v41, v118
    s_waitcnt lgkmcnt(15)
    v_mfma_f32_32x32x16_bf16 v[96:111], a[116:119], a[52:55], v[96:111]
    v_add_f32 v41, v41, v119
    v_add_f32 v41, v41, v120
    v_add_f32 v41, v41, v121
    v_add_f32 v41, v41, v122
    v_add_f32 v41, v41, v123
    v_add_f32 v41, v41, v124
    s_waitcnt lgkmcnt(15)
    v_mfma_f32_32x32x16_bf16 v[96:111], a[120:123], a[56:59], v[96:111]
    v_add_f32 v41, v41, v125
    v_add_f32 v41, v41, v126
    v_add_f32 v41, v41, v127
    v_cvt_pk_bf16_f32 v48, v112, v113
    v_cvt_pk_bf16_f32 v49, v114, v115
    s_waitcnt lgkmcnt(15)
    v_mfma_f32_32x32x16_bf16 v[96:111], a[124:127], a[60:63], v[96:111]
    v_cvt_pk_bf16_f32 v50, v116, v117
    v_cvt_pk_bf16_f32 v51, v118, v119
    v_cvt_pk_bf16_f32 v52, v120, v121
    v_cvt_pk_bf16_f32 v53, v122, v123
    v_cvt_pk_bf16_f32 v54, v124, v125
    v_cvt_pk_bf16_f32 v55, v126, v127
    s_waitcnt vmcnt(8)
    s_waitcnt vmcnt(4)
    s_barrier
    s_waitcnt lgkmcnt(0)
    v_mfma_f32_32x32x16_bf16 v[128:143], a[128:131], v[48:51], v[128:143]
    ds_read_b128 a[64:67], v16 offset:49152
    v_mfma_f32_32x32x16_bf16 v[144:159], a[132:135], v[48:51], v[144:159]
    ds_read_b128 a[68:71], v17 offset:49152
    ds_read_b128 a[72:75], v18 offset:49152
    v_mfma_f32_32x32x16_bf16 v[160:175], a[136:139], v[48:51], v[160:175]
    ds_read_b128 a[76:79], v19 offset:49152
    ds_read_b128 a[80:83], v20 offset:49152
    v_mfma_f32_32x32x16_bf16 v[176:191], a[140:143], v[48:51], v[176:191]
    ds_read_b128 a[84:87], v21 offset:49152
    ds_read_b128 a[88:91], v22 offset:49152
    v_mfma_f32_32x32x16_bf16 v[192:207], a[144:147], v[48:51], v[192:207]
    ds_read_b128 a[92:95], v23 offset:49152
    ds_read_b128 a[96:99], v16 offset:49408
    v_mfma_f32_32x32x16_bf16 v[208:223], a[148:151], v[48:51], v[208:223]
    ds_read_b128 a[100:103], v17 offset:49408
    ds_read_b128 a[104:107], v18 offset:49408
    v_mfma_f32_32x32x16_bf16 v[224:239], a[152:155], v[48:51], v[224:239]
    ds_read_b128 a[108:111], v19 offset:49408
    ds_read_b128 a[112:115], v20 offset:49408
    v_mfma_f32_32x32x16_bf16 v[240:255], a[156:159], v[48:51], v[240:255]
    ds_read_b128 a[116:119], v21 offset:49408
    ds_read_b128 a[120:123], v22 offset:49408
    v_mfma_f32_32x32x16_bf16 v[128:143], a[160:163], v[52:55], v[128:143]
    ds_read_b128 a[124:127], v23 offset:49408
    v_max3_f32 v42, v96, v97, v98
    v_mfma_f32_32x32x16_bf16 v[144:159], a[164:167], v[52:55], v[144:159]
    v_max3_f32 v42, v42, v99, v100
    v_max3_f32 v42, v42, v101, v102
    v_mfma_f32_32x32x16_bf16 v[160:175], a[168:171], v[52:55], v[160:175]
    v_max3_f32 v42, v42, v103, v104
    v_max3_f32 v42, v42, v105, v106
    v_mfma_f32_32x32x16_bf16 v[176:191], a[172:175], v[52:55], v[176:191]
    v_max3_f32 v42, v42, v107, v108
    v_max3_f32 v42, v42, v109, v110
    v_mfma_f32_32x32x16_bf16 v[192:207], a[176:179], v[52:55], v[192:207]
    v_max_f32 v42, v42, v111
    v_mov_b32 v43, v42
    v_mfma_f32_32x32x16_bf16 v[208:223], a[180:183], v[52:55], v[208:223]
    s_nop 1
    v_permlane32_swap_b32 v42, v43
    v_mfma_f32_32x32x16_bf16 v[224:239], a[184:187], v[52:55], v[224:239]
    v_max_f32 v42, v42, v43
    v_mul_f32 v42, s55, v42
    v_mfma_f32_32x32x16_bf16 v[240:255], a[188:191], v[52:55], v[240:255]
    v_sub_f32 v43, v42, v40
    v_cmp_gt_f32 vcc, v43, v39
    s_nop 4
    s_cbranch_vccz LA_nr14
    s_nop 15
    v_max_f32 v42, v40, v42
    v_sub_f32 v43, v40, v42
    v_exp_f32 v43, v43
    v_mov_b32 v40, v42
    s_nop 0
    v_mul_f32 v41, v41, v43
    v_mul_f32 v128, v128, v43
    v_mul_f32 v129, v129, v43
    v_mul_f32 v130, v130, v43
    v_mul_f32 v131, v131, v43
    v_mul_f32 v132, v132, v43
    v_mul_f32 v133, v133, v43
    v_mul_f32 v134, v134, v43
    v_mul_f32 v135, v135, v43
    v_mul_f32 v136, v136, v43
    v_mul_f32 v137, v137, v43
    v_mul_f32 v138, v138, v43
    v_mul_f32 v139, v139, v43
    v_mul_f32 v140, v140, v43
    v_mul_f32 v141, v141, v43
    v_mul_f32 v142, v142, v43
    v_mul_f32 v143, v143, v43
    v_mul_f32 v144, v144, v43
    v_mul_f32 v145, v145, v43
    v_mul_f32 v146, v146, v43
    v_mul_f32 v147, v147, v43
    v_mul_f32 v148, v148, v43
    v_mul_f32 v149, v149, v43
    v_mul_f32 v150, v150, v43
    v_mul_f32 v151, v151, v43
    v_mul_f32 v152, v152, v43
    v_mul_f32 v153, v153, v43
    v_mul_f32 v154, v154, v43
    v_mul_f32 v155, v155, v43
    v_mul_f32 v156, v156, v43
    v_mul_f32 v157, v157, v43
    v_mul_f32 v158, v158, v43
    v_mul_f32 v159, v159, v43
    v_mul_f32 v160, v160, v43
    v_mul_f32 v161, v161, v43
    v_mul_f32 v162, v162, v43
    v_mul_f32 v163, v163, v43
    v_mul_f32 v164, v164, v43
    v_mul_f32 v165, v165, v43
    v_mul_f32 v166, v166, v43
    v_mul_f32 v167, v167, v43
    v_mul_f32 v168, v168, v43
    v_mul_f32 v169, v169, v43
    v_mul_f32 v170, v170, v43
    v_mul_f32 v171, v171, v43
    v_mul_f32 v172, v172, v43
    v_mul_f32 v173, v173, v43
    v_mul_f32 v174, v174, v43
    v_mul_f32 v175, v175, v43
    v_mul_f32 v176, v176, v43
    v_mul_f32 v177, v177, v43
    v_mul_f32 v178, v178, v43
    v_mul_f32 v179, v179, v43
    v_mul_f32 v180, v180, v43
    v_mul_f32 v181, v181, v43
    v_mul_f32 v182, v182, v43
    v_mul_f32 v183, v183, v43
    v_mul_f32 v184, v184, v43
    v_mul_f32 v185, v185, v43
    v_mul_f32 v186, v186, v43
    v_mul_f32 v187, v187, v43
    v_mul_f32 v188, v188, v43
    v_mul_f32 v189, v189, v43
    v_mul_f32 v190, v190, v43
    v_mul_f32 v191, v191, v43
    v_mul_f32 v192, v192, v43
    v_mul_f32 v193, v193, v43
    v_mul_f32 v194, v194, v43
    v_mul_f32 v195, v195, v43
    v_mul_f32 v196, v196, v43
    v_mul_f32 v197, v197, v43
    v_mul_f32 v198, v198, v43
    v_mul_f32 v199, v199, v43
    v_mul_f32 v200, v200, v43
    v_mul_f32 v201, v201, v43
    v_mul_f32 v202, v202, v43
    v_mul_f32 v203, v203, v43
    v_mul_f32 v204, v204, v43
    v_mul_f32 v205, v205, v43
    v_mul_f32 v206, v206, v43
    v_mul_f32 v207, v207, v43
    v_mul_f32 v208, v208, v43
    v_mul_f32 v209, v209, v43
    v_mul_f32 v210, v210, v43
    v_mul_f32 v211, v211, v43
    v_mul_f32 v212, v212, v43
    v_mul_f32 v213, v213, v43
    v_mul_f32 v214, v214, v43
    v_mul_f32 v215, v215, v43
    v_mul_f32 v216, v216, v43
    v_mul_f32 v217, v217, v43
    v_mul_f32 v218, v218, v43
    v_mul_f32 v219, v219, v43
    v_mul_f32 v220, v220, v43
    v_mul_f32 v221, v221, v43
    v_mul_f32 v222, v222, v43
    v_mul_f32 v223, v223, v43
    v_mul_f32 v224, v224, v43
    v_mul_f32 v225, v225, v43
    v_mul_f32 v226, v226, v43
    v_mul_f32 v227, v227, v43
    v_mul_f32 v228, v228, v43
    v_mul_f32 v229, v229, v43
    v_mul_f32 v230, v230, v43
    v_mul_f32 v231, v231, v43
    v_mul_f32 v232, v232, v43
    v_mul_f32 v233, v233, v43
    v_mul_f32 v234, v234, v43
    v_mul_f32 v235, v235, v43
    v_mul_f32 v236, v236, v43
    v_mul_f32 v237, v237, v43
    v_mul_f32 v238, v238, v43
    v_mul_f32 v239, v239, v43
    v_mul_f32 v240, v240, v43
    v_mul_f32 v241, v241, v43
    v_mul_f32 v242, v242, v43
    v_mul_f32 v243, v243, v43
    v_mul_f32 v244, v244, v43
    v_mul_f32 v245, v245, v43
    v_mul_f32 v246, v246, v43
    v_mul_f32 v247, v247, v43
    v_mul_f32 v248, v248, v43
    v_mul_f32 v249, v249, v43
    v_mul_f32 v250, v250, v43
    v_mul_f32 v251, v251, v43
    v_mul_f32 v252, v252, v43
    v_mul_f32 v253, v253, v43
    v_mul_f32 v254, v254, v43
    v_mul_f32 v255, v255, v43
LA_nr14:
    s_waitcnt lgkmcnt(15)
    v_mfma_f32_32x32x16_bf16 v[112:127], a[64:67], a[0:3], 0
    v_fma_f32 v96, v96, s55, -v40
    v_fma_f32 v97, v97, s55, -v40
    v_fma_f32 v98, v98, s55, -v40
    v_fma_f32 v99, v99, s55, -v40
    v_fma_f32 v100, v100, s55, -v40
    s_waitcnt lgkmcnt(14)
    v_mfma_f32_32x32x16_bf16 v[112:127], a[68:71], a[4:7], v[112:127]
    v_fma_f32 v101, v101, s55, -v40
    v_fma_f32 v102, v102, s55, -v40
    v_fma_f32 v103, v103, s55, -v40
    v_fma_f32 v104, v104, s55, -v40
    v_fma_f32 v105, v105, s55, -v40
    v_fma_f32 v106, v106, s55, -v40
    s_waitcnt lgkmcnt(13)
    v_mfma_f32_32x32x16_bf16 v[112:127], a[72:75], a[8:11], v[112:127]
    v_fma_f32 v107, v107, s55, -v40
    v_fma_f32 v108, v108, s55, -v40
    v_fma_f32 v109, v109, s55, -v40
    v_fma_f32 v110, v110, s55, -v40
    v_fma_f32 v111, v111, s55, -v40
    s_waitcnt lgkmcnt(12)
    v_mfma_f32_32x32x16_bf16 v[112:127], a[76:79], a[12:15], v[112:127]
    v_exp_f32 v96, v96
    ds_read_b64_tr_b16 a[128:129], v24 offset:32768
    ds_read_b64_tr_b16 a[130:131], v24 offset:36864
    v_exp_f32 v97, v97
    ds_read_b64_tr_b16 a[132:133], v25 offset:32768
    ds_read_b64_tr_b16 a[134:135], v25 offset:36864
    s_waitcnt lgkmcnt(15)
    v_mfma_f32_32x32x16_bf16 v[112:127], a[80:83], a[16:19], v[112:127]
    v_exp_f32 v98, v98
    ds_read_b64_tr_b16 a[136:137], v26 offset:32768
    ds_read_b64_tr_b16 a[138:139], v26 offset:36864
    v_exp_f32 v99, v99
    ds_read_b64_tr_b16 a[140:141], v27 offset:32768
    s_waitcnt lgkmcnt(15)
    v_mfma_f32_32x32x16_bf16 v[112:127], a[84:87], a[20:23], v[112:127]
    ds_read_b64_tr_b16 a[142:143], v27 offset:36864
    v_exp_f32 v100, v100
    ds_read_b64_tr_b16 a[144:145], v24 offset:33024
    ds_read_b64_tr_b16 a[146:147], v24 offset:37120
    v_exp_f32 v101, v101
    ds_read_b64_tr_b16 a[148:149], v25 offset:33024
    s_waitcnt lgkmcnt(15)
    v_mfma_f32_32x32x16_bf16 v[112:127], a[88:91], a[24:27], v[112:127]
    ds_read_b64_tr_b16 a[150:151], v25 offset:37120
    v_exp_f32 v102, v102
    ds_read_b64_tr_b16 a[152:153], v26 offset:33024
    ds_read_b64_tr_b16 a[154:155], v26 offset:37120
    v_exp_f32 v103, v103
    s_waitcnt lgkmcnt(15)
    v_mfma_f32_32x32x16_bf16 v[112:127], a[92:95], a[28:31], v[112:127]
    ds_read_b64_tr_b16 a[156:157], v27 offset:33024
    ds_read_b64_tr_b16 a[158:159], v27 offset:37120
    v_exp_f32 v104, v104
    ds_read_b64_tr_b16 a[160:161], v24 offset:40960
    ds_read_b64_tr_b16 a[162:163], v24 offset:45056
    v_exp_f32 v105, v105
    s_waitcnt lgkmcnt(15)
    v_mfma_f32_32x32x16_bf16 v[112:127], a[96:99], a[32:35], v[112:127]
    ds_read_b64_tr_b16 a[164:165], v25 offset:40960
    ds_read_b64_tr_b16 a[166:167], v25 offset:45056
    v_exp_f32 v106, v106
    ds_read_b64_tr_b16 a[168:169], v26 offset:40960
    ds_read_b64_tr_b16 a[170:171], v26 offset:45056
    s_waitcnt lgkmcnt(15)
    v_mfma_f32_32x32x16_bf16 v[112:127], a[100:103], a[36:39], v[112:127]
    v_exp_f32 v107, v107
    ds_read_b64_tr_b16 a[172:173], v27 offset:40960
    ds_read_b64_tr_b16 a[174:175], v27 offset:45056
    v_exp_f32 v108, v108
    ds_read_b64_tr_b16 a[176:177], v24 offset:41216
    ds_read_b64_tr_b16 a[178:179], v24 offset:45312
    s_waitcnt lgkmcnt(15)
    v_mfma_f32_32x32x16_bf16 v[112:127], a[104:107], a[40:43], v[112:127]
    v_exp_f32 v109, v109
    ds_read_b64_tr_b16 a[180:181], v25 offset:41216
    ds_read_b64_tr_b16 a[182:183], v25 offset:45312
    v_exp_f32 v110, v110
    ds_read_b64_tr_b16 a[184:185], v26 offset:41216
    s_waitcnt lgkmcnt(15)
    v_mfma_f32_32x32x16_bf16 v[112:127], a[108:111], a[44:47], v[112:127]
    ds_read_b64_tr_b16 a[186:187], v26 offset:45312
    v_exp_f32 v111, v111
    ds_read_b64_tr_b16 a[188:189], v27 offset:41216
    ds_read_b64_tr_b16 a[190:191], v27 offset:45312
    v_add_f32 v41, v41, v96
    v_add_f32 v41, v41, v97
    s_waitcnt lgkmcnt(15)
    v_mfma_f32_32x32x16_bf16 v[112:127], a[112:115], a[48:51], v[112:127]
    v_add_f32 v41, v41, v98
    v_add_f32 v41, v41, v99
    v_add_f32 v41, v41, v100
    v_add_f32 v41, v41, v101
    v_add_f32 v41, v41, v102
    s_waitcnt lgkmcnt(15)
    v_mfma_f32_32x32x16_bf16 v[112:127], a[116:119], a[52:55], v[112:127]
    v_add_f32 v41, v41, v103
    v_add_f32 v41, v41, v104
    v_add_f32 v41, v41, v105
    v_add_f32 v41, v41, v106
    v_add_f32 v41, v41, v107
    v_add_f32 v41, v41, v108
    s_waitcnt lgkmcnt(15)
    v_mfma_f32_32x32x16_bf16 v[112:127], a[120:123], a[56:59], v[112:127]
    v_add_f32 v41, v41, v109
    v_add_f32 v41, v41, v110
    v_add_f32 v41, v41, v111
    v_cvt_pk_bf16_f32 v48, v96, v97
    v_cvt_pk_bf16_f32 v49, v98, v99
    s_waitcnt lgkmcnt(15)
    v_mfma_f32_32x32x16_bf16 v[112:127], a[124:127], a[60:63], v[112:127]
    v_cvt_pk_bf16_f32 v50, v100, v101
    v_cvt_pk_bf16_f32 v51, v102, v103
    v_cvt_pk_bf16_f32 v52, v104, v105
    v_cvt_pk_bf16_f32 v53, v106, v107
    v_cvt_pk_bf16_f32 v54, v108, v109
    v_cvt_pk_bf16_f32 v55, v110, v111
    s_waitcnt vmcnt(0)
    s_barrier
    s_nop 15
    s_waitcnt lgkmcnt(0)
    v_mfma_f32_32x32x16_bf16 v[128:143], a[128:131], v[48:51], v[128:143]
    v_mfma_f32_32x32x16_bf16 v[144:159], a[132:135], v[48:51], v[144:159]
    v_max3_f32 v42, v112, v113, v114
    v_mfma_f32_32x32x16_bf16 v[160:175], a[136:139], v[48:51], v[160:175]
    v_max3_f32 v42, v42, v115, v116
    v_mfma_f32_32x32x16_bf16 v[176:191], a[140:143], v[48:51], v[176:191]
    v_max3_f32 v42, v42, v117, v118
    v_mfma_f32_32x32x16_bf16 v[192:207], a[144:147], v[48:51], v[192:207]
    v_max3_f32 v42, v42, v119, v120
    v_mfma_f32_32x32x16_bf16 v[208:223], a[148:151], v[48:51], v[208:223]
    v_max3_f32 v42, v42, v121, v122
    v_mfma_f32_32x32x16_bf16 v[224:239], a[152:155], v[48:51], v[224:239]
    v_max3_f32 v42, v42, v123, v124
    v_mfma_f32_32x32x16_bf16 v[240:255], a[156:159], v[48:51], v[240:255]
    v_max3_f32 v42, v42, v125, v126
    v_mfma_f32_32x32x16_bf16 v[128:143], a[160:163], v[52:55], v[128:143]
    v_max_f32 v42, v42, v127
    v_mfma_f32_32x32x16_bf16 v[144:159], a[164:167], v[52:55], v[144:159]
    v_mov_b32 v43, v42
    v_mfma_f32_32x32x16_bf16 v[160:175], a[168:171], v[52:55], v[160:175]
    s_nop 1
    v_mfma_f32_32x32x16_bf16 v[176:191], a[172:175], v[52:55], v[176:191]
    v_permlane32_swap_b32 v42, v43
    v_mfma_f32_32x32x16_bf16 v[192:207], a[176:179], v[52:55], v[192:207]
    v_max_f32 v42, v42, v43
    v_mfma_f32_32x32x16_bf16 v[208:223], a[180:183], v[52:55], v[208:223]
    v_mul_f32 v42, s55, v42
    v_mfma_f32_32x32x16_bf16 v[224:239], a[184:187], v[52:55], v[224:239]
    v_sub_f32 v43, v42, v40
    v_mfma_f32_32x32x16_bf16 v[240:255], a[188:191], v[52:55], v[240:255]
    v_cmp_gt_f32 vcc, v43, v39
    s_nop 4
    s_cbranch_vccz LA_nr15
    s_nop 15
    v_max_f32 v42, v40, v42
    v_sub_f32 v43, v40, v42
    v_exp_f32 v43, v43
    v_mov_b32 v40, v42
    s_nop 0
    v_mul_f32 v41, v41, v43
    v_mul_f32 v128, v128, v43
    v_mul_f32 v129, v129, v43
    v_mul_f32 v130, v130, v43
    v_mul_f32 v131, v131, v43
    v_mul_f32 v132, v132, v43
    v_mul_f32 v133, v133, v43
    v_mul_f32 v134, v134, v43
    v_mul_f32 v135, v135, v43
    v_mul_f32 v136, v136, v43
    v_mul_f32 v137, v137, v43
    v_mul_f32 v138, v138, v43
    v_mul_f32 v139, v139, v43
    v_mul_f32 v140, v140, v43
    v_mul_f32 v141, v141, v43
    v_mul_f32 v142, v142, v43
    v_mul_f32 v143, v143, v43
    v_mul_f32 v144, v144, v43
    v_mul_f32 v145, v145, v43
    v_mul_f32 v146, v146, v43
    v_mul_f32 v147, v147, v43
    v_mul_f32 v148, v148, v43
    v_mul_f32 v149, v149, v43
    v_mul_f32 v150, v150, v43
    v_mul_f32 v151, v151, v43
    v_mul_f32 v152, v152, v43
    v_mul_f32 v153, v153, v43
    v_mul_f32 v154, v154, v43
    v_mul_f32 v155, v155, v43
    v_mul_f32 v156, v156, v43
    v_mul_f32 v157, v157, v43
    v_mul_f32 v158, v158, v43
    v_mul_f32 v159, v159, v43
    v_mul_f32 v160, v160, v43
    v_mul_f32 v161, v161, v43
    v_mul_f32 v162, v162, v43
    v_mul_f32 v163, v163, v43
    v_mul_f32 v164, v164, v43
    v_mul_f32 v165, v165, v43
    v_mul_f32 v166, v166, v43
    v_mul_f32 v167, v167, v43
    v_mul_f32 v168, v168, v43
    v_mul_f32 v169, v169, v43
    v_mul_f32 v170, v170, v43
    v_mul_f32 v171, v171, v43
    v_mul_f32 v172, v172, v43
    v_mul_f32 v173, v173, v43
    v_mul_f32 v174, v174, v43
    v_mul_f32 v175, v175, v43
    v_mul_f32 v176, v176, v43
    v_mul_f32 v177, v177, v43
    v_mul_f32 v178, v178, v43
    v_mul_f32 v179, v179, v43
    v_mul_f32 v180, v180, v43
    v_mul_f32 v181, v181, v43
    v_mul_f32 v182, v182, v43
    v_mul_f32 v183, v183, v43
    v_mul_f32 v184, v184, v43
    v_mul_f32 v185, v185, v43
    v_mul_f32 v186, v186, v43
    v_mul_f32 v187, v187, v43
    v_mul_f32 v188, v188, v43
    v_mul_f32 v189, v189, v43
    v_mul_f32 v190, v190, v43
    v_mul_f32 v191, v191, v43
    v_mul_f32 v192, v192, v43
    v_mul_f32 v193, v193, v43
    v_mul_f32 v194, v194, v43
    v_mul_f32 v195, v195, v43
    v_mul_f32 v196, v196, v43
    v_mul_f32 v197, v197, v43
    v_mul_f32 v198, v198, v43
    v_mul_f32 v199, v199, v43
    v_mul_f32 v200, v200, v43
    v_mul_f32 v201, v201, v43
    v_mul_f32 v202, v202, v43
    v_mul_f32 v203, v203, v43
    v_mul_f32 v204, v204, v43
    v_mul_f32 v205, v205, v43
    v_mul_f32 v206, v206, v43
    v_mul_f32 v207, v207, v43
    v_mul_f32 v208, v208, v43
    v_mul_f32 v209, v209, v43
    v_mul_f32 v210, v210, v43
    v_mul_f32 v211, v211, v43
    v_mul_f32 v212, v212, v43
    v_mul_f32 v213, v213, v43
    v_mul_f32 v214, v214, v43
    v_mul_f32 v215, v215, v43
    v_mul_f32 v216, v216, v43
    v_mul_f32 v217, v217, v43
    v_mul_f32 v218, v218, v43
    v_mul_f32 v219, v219, v43
    v_mul_f32 v220, v220, v43
    v_mul_f32 v221, v221, v43
    v_mul_f32 v222, v222, v43
    v_mul_f32 v223, v223, v43
    v_mul_f32 v224, v224, v43
    v_mul_f32 v225, v225, v43
    v_mul_f32 v226, v226, v43
    v_mul_f32 v227, v227, v43
    v_mul_f32 v228, v228, v43
    v_mul_f32 v229, v229, v43
    v_mul_f32 v230, v230, v43
    v_mul_f32 v231, v231, v43
    v_mul_f32 v232, v232, v43
    v_mul_f32 v233, v233, v43
    v_mul_f32 v234, v234, v43
    v_mul_f32 v235, v235, v43
    v_mul_f32 v236, v236, v43
    v_mul_f32 v237, v237, v43
    v_mul_f32 v238, v238, v43
    v_mul_f32 v239, v239, v43
    v_mul_f32 v240, v240, v43
    v_mul_f32 v241, v241, v43
    v_mul_f32 v242, v242, v43
    v_mul_f32 v243, v243, v43
    v_mul_f32 v244, v244, v43
    v_mul_f32 v245, v245, v43
    v_mul_f32 v246, v246, v43
    v_mul_f32 v247, v247, v43
    v_mul_f32 v248, v248, v43
    v_mul_f32 v249, v249, v43
    v_mul_f32 v250, v250, v43
    v_mul_f32 v251, v251, v43
    v_mul_f32 v252, v252, v43
    v_mul_f32 v253, v253, v43
    v_mul_f32 v254, v254, v43
    v_mul_f32 v255, v255, v43
LA_nr15:
    v_fma_f32 v112, v112, s55, -v40
    v_fma_f32 v113, v113, s55, -v40
    v_fma_f32 v114, v114, s55, -v40
    v_fma_f32 v115, v115, s55, -v40
    v_fma_f32 v116, v116, s55, -v40
    v_fma_f32 v117, v117, s55, -v40
    v_fma_f32 v118, v118, s55, -v40
    v_fma_f32 v119, v119, s55, -v40
    v_fma_f32 v120, v120, s55, -v40
    v_fma_f32 v121, v121, s55, -v40
    v_fma_f32 v122, v122, s55, -v40
    v_fma_f32 v123, v123, s55, -v40
    v_fma_f32 v124, v124, s55, -v40
    v_fma_f32 v125, v125, s55, -v40
    v_fma_f32 v126, v126, s55, -v40
    v_fma_f32 v127, v127, s55, -v40
    v_exp_f32 v112, v112
    ds_read_b64_tr_b16 a[128:129], v24 offset:49152
    ds_read_b64_tr_b16 a[130:131], v24 offset:53248
    v_exp_f32 v113, v113
    ds_read_b64_tr_b16 a[132:133], v25 offset:49152
    ds_read_b64_tr_b16 a[134:135], v25 offset:53248
    v_exp_f32 v114, v114
    ds_read_b64_tr_b16 a[136:137], v26 offset:49152
    ds_read_b64_tr_b16 a[138:139], v26 offset:53248
    v_exp_f32 v115, v115
    ds_read_b64_tr_b16 a[140:141], v27 offset:49152
    ds_read_b64_tr_b16 a[142:143], v27 offset:53248
    v_exp_f32 v116, v116
    ds_read_b64_tr_b16 a[144:145], v24 offset:49408
    ds_read_b64_tr_b16 a[146:147], v24 offset:53504
    v_exp_f32 v117, v117
    ds_read_b64_tr_b16 a[148:149], v25 offset:49408
    ds_read_b64_tr_b16 a[150:151], v25 offset:53504
    v_exp_f32 v118, v118
    ds_read_b64_tr_b16 a[152:153], v26 offset:49408
    ds_read_b64_tr_b16 a[154:155], v26 offset:53504
    v_exp_f32 v119, v119
    ds_read_b64_tr_b16 a[156:157], v27 offset:49408
    ds_read_b64_tr_b16 a[158:159], v27 offset:53504
    v_exp_f32 v120, v120
    ds_read_b64_tr_b16 a[160:161], v24 offset:57344
    ds_read_b64_tr_b16 a[162:163], v24 offset:61440
    v_exp_f32 v121, v121
    ds_read_b64_tr_b16 a[164:165], v25 offset:57344
    ds_read_b64_tr_b16 a[166:167], v25 offset:61440
    v_exp_f32 v122, v122
    ds_read_b64_tr_b16 a[168:169], v26 offset:57344
    ds_read_b64_tr_b16 a[170:171], v26 offset:61440
    v_exp_f32 v123, v123
    ds_read_b64_tr_b16 a[172:173], v27 offset:57344
    ds_read_b64_tr_b16 a[174:175], v27 offset:61440
    v_exp_f32 v124, v124
    ds_read_b64_tr_b16 a[176:177], v24 offset:57600
    ds_read_b64_tr_b16 a[178:179], v24 offset:61696
    v_exp_f32 v125, v125
    ds_read_b64_tr_b16 a[180:181], v25 offset:57600
    ds_read_b64_tr_b16 a[182:183], v25 offset:61696
    v_exp_f32 v126, v126
    ds_read_b64_tr_b16 a[184:185], v26 offset:57600
    ds_read_b64_tr_b16 a[186:187], v26 offset:61696
    v_exp_f32 v127, v127
    ds_read_b64_tr_b16 a[188:189], v27 offset:57600
    ds_read_b64_tr_b16 a[190:191], v27 offset:61696
    v_add_f32 v41, v41, v112
    v_add_f32 v41, v41, v113
    v_add_f32 v41, v41, v114
    v_add_f32 v41, v41, v115
    v_add_f32 v41, v41, v116
    v_add_f32 v41, v41, v117
    v_add_f32 v41, v41, v118
    v_add_f32 v41, v41, v119
    v_add_f32 v41, v41, v120
    v_add_f32 v41, v41, v121
    v_add_f32 v41, v41, v122
    v_add_f32 v41, v41, v123
    v_add_f32 v41, v41, v124
    v_add_f32 v41, v41, v125
    v_add_f32 v41, v41, v126
    v_add_f32 v41, v41, v127
    v_cvt_pk_bf16_f32 v48, v112, v113
    v_cvt_pk_bf16_f32 v49, v114, v115
    v_cvt_pk_bf16_f32 v50, v116, v117
    v_cvt_pk_bf16_f32 v51, v118, v119
    v_cvt_pk_bf16_f32 v52, v120, v121
    v_cvt_pk_bf16_f32 v53, v122, v123
    v_cvt_pk_bf16_f32 v54, v124, v125
    v_cvt_pk_bf16_f32 v55, v126, v127
    s_nop 1
    s_waitcnt lgkmcnt(0)
    v_mfma_f32_32x32x16_bf16 v[128:143], a[128:131], v[48:51], v[128:143]
    v_mfma_f32_32x32x16_bf16 v[144:159], a[132:135], v[48:51], v[144:159]
    v_mfma_f32_32x32x16_bf16 v[160:175], a[136:139], v[48:51], v[160:175]
    v_mfma_f32_32x32x16_bf16 v[176:191], a[140:143], v[48:51], v[176:191]
    v_mfma_f32_32x32x16_bf16 v[192:207], a[144:147], v[48:51], v[192:207]
    v_mfma_f32_32x32x16_bf16 v[208:223], a[148:151], v[48:51], v[208:223]
    v_mfma_f32_32x32x16_bf16 v[224:239], a[152:155], v[48:51], v[224:239]
    v_mfma_f32_32x32x16_bf16 v[240:255], a[156:159], v[48:51], v[240:255]
    v_mfma_f32_32x32x16_bf16 v[128:143], a[160:163], v[52:55], v[128:143]
    v_mfma_f32_32x32x16_bf16 v[144:159], a[164:167], v[52:55], v[144:159]
    v_mfma_f32_32x32x16_bf16 v[160:175], a[168:171], v[52:55], v[160:175]
    v_mfma_f32_32x32x16_bf16 v[176:191], a[172:175], v[52:55], v[176:191]
    v_mfma_f32_32x32x16_bf16 v[192:207], a[176:179], v[52:55], v[192:207]
    v_mfma_f32_32x32x16_bf16 v[208:223], a[180:183], v[52:55], v[208:223]
    v_mfma_f32_32x32x16_bf16 v[224:239], a[184:187], v[52:55], v[224:239]
    v_mfma_f32_32x32x16_bf16 v[240:255], a[188:191], v[52:55], v[240:255]
    v_mov_b32 v43, v41
    s_nop 1
    v_permlane32_swap_b32 v41, v43
    v_add_f32 v41, v41, v43
    v_log_f32 v44, v41
    v_rcp_f32 v43, v41
    v_add_f32 v44, v44, v40
    v_lshlrev_b32 v16, 13, v7
    s_lshl_b32 s53, s48, 9
    s_mul_i32 s54, s42, 7340032
    s_add_u32 s53, s53, s54
    v_add_u32 v16, s53, v16
    v_lshl_add_u32 v16, v3, 4, v16
    s_mul_i32 s54, s42, 896
    v_add_u32 v18, s54, v7
    v_lshlrev_b32 v18, 4, v18
    v_add_u32 v18, s48, v18
    v_lshlrev_b32 v18, 2, v18
    v_add_u32 v18, 14680064, v18
    s_lshl_b32 s53, s40, 5
    v_add_u32 v17, s53, v2
    v_cmp_gt_u32 vcc, 112, v17
    v_mov_b32 v17, 0x7fff0000
    s_nop 1
    v_cndmask_b32 v16, v17, v16, vcc
    v_cndmask_b32 v18, v17, v18, vcc
    buffer_store_dword v44, v18, s[36:39], 0 offen
    s_nop 15
    v_mul_f32 v128, v128, v43
    v_mul_f32 v129, v129, v43
    v_mul_f32 v130, v130, v43
    v_mul_f32 v131, v131, v43
    v_mul_f32 v132, v132, v43
    v_mul_f32 v133, v133, v43
    v_mul_f32 v134, v134, v43
    v_mul_f32 v135, v135, v43
    v_cvt_pk_bf16_f32 v120, v128, v129
    v_cvt_pk_bf16_f32 v121, v130, v131
    v_cvt_pk_bf16_f32 v122, v132, v133
    v_cvt_pk_bf16_f32 v123, v134, v135
    s_nop 1
    v_permlane32_swap_b32 v120, v122
    v_permlane32_swap_b32 v121, v123
    s_nop 1
    buffer_store_dwordx4 v[120:123], v16, s[36:39], 0 offen offset:0
    s_nop 1
    v_mul_f32 v136, v136, v43
    v_mul_f32 v137, v137, v43
    v_mul_f32 v138, v138, v43
    v_mul_f32 v139, v139, v43
    v_mul_f32 v140, v140, v43
    v_mul_f32 v141, v141, v43
    v_mul_f32 v142, v142, v43
    v_mul_f32 v143, v143, v43
    v_cvt_pk_bf16_f32 v120, v136, v137
    v_cvt_pk_bf16_f32 v121, v138, v139
    v_cvt_pk_bf16_f32 v122, v140, v141
    v_cvt_pk_bf16_f32 v123, v142, v143
    s_nop 1
    v_permlane32_swap_b32 v120, v122
    v_permlane32_swap_b32 v121, v123
    s_nop 1
    buffer_store_dwordx4 v[120:123], v16, s[36:39], 0 offen offset:32
    s_nop 1
    v_mul_f32 v144, v144, v43
    v_mul_f32 v145, v145, v43
    v_mul_f32 v146, v146, v43
    v_mul_f32 v147, v147, v43
    v_mul_f32 v148, v148, v43
    v_mul_f32 v149, v149, v43
    v_mul_f32 v150, v150, v43
    v_mul_f32 v151, v151, v43
    v_cvt_pk_bf16_f32 v120, v144, v145
    v_cvt_pk_bf16_f32 v121, v146, v147
    v_cvt_pk_bf16_f32 v122, v148, v149
    v_cvt_pk_bf16_f32 v123, v150, v151
    s_nop 1
    v_permlane32_swap_b32 v120, v122
    v_permlane32_swap_b32 v121, v123
    s_nop 1
    buffer_store_dwordx4 v[120:123], v16, s[36:39], 0 offen offset:64
    s_nop 1
    v_mul_f32 v152, v152, v43
    v_mul_f32 v153, v153, v43
    v_mul_f32 v154, v154, v43
    v_mul_f32 v155, v155, v43
    v_mul_f32 v156, v156, v43
    v_mul_f32 v157, v157, v43
    v_mul_f32 v158, v158, v43
    v_mul_f32 v159, v159, v43
    v_cvt_pk_bf16_f32 v120, v152, v153
    v_cvt_pk_bf16_f32 v121, v154, v155
    v_cvt_pk_bf16_f32 v122, v156, v157
    v_cvt_pk_bf16_f32 v123, v158, v159
    s_nop 1
    v_permlane32_swap_b32 v120, v122
    v_permlane32_swap_b32 v121, v123
    s_nop 1
    buffer_store_dwordx4 v[120:123], v16, s[36:39], 0 offen offset:96
    s_nop 1
    v_mul_f32 v160, v160, v43
    v_mul_f32 v161, v161, v43
    v_mul_f32 v162, v162, v43
    v_mul_f32 v163, v163, v43
    v_mul_f32 v164, v164, v43
    v_mul_f32 v165, v165, v43
    v_mul_f32 v166, v166, v43
    v_mul_f32 v167, v167, v43
    v_cvt_pk_bf16_f32 v120, v160, v161
    v_cvt_pk_bf16_f32 v121, v162, v163
    v_cvt_pk_bf16_f32 v122, v164, v165
    v_cvt_pk_bf16_f32 v123, v166, v167
    s_nop 1
    v_permlane32_swap_b32 v120, v122
    v_permlane32_swap_b32 v121, v123
    s_nop 1
    buffer_store_dwordx4 v[120:123], v16, s[36:39], 0 offen offset:128
    s_nop 1
    v_mul_f32 v168, v168, v43
    v_mul_f32 v169, v169, v43
    v_mul_f32 v170, v170, v43
    v_mul_f32 v171, v171, v43
    v_mul_f32 v172, v172, v43
    v_mul_f32 v173, v173, v43
    v_mul_f32 v174, v174, v43
    v_mul_f32 v175, v175, v43
    v_cvt_pk_bf16_f32 v120, v168, v169
    v_cvt_pk_bf16_f32 v121, v170, v171
    v_cvt_pk_bf16_f32 v122, v172, v173
    v_cvt_pk_bf16_f32 v123, v174, v175
    s_nop 1
    v_permlane32_swap_b32 v120, v122
    v_permlane32_swap_b32 v121, v123
    s_nop 1
    buffer_store_dwordx4 v[120:123], v16, s[36:39], 0 offen offset:160
    s_nop 1
    v_mul_f32 v176, v176, v43
    v_mul_f32 v177, v177, v43
    v_mul_f32 v178, v178, v43
    v_mul_f32 v179, v179, v43
    v_mul_f32 v180, v180, v43
    v_mul_f32 v181, v181, v43
    v_mul_f32 v182, v182, v43
    v_mul_f32 v183, v183, v43
    v_cvt_pk_bf16_f32 v120, v176, v177
    v_cvt_pk_bf16_f32 v121, v178, v179
    v_cvt_pk_bf16_f32 v122, v180, v181
    v_cvt_pk_bf16_f32 v123, v182, v183
    s_nop 1
    v_permlane32_swap_b32 v120, v122
    v_permlane32_swap_b32 v121, v123
    s_nop 1
    buffer_store_dwordx4 v[120:123], v16, s[36:39], 0 offen offset:192
    s_nop 1
    v_mul_f32 v184, v184, v43
    v_mul_f32 v185, v185, v43
    v_mul_f32 v186, v186, v43
    v_mul_f32 v187, v187, v43
    v_mul_f32 v188, v188, v43
    v_mul_f32 v189, v189, v43
    v_mul_f32 v190, v190, v43
    v_mul_f32 v191, v191, v43
    v_cvt_pk_bf16_f32 v120, v184, v185
    v_cvt_pk_bf16_f32 v121, v186, v187
    v_cvt_pk_bf16_f32 v122, v188, v189
    v_cvt_pk_bf16_f32 v123, v190, v191
    s_nop 1
    v_permlane32_swap_b32 v120, v122
    v_permlane32_swap_b32 v121, v123
    s_nop 1
    buffer_store_dwordx4 v[120:123], v16, s[36:39], 0 offen offset:224
    s_nop 1
    v_mul_f32 v192, v192, v43
    v_mul_f32 v193, v193, v43
    v_mul_f32 v194, v194, v43
    v_mul_f32 v195, v195, v43
    v_mul_f32 v196, v196, v43
    v_mul_f32 v197, v197, v43
    v_mul_f32 v198, v198, v43
    v_mul_f32 v199, v199, v43
    v_cvt_pk_bf16_f32 v120, v192, v193
    v_cvt_pk_bf16_f32 v121, v194, v195
    v_cvt_pk_bf16_f32 v122, v196, v197
    v_cvt_pk_bf16_f32 v123, v198, v199
    s_nop 1
    v_permlane32_swap_b32 v120, v122
    v_permlane32_swap_b32 v121, v123
    s_nop 1
    buffer_store_dwordx4 v[120:123], v16, s[36:39], 0 offen offset:256
    s_nop 1
    v_mul_f32 v200, v200, v43
    v_mul_f32 v201, v201, v43
    v_mul_f32 v202, v202, v43
    v_mul_f32 v203, v203, v43
    v_mul_f32 v204, v204, v43
    v_mul_f32 v205, v205, v43
    v_mul_f32 v206, v206, v43
    v_mul_f32 v207, v207, v43
    v_cvt_pk_bf16_f32 v120, v200, v201
    v_cvt_pk_bf16_f32 v121, v202, v203
    v_cvt_pk_bf16_f32 v122, v204, v205
    v_cvt_pk_bf16_f32 v123, v206, v207
    s_nop 1
    v_permlane32_swap_b32 v120, v122
    v_permlane32_swap_b32 v121, v123
    s_nop 1
    buffer_store_dwordx4 v[120:123], v16, s[36:39], 0 offen offset:288
    s_nop 1
    v_mul_f32 v208, v208, v43
    v_mul_f32 v209, v209, v43
    v_mul_f32 v210, v210, v43
    v_mul_f32 v211, v211, v43
    v_mul_f32 v212, v212, v43
    v_mul_f32 v213, v213, v43
    v_mul_f32 v214, v214, v43
    v_mul_f32 v215, v215, v43
    v_cvt_pk_bf16_f32 v120, v208, v209
    v_cvt_pk_bf16_f32 v121, v210, v211
    v_cvt_pk_bf16_f32 v122, v212, v213
    v_cvt_pk_bf16_f32 v123, v214, v215
    s_nop 1
    v_permlane32_swap_b32 v120, v122
    v_permlane32_swap_b32 v121, v123
    s_nop 1
    buffer_store_dwordx4 v[120:123], v16, s[36:39], 0 offen offset:320
    s_nop 1
    v_mul_f32 v216, v216, v43
    v_mul_f32 v217, v217, v43
    v_mul_f32 v218, v218, v43
    v_mul_f32 v219, v219, v43
    v_mul_f32 v220, v220, v43
    v_mul_f32 v221, v221, v43
    v_mul_f32 v222, v222, v43
    v_mul_f32 v223, v223, v43
    v_cvt_pk_bf16_f32 v120, v216, v217
    v_cvt_pk_bf16_f32 v121, v218, v219
    v_cvt_pk_bf16_f32 v122, v220, v221
    v_cvt_pk_bf16_f32 v123, v222, v223
    s_nop 1
    v_permlane32_swap_b32 v120, v122
    v_permlane32_swap_b32 v121, v123
    s_nop 1
    buffer_store_dwordx4 v[120:123], v16, s[36:39], 0 offen offset:352
    s_nop 1
    v_mul_f32 v224, v224, v43
    v_mul_f32 v225, v225, v43
    v_mul_f32 v226, v226, v43
    v_mul_f32 v227, v227, v43
    v_mul_f32 v228, v228, v43
    v_mul_f32 v229, v229, v43
    v_mul_f32 v230, v230, v43
    v_mul_f32 v231, v231, v43
    v_cvt_pk_bf16_f32 v120, v224, v225
    v_cvt_pk_bf16_f32 v121, v226, v227
    v_cvt_pk_bf16_f32 v122, v228, v229
    v_cvt_pk_bf16_f32 v123, v230, v231
    s_nop 1
    v_permlane32_swap_b32 v120, v122
    v_permlane32_swap_b32 v121, v123
    s_nop 1
    buffer_store_dwordx4 v[120:123], v16, s[36:39], 0 offen offset:384
    s_nop 1
    v_mul_f32 v232, v232, v43
    v_mul_f32 v233, v233, v43
    v_mul_f32 v234, v234, v43
    v_mul_f32 v235, v235, v43
    v_mul_f32 v236, v236, v43
    v_mul_f32 v237, v237, v43
    v_mul_f32 v238, v238, v43
    v_mul_f32 v239, v239, v43
    v_cvt_pk_bf16_f32 v120, v232, v233
    v_cvt_pk_bf16_f32 v121, v234, v235
    v_cvt_pk_bf16_f32 v122, v236, v237
    v_cvt_pk_bf16_f32 v123, v238, v239
    s_nop 1
    v_permlane32_swap_b32 v120, v122
    v_permlane32_swap_b32 v121, v123
    s_nop 1
    buffer_store_dwordx4 v[120:123], v16, s[36:39], 0 offen offset:416
    s_nop 1
    v_mul_f32 v240, v240, v43
    v_mul_f32 v241, v241, v43
    v_mul_f32 v242, v242, v43
    v_mul_f32 v243, v243, v43
    v_mul_f32 v244, v244, v43
    v_mul_f32 v245, v245, v43
    v_mul_f32 v246, v246, v43
    v_mul_f32 v247, v247, v43
    v_cvt_pk_bf16_f32 v120, v240, v241
    v_cvt_pk_bf16_f32 v121, v242, v243
    v_cvt_pk_bf16_f32 v122, v244, v245
    v_cvt_pk_bf16_f32 v123, v246, v247
    s_nop 1
    v_permlane32_swap_b32 v120, v122
    v_permlane32_swap_b32 v121, v123
    s_nop 1
    buffer_store_dwordx4 v[120:123], v16, s[36:39], 0 offen offset:448
    s_nop 1
    v_mul_f32 v248, v248, v43
    v_mul_f32 v249, v249, v43
    v_mul_f32 v250, v250, v43
    v_mul_f32 v251, v251, v43
    v_mul_f32 v252, v252, v43
    v_mul_f32 v253, v253, v43
    v_mul_f32 v254, v254, v43
    v_mul_f32 v255, v255, v43
    v_cvt_pk_bf16_f32 v120, v248, v249
    v_cvt_pk_bf16_f32 v121, v250, v251
    v_cvt_pk_bf16_f32 v122, v252, v253
    v_cvt_pk_bf16_f32 v123, v254, v255
    s_nop 1
    v_permlane32_swap_b32 v120, v122
    v_permlane32_swap_b32 v121, v123
    s_nop 1
    buffer_store_dwordx4 v[120:123], v16, s[36:39], 0 offen offset:480
    s_nop 1
LA_end:
    s_endpgm
.globl oproj_kernel
.p2align 8
.type oproj_kernel,@function
oproj_kernel:
    s_cmp_ge_u32 s2, 224
    s_cbranch_scc1 LB_end
    s_load_dwordx16 s[4:19], s[0:1], 0
    v_lshrrev_b32 v1, 6, v0
    s_nop 0
    v_readfirstlane_b32 s40, v1
    s_and_b32 s44, s2, 7
    s_lshr_b32 s45, s2, 3
    s_mov_b32 s41, 0x24924925
    s_mul_hi_u32 s42, s45, s41
    s_mul_i32 s43, s42, 7
    s_sub_u32 s43, s45, s43
    s_lshl_b32 s42, s42, 3
    s_add_u32 s42, s42, s44
    s_cmp_ge_u32 s42, 28
    s_cbranch_scc1 LB_end
    s_waitcnt lgkmcnt(0)
    s_mov_b32 s20, s18
    s_mov_b32 s21, s19
    s_mov_b32 s22, 14794752
    s_mov_b32 s23, 0x00020000
    s_mov_b32 s24, s12
    s_mov_b32 s25, s13
    s_mov_b32 s26, 3670016
    s_mov_b32 s27, 0x00020000
    s_mov_b32 s28, s14
    s_mov_b32 s29, s15
    s_mov_b32 s30, 802816
    s_mov_b32 s31, 0x00020000
    v_and_b32 v1, 63, v0
    v_and_b32 v2, 31, v1
    v_lshrrev_b32 v3, 5, v1
    v_bfe_u32 v4, v1, 4, 1
    v_bfe_u32 v5, v1, 2, 2
    v_and_b32 v6, 3, v1
    s_lshl_b32 s44, s42, 5
    v_add_u32 v7, s44, v2
    v_lshlrev_b32 v8, 6, v7
    s_lshl_b32 s44, s40, 4
    s_add_u32 s44, s44, 14680064
    v_add_u32 v8, s44, v8
    buffer_load_dwordx4 v[20:23], v8, s[20:23], 0 offen
    v_add_u32 v9, 57344, v8
    buffer_load_dwordx4 v[24:27], v9, s[20:23], 0 offen
    v_lshrrev_b32 v10, 3, v1
    v_lshrrev_b32 v11, 4, v1
    v_and_b32 v14, 7, v1
    s_lshl_b32 s44, s42, 18
    s_lshl_b32 s47, s40, 11
    s_add_u32 s44, s44, s47
    v_add_u32 v16, 0, v11
    v_and_b32 v16, 7, v16
    v_xor_b32 v16, v16, v14
    v_lshlrev_b32 v16, 4, v16
    v_lshl_add_u32 v8, v10, 13, v16
    v_add_u32 v8, s44, v8
    v_add_u32 v16, 4, v11
    v_and_b32 v16, 7, v16
    v_xor_b32 v16, v16, v14
    v_lshlrev_b32 v16, 4, v16
    v_lshl_add_u32 v15, v10, 13, v16
    v_add_u32 v15, s44, v15
    v_lshrrev_b32 v10, 1, v2
    v_and_b32 v10, 7, v10
    s_lshl_b32 s44, s40, 15
    v_add_u32 v11, 0, v3
    v_xor_b32 v11, v11, v10
    v_lshlrev_b32 v11, 4, v11
    v_lshl_add_u32 v16, v2, 7, v11
    v_add_u32 v16, s44, v16
    v_add_u32 v11, 2, v3
    v_xor_b32 v11, v11, v10
    v_lshlrev_b32 v11, 4, v11
    v_lshl_add_u32 v17, v2, 7, v11
    v_add_u32 v17, s44, v17
    v_add_u32 v11, 4, v3
    v_xor_b32 v11, v11, v10
    v_lshlrev_b32 v11, 4, v11
    v_lshl_add_u32 v18, v2, 7, v11
    v_add_u32 v18, s44, v18
    v_add_u32 v11, 6, v3
    v_xor_b32 v11, v11, v10
    v_lshlrev_b32 v11, 4, v11
    v_lshl_add_u32 v19, v2, 7, v11
    v_add_u32 v19, s44, v19
    v_lshrrev_b32 v10, 3, v1
    v_mul_u32_u24 v9, 896, v10
    v_and_b32 v10, 7, v1
    v_lshlrev_b32 v11, 2, v4
    v_xor_b32 v10, v10, v11
    v_lshl_add_u32 v9, v10, 4, v9
    s_lshl_b32 s44, s43, 7
    v_add_u32 v9, s44, v9
    v_lshlrev_b32 v10, 3, v3
    v_add_u32 v10, v10, v5
    v_lshlrev_b32 v10, 7, v10
    s_lshl_b32 s44, s40, 15
    v_add_u32 v10, s44, v10
    v_lshrrev_b32 v11, 1, v6
    v_lshl_add_u32 v11, v4, 1, v11
    v_lshl_add_u32 v10, v11, 4, v10
    v_and_b32 v11, 1, v6
    v_lshl_add_u32 v10, v11, 3, v10
    v_lshrrev_b32 v11, 1, v5
    v_xor_b32 v14, 0, v11
    v_lshl_add_u32 v12, v14, 6, v10
    v_xor_b32 v14, 1, v11
    v_lshl_add_u32 v13, v14, 6, v10
    v_mov_b32 v32, 0
    v_mov_b32 v33, 0
    v_mov_b32 v34, 0
    v_mov_b32 v35, 0
    v_mov_b32 v36, 0
    v_mov_b32 v37, 0
    v_mov_b32 v38, 0
    v_mov_b32 v39, 0
    v_mov_b32 v40, 0
    v_mov_b32 v41, 0
    v_mov_b32 v42, 0
    v_mov_b32 v43, 0
    v_mov_b32 v44, 0
    v_mov_b32 v45, 0
    v_mov_b32 v46, 0
    v_mov_b32 v47, 0
    v_mov_b32 v48, 0
    v_mov_b32 v49, 0
    v_mov_b32 v50, 0
    v_mov_b32 v51, 0
    v_mov_b32 v52, 0
    v_mov_b32 v53, 0
    v_mov_b32 v54, 0
    v_mov_b32 v55, 0
    v_mov_b32 v56, 0
    v_mov_b32 v57, 0
    v_mov_b32 v58, 0
    v_mov_b32 v59, 0
    v_mov_b32 v60, 0
    v_mov_b32 v61, 0
    v_mov_b32 v62, 0
    v_mov_b32 v63, 0
    s_mul_i32 s45, s40, 917504
    s_lshl_b32 s46, s40, 15
    s_add_u32 m0, s46, 0
    s_add_u32 s47, s45, 0
    buffer_load_dwordx4 v9, s[24:27], s47 offen lds
    s_add_u32 m0, s46, 1024
    s_add_u32 s47, s45, 7168
    buffer_load_dwordx4 v9, s[24:27], s47 offen lds
    s_add_u32 m0, s46, 2048
    s_add_u32 s47, s45, 14336
    buffer_load_dwordx4 v9, s[24:27], s47 offen lds
    s_add_u32 m0, s46, 3072
    s_add_u32 s47, s45, 21504
    buffer_load_dwordx4 v9, s[24:27], s47 offen lds
    s_add_u32 m0, s46, 4096
    s_add_u32 s47, s45, 28672
    buffer_load_dwordx4 v9, s[24:27], s47 offen lds
    s_add_u32 m0, s46, 5120
    s_add_u32 s47, s45, 35840
    buffer_load_dwordx4 v9, s[24:27], s47 offen lds
    s_add_u32 m0, s46, 6144
    s_add_u32 s47, s45, 43008
    buffer_load_dwordx4 v9, s[24:27], s47 offen lds
    s_add_u32 m0, s46, 7168
    s_add_u32 s47, s45, 50176
    buffer_load_dwordx4 v9, s[24:27], s47 offen lds
    s_add_u32 m0, s46, 8192
    s_mov_b32 s47, 0
    buffer_load_dwordx4 v8, s[20:23], s47 offen lds
    s_add_u32 m0, s46, 9216
    s_mov_b32 s47, 65536
    buffer_load_dwordx4 v15, s[20:23], s47 offen lds
    s_add_u32 m0, s46, 10240
    s_mov_b32 s47, 131072
    buffer_load_dwordx4 v8, s[20:23], s47 offen lds
    s_add_u32 m0, s46, 11264
    s_mov_b32 s47, 196608
    buffer_load_dwordx4 v15, s[20:23], s47 offen lds
    s_add_u32 m0, s46, 12288
    s_mov_b32 s47, 7340032
    buffer_load_dwordx4 v8, s[20:23], s47 offen lds
    s_add_u32 m0, s46, 13312
    s_mov_b32 s47, 7405568
    buffer_load_dwordx4 v15, s[20:23], s47 offen lds
    s_add_u32 m0, s46, 14336
    s_mov_b32 s47, 7471104
    buffer_load_dwordx4 v8, s[20:23], s47 offen lds
    s_add_u32 m0, s46, 15360
    s_mov_b32 s47, 7536640
    buffer_load_dwordx4 v15, s[20:23], s47 offen lds
    s_waitcnt vmcnt(16)
    v_max_f32 v28, v20, v24
    v_sub_f32 v20, v20, v28
    v_sub_f32 v24, v24, v28
    v_exp_f32 v20, v20
    v_exp_f32 v24, v24
    s_nop 0
    v_add_f32 v28, v20, v24
    v_rcp_f32 v28, v28
    s_nop 0
    v_mul_f32 v20, v20, v28
    v_mul_f32 v24, v24, v28
    v_max_f32 v28, v21, v25
    v_sub_f32 v21, v21, v28
    v_sub_f32 v25, v25, v28
    v_exp_f32 v21, v21
    v_exp_f32 v25, v25
    s_nop 0
    v_add_f32 v28, v21, v25
    v_rcp_f32 v28, v28
    s_nop 0
    v_mul_f32 v21, v21, v28
    v_mul_f32 v25, v25, v28
    v_max_f32 v28, v22, v26
    v_sub_f32 v22, v22, v28
    v_sub_f32 v26, v26, v28
    v_exp_f32 v22, v22
    v_exp_f32 v26, v26
    s_nop 0
    v_add_f32 v28, v22, v26
    v_rcp_f32 v28, v28
    s_nop 0
    v_mul_f32 v22, v22, v28
    v_mul_f32 v26, v26, v28
    v_max_f32 v28, v23, v27
    v_sub_f32 v23, v23, v28
    v_sub_f32 v27, v27, v28
    v_exp_f32 v23, v23
    v_exp_f32 v27, v27
    s_nop 0
    v_add_f32 v28, v23, v27
    v_rcp_f32 v28, v28
    s_nop 0
    v_mul_f32 v23, v23, v28
    v_mul_f32 v27, v27, v28
    s_add_u32 m0, s46, 16384
    s_add_u32 s47, s45, 57344
    buffer_load_dwordx4 v9, s[24:27], s47 offen lds
    s_add_u32 m0, s46, 17408
    s_add_u32 s47, s45, 64512
    buffer_load_dwordx4 v9, s[24:27], s47 offen lds
    s_add_u32 m0, s46, 18432
    s_add_u32 s47, s45, 71680
    buffer_load_dwordx4 v9, s[24:27], s47 offen lds
    s_add_u32 m0, s46, 19456
    s_add_u32 s47, s45, 78848
    buffer_load_dwordx4 v9, s[24:27], s47 offen lds
    s_add_u32 m0, s46, 20480
    s_add_u32 s47, s45, 86016
    buffer_load_dwordx4 v9, s[24:27], s47 offen lds
    s_add_u32 m0, s46, 21504
    s_add_u32 s47, s45, 93184
    buffer_load_dwordx4 v9, s[24:27], s47 offen lds
    s_add_u32 m0, s46, 22528
    s_add_u32 s47, s45, 100352
    buffer_load_dwordx4 v9, s[24:27], s47 offen lds
    s_add_u32 m0, s46, 23552
    s_add_u32 s47, s45, 107520
    buffer_load_dwordx4 v9, s[24:27], s47 offen lds
    s_add_u32 m0, s46, 24576
    s_mov_b32 s47, 128
    buffer_load_dwordx4 v8, s[20:23], s47 offen lds
    s_add_u32 m0, s46, 25600
    s_mov_b32 s47, 65664
    buffer_load_dwordx4 v15, s[20:23], s47 offen lds
    s_add_u32 m0, s46, 26624
    s_mov_b32 s47, 131200
    buffer_load_dwordx4 v8, s[20:23], s47 offen lds
    s_add_u32 m0, s46, 27648
    s_mov_b32 s47, 196736
    buffer_load_dwordx4 v15, s[20:23], s47 offen lds
    s_add_u32 m0, s46, 28672
    s_mov_b32 s47, 7340160
    buffer_load_dwordx4 v8, s[20:23], s47 offen lds
    s_add_u32 m0, s46, 29696
    s_mov_b32 s47, 7405696
    buffer_load_dwordx4 v15, s[20:23], s47 offen lds
    s_add_u32 m0, s46, 30720
    s_mov_b32 s47, 7471232
    buffer_load_dwordx4 v8, s[20:23], s47 offen lds
    s_add_u32 m0, s46, 31744
    s_mov_b32 s47, 7536768
    buffer_load_dwordx4 v15, s[20:23], s47 offen lds
    s_waitcnt vmcnt(16)
    ds_read_b64_tr_b16 a[0:1], v12 offset:0
    ds_read_b64_tr_b16 a[2:3], v12 offset:512
    ds_read_b64_tr_b16 a[4:5], v13 offset:0
    ds_read_b64_tr_b16 a[6:7], v13 offset:512
    ds_read_b128 v[128:131], v16 offset:8192
    ds_read_b128 v[144:147], v16 offset:12288
    ds_read_b64_tr_b16 a[8:9], v12 offset:2048
    ds_read_b64_tr_b16 a[10:11], v12 offset:2560
    ds_read_b64_tr_b16 a[12:13], v13 offset:2048
    ds_read_b64_tr_b16 a[14:15], v13 offset:2560
    ds_read_b128 v[132:135], v17 offset:8192
    ds_read_b128 v[148:151], v17 offset:12288
    ds_read_b64_tr_b16 a[16:17], v12 offset:4096
    ds_read_b64_tr_b16 a[18:19], v12 offset:4608
    ds_read_b64_tr_b16 a[20:21], v13 offset:4096
    ds_read_b64_tr_b16 a[22:23], v13 offset:4608
    ds_read_b128 v[136:139], v18 offset:8192
    ds_read_b128 v[152:155], v18 offset:12288
    ds_read_b64_tr_b16 a[24:25], v12 offset:6144
    ds_read_b64_tr_b16 a[26:27], v12 offset:6656
    ds_read_b64_tr_b16 a[28:29], v13 offset:6144
    ds_read_b64_tr_b16 a[30:31], v13 offset:6656
    ds_read_b128 v[140:143], v19 offset:8192
    ds_read_b128 v[156:159], v19 offset:12288
    s_waitcnt lgkmcnt(15)
    v_mfma_f32_32x32x16_bf16 v[64:79], a[0:3], v[128:131], 0
    v_mfma_f32_32x32x16_bf16 v[80:95], a[4:7], v[128:131], 0
    v_mfma_f32_32x32x16_bf16 v[96:111], a[0:3], v[144:147], 0
    v_mfma_f32_32x32x16_bf16 v[112:127], a[4:7], v[144:147], 0
    s_waitcnt lgkmcnt(12)
    v_mfma_f32_32x32x16_bf16 v[64:79], a[8:11], v[132:135], v[64:79]
    v_mfma_f32_32x32x16_bf16 v[80:95], a[12:15], v[132:135], v[80:95]
    v_mfma_f32_32x32x16_bf16 v[96:111], a[8:11], v[148:151], v[96:111]
    v_mfma_f32_32x32x16_bf16 v[112:127], a[12:15], v[148:151], v[112:127]
    s_waitcnt lgkmcnt(6)
    v_mfma_f32_32x32x16_bf16 v[64:79], a[16:19], v[136:139], v[64:79]
    v_mfma_f32_32x32x16_bf16 v[80:95], a[20:23], v[136:139], v[80:95]
    v_mfma_f32_32x32x16_bf16 v[96:111], a[16:19], v[152:155], v[96:111]
    v_mfma_f32_32x32x16_bf16 v[112:127], a[20:23], v[152:155], v[112:127]
    s_waitcnt lgkmcnt(0)
    v_mfma_f32_32x32x16_bf16 v[64:79], a[24:27], v[140:143], v[64:79]
    v_mfma_f32_32x32x16_bf16 v[80:95], a[28:31], v[140:143], v[80:95]
    v_mfma_f32_32x32x16_bf16 v[96:111], a[24:27], v[156:159], v[96:111]
    v_mfma_f32_32x32x16_bf16 v[112:127], a[28:31], v[156:159], v[112:127]
    s_add_u32 m0, s46, 0
    s_add_u32 s47, s45, 114688
    buffer_load_dwordx4 v9, s[24:27], s47 offen lds
    s_add_u32 m0, s46, 1024
    s_add_u32 s47, s45, 121856
    buffer_load_dwordx4 v9, s[24:27], s47 offen lds
    s_add_u32 m0, s46, 2048
    s_add_u32 s47, s45, 129024
    buffer_load_dwordx4 v9, s[24:27], s47 offen lds
    s_add_u32 m0, s46, 3072
    s_add_u32 s47, s45, 136192
    buffer_load_dwordx4 v9, s[24:27], s47 offen lds
    s_add_u32 m0, s46, 4096
    s_add_u32 s47, s45, 143360
    buffer_load_dwordx4 v9, s[24:27], s47 offen lds
    s_add_u32 m0, s46, 5120
    s_add_u32 s47, s45, 150528
    buffer_load_dwordx4 v9, s[24:27], s47 offen lds
    s_add_u32 m0, s46, 6144
    s_add_u32 s47, s45, 157696
    buffer_load_dwordx4 v9, s[24:27], s47 offen lds
    s_add_u32 m0, s46, 7168
    s_add_u32 s47, s45, 164864
    buffer_load_dwordx4 v9, s[24:27], s47 offen lds
    s_add_u32 m0, s46, 8192
    s_mov_b32 s47, 256
    buffer_load_dwordx4 v8, s[20:23], s47 offen lds
    s_add_u32 m0, s46, 9216
    s_mov_b32 s47, 65792
    buffer_load_dwordx4 v15, s[20:23], s47 offen lds
    s_add_u32 m0, s46, 10240
    s_mov_b32 s47, 131328
    buffer_load_dwordx4 v8, s[20:23], s47 offen lds
    s_add_u32 m0, s46, 11264
    s_mov_b32 s47, 196864
    buffer_load_dwordx4 v15, s[20:23], s47 offen lds
    s_add_u32 m0, s46, 12288
    s_mov_b32 s47, 7340288
    buffer_load_dwordx4 v8, s[20:23], s47 offen lds
    s_add_u32 m0, s46, 13312
    s_mov_b32 s47, 7405824
    buffer_load_dwordx4 v15, s[20:23], s47 offen lds
    s_add_u32 m0, s46, 14336
    s_mov_b32 s47, 7471360
    buffer_load_dwordx4 v8, s[20:23], s47 offen lds
    s_add_u32 m0, s46, 15360
    s_mov_b32 s47, 7536896
    buffer_load_dwordx4 v15, s[20:23], s47 offen lds
    s_waitcnt vmcnt(16)
    ds_read_b64_tr_b16 a[0:1], v12 offset:16384
    ds_read_b64_tr_b16 a[2:3], v12 offset:16896
    ds_read_b64_tr_b16 a[4:5], v13 offset:16384
    ds_read_b64_tr_b16 a[6:7], v13 offset:16896
    ds_read_b128 v[128:131], v16 offset:24576
    ds_read_b128 v[144:147], v16 offset:28672
    ds_read_b64_tr_b16 a[8:9], v12 offset:18432
    ds_read_b64_tr_b16 a[10:11], v12 offset:18944
    ds_read_b64_tr_b16 a[12:13], v13 offset:18432
    ds_read_b64_tr_b16 a[14:15], v13 offset:18944
    ds_read_b128 v[132:135], v17 offset:24576
    ds_read_b128 v[148:151], v17 offset:28672
    ds_read_b64_tr_b16 a[16:17], v12 offset:20480
    ds_read_b64_tr_b16 a[18:19], v12 offset:20992
    ds_read_b64_tr_b16 a[20:21], v13 offset:20480
    ds_read_b64_tr_b16 a[22:23], v13 offset:20992
    ds_read_b128 v[136:139], v18 offset:24576
    ds_read_b128 v[152:155], v18 offset:28672
    ds_read_b64_tr_b16 a[24:25], v12 offset:22528
    ds_read_b64_tr_b16 a[26:27], v12 offset:23040
    ds_read_b64_tr_b16 a[28:29], v13 offset:22528
    ds_read_b64_tr_b16 a[30:31], v13 offset:23040
    ds_read_b128 v[140:143], v19 offset:24576
    ds_read_b128 v[156:159], v19 offset:28672
    s_waitcnt lgkmcnt(15)
    v_mfma_f32_32x32x16_bf16 v[64:79], a[0:3], v[128:131], v[64:79]
    v_mfma_f32_32x32x16_bf16 v[80:95], a[4:7], v[128:131], v[80:95]
    v_mfma_f32_32x32x16_bf16 v[96:111], a[0:3], v[144:147], v[96:111]
    v_mfma_f32_32x32x16_bf16 v[112:127], a[4:7], v[144:147], v[112:127]
    s_waitcnt lgkmcnt(12)
    v_mfma_f32_32x32x16_bf16 v[64:79], a[8:11], v[132:135], v[64:79]
    v_mfma_f32_32x32x16_bf16 v[80:95], a[12:15], v[132:135], v[80:95]
    v_mfma_f32_32x32x16_bf16 v[96:111], a[8:11], v[148:151], v[96:111]
    v_mfma_f32_32x32x16_bf16 v[112:127], a[12:15], v[148:151], v[112:127]
    s_waitcnt lgkmcnt(6)
    v_mfma_f32_32x32x16_bf16 v[64:79], a[16:19], v[136:139], v[64:79]
    v_mfma_f32_32x32x16_bf16 v[80:95], a[20:23], v[136:139], v[80:95]
    v_mfma_f32_32x32x16_bf16 v[96:111], a[16:19], v[152:155], v[96:111]
    v_mfma_f32_32x32x16_bf16 v[112:127], a[20:23], v[152:155], v[112:127]
    s_waitcnt lgkmcnt(0)
    v_mfma_f32_32x32x16_bf16 v[64:79], a[24:27], v[140:143], v[64:79]
    v_mfma_f32_32x32x16_bf16 v[80:95], a[28:31], v[140:143], v[80:95]
    v_mfma_f32_32x32x16_bf16 v[96:111], a[24:27], v[156:159], v[96:111]
    v_mfma_f32_32x32x16_bf16 v[112:127], a[28:31], v[156:159], v[112:127]
    s_add_u32 m0, s46, 16384
    s_add_u32 s47, s45, 172032
    buffer_load_dwordx4 v9, s[24:27], s47 offen lds
    s_add_u32 m0, s46, 17408
    s_add_u32 s47, s45, 179200
    buffer_load_dwordx4 v9, s[24:27], s47 offen lds
    s_add_u32 m0, s46, 18432
    s_add_u32 s47, s45, 186368
    buffer_load_dwordx4 v9, s[24:27], s47 offen lds
    s_add_u32 m0, s46, 19456
    s_add_u32 s47, s45, 193536
    buffer_load_dwordx4 v9, s[24:27], s47 offen lds
    s_add_u32 m0, s46, 20480
    s_add_u32 s47, s45, 200704
    buffer_load_dwordx4 v9, s[24:27], s47 offen lds
    s_add_u32 m0, s46, 21504
    s_add_u32 s47, s45, 207872
    buffer_load_dwordx4 v9, s[24:27], s47 offen lds
    s_add_u32 m0, s46, 22528
    s_add_u32 s47, s45, 215040
    buffer_load_dwordx4 v9, s[24:27], s47 offen lds
    s_add_u32 m0, s46, 23552
    s_add_u32 s47, s45, 222208
    buffer_load_dwordx4 v9, s[24:27], s47 offen lds
    s_add_u32 m0, s46, 24576
    s_mov_b32 s47, 384
    buffer_load_dwordx4 v8, s[20:23], s47 offen lds
    s_add_u32 m0, s46, 25600
    s_mov_b32 s47, 65920
    buffer_load_dwordx4 v15, s[20:23], s47 offen lds
    s_add_u32 m0, s46, 26624
    s_mov_b32 s47, 131456
    buffer_load_dwordx4 v8, s[20:23], s47 offen lds
    s_add_u32 m0, s46, 27648
    s_mov_b32 s47, 196992
    buffer_load_dwordx4 v15, s[20:23], s47 offen lds
    s_add_u32 m0, s46, 28672
    s_mov_b32 s47, 7340416
    buffer_load_dwordx4 v8, s[20:23], s47 offen lds
    s_add_u32 m0, s46, 29696
    s_mov_b32 s47, 7405952
    buffer_load_dwordx4 v15, s[20:23], s47 offen lds
    s_add_u32 m0, s46, 30720
    s_mov_b32 s47, 7471488
    buffer_load_dwordx4 v8, s[20:23], s47 offen lds
    s_add_u32 m0, s46, 31744
    s_mov_b32 s47, 7537024
    buffer_load_dwordx4 v15, s[20:23], s47 offen lds
    s_waitcnt vmcnt(16)
    ds_read_b64_tr_b16 a[0:1], v12 offset:0
    ds_read_b64_tr_b16 a[2:3], v12 offset:512
    ds_read_b64_tr_b16 a[4:5], v13 offset:0
    ds_read_b64_tr_b16 a[6:7], v13 offset:512
    ds_read_b128 v[128:131], v16 offset:8192
    ds_read_b128 v[144:147], v16 offset:12288
    ds_read_b64_tr_b16 a[8:9], v12 offset:2048
    ds_read_b64_tr_b16 a[10:11], v12 offset:2560
    ds_read_b64_tr_b16 a[12:13], v13 offset:2048
    ds_read_b64_tr_b16 a[14:15], v13 offset:2560
    ds_read_b128 v[132:135], v17 offset:8192
    ds_read_b128 v[148:151], v17 offset:12288
    ds_read_b64_tr_b16 a[16:17], v12 offset:4096
    ds_read_b64_tr_b16 a[18:19], v12 offset:4608
    ds_read_b64_tr_b16 a[20:21], v13 offset:4096
    ds_read_b64_tr_b16 a[22:23], v13 offset:4608
    ds_read_b128 v[136:139], v18 offset:8192
    ds_read_b128 v[152:155], v18 offset:12288
    ds_read_b64_tr_b16 a[24:25], v12 offset:6144
    ds_read_b64_tr_b16 a[26:27], v12 offset:6656
    ds_read_b64_tr_b16 a[28:29], v13 offset:6144
    ds_read_b64_tr_b16 a[30:31], v13 offset:6656
    ds_read_b128 v[140:143], v19 offset:8192
    ds_read_b128 v[156:159], v19 offset:12288
    s_waitcnt lgkmcnt(15)
    v_mfma_f32_32x32x16_bf16 v[64:79], a[0:3], v[128:131], v[64:79]
    v_mfma_f32_32x32x16_bf16 v[80:95], a[4:7], v[128:131], v[80:95]
    v_mfma_f32_32x32x16_bf16 v[96:111], a[0:3], v[144:147], v[96:111]
    v_mfma_f32_32x32x16_bf16 v[112:127], a[4:7], v[144:147], v[112:127]
    s_waitcnt lgkmcnt(12)
    v_mfma_f32_32x32x16_bf16 v[64:79], a[8:11], v[132:135], v[64:79]
    v_mfma_f32_32x32x16_bf16 v[80:95], a[12:15], v[132:135], v[80:95]
    v_mfma_f32_32x32x16_bf16 v[96:111], a[8:11], v[148:151], v[96:111]
    v_mfma_f32_32x32x16_bf16 v[112:127], a[12:15], v[148:151], v[112:127]
    s_waitcnt lgkmcnt(6)
    v_mfma_f32_32x32x16_bf16 v[64:79], a[16:19], v[136:139], v[64:79]
    v_mfma_f32_32x32x16_bf16 v[80:95], a[20:23], v[136:139], v[80:95]
    v_mfma_f32_32x32x16_bf16 v[96:111], a[16:19], v[152:155], v[96:111]
    v_mfma_f32_32x32x16_bf16 v[112:127], a[20:23], v[152:155], v[112:127]
    s_waitcnt lgkmcnt(0)
    v_mfma_f32_32x32x16_bf16 v[64:79], a[24:27], v[140:143], v[64:79]
    v_mfma_f32_32x32x16_bf16 v[80:95], a[28:31], v[140:143], v[80:95]
    v_mfma_f32_32x32x16_bf16 v[96:111], a[24:27], v[156:159], v[96:111]
    v_mfma_f32_32x32x16_bf16 v[112:127], a[28:31], v[156:159], v[112:127]
    s_add_u32 m0, s46, 0
    s_add_u32 s47, s45, 229376
    buffer_load_dwordx4 v9, s[24:27], s47 offen lds
    s_add_u32 m0, s46, 1024
    s_add_u32 s47, s45, 236544
    buffer_load_dwordx4 v9, s[24:27], s47 offen lds
    s_add_u32 m0, s46, 2048
    s_add_u32 s47, s45, 243712
    buffer_load_dwordx4 v9, s[24:27], s47 offen lds
    s_add_u32 m0, s46, 3072
    s_add_u32 s47, s45, 250880
    buffer_load_dwordx4 v9, s[24:27], s47 offen lds
    s_add_u32 m0, s46, 4096
    s_add_u32 s47, s45, 258048
    buffer_load_dwordx4 v9, s[24:27], s47 offen lds
    s_add_u32 m0, s46, 5120
    s_add_u32 s47, s45, 265216
    buffer_load_dwordx4 v9, s[24:27], s47 offen lds
    s_add_u32 m0, s46, 6144
    s_add_u32 s47, s45, 272384
    buffer_load_dwordx4 v9, s[24:27], s47 offen lds
    s_add_u32 m0, s46, 7168
    s_add_u32 s47, s45, 279552
    buffer_load_dwordx4 v9, s[24:27], s47 offen lds
    s_add_u32 m0, s46, 8192
    s_mov_b32 s47, 512
    buffer_load_dwordx4 v8, s[20:23], s47 offen lds
    s_add_u32 m0, s46, 9216
    s_mov_b32 s47, 66048
    buffer_load_dwordx4 v15, s[20:23], s47 offen lds
    s_add_u32 m0, s46, 10240
    s_mov_b32 s47, 131584
    buffer_load_dwordx4 v8, s[20:23], s47 offen lds
    s_add_u32 m0, s46, 11264
    s_mov_b32 s47, 197120
    buffer_load_dwordx4 v15, s[20:23], s47 offen lds
    s_add_u32 m0, s46, 12288
    s_mov_b32 s47, 7340544
    buffer_load_dwordx4 v8, s[20:23], s47 offen lds
    s_add_u32 m0, s46, 13312
    s_mov_b32 s47, 7406080
    buffer_load_dwordx4 v15, s[20:23], s47 offen lds
    s_add_u32 m0, s46, 14336
    s_mov_b32 s47, 7471616
    buffer_load_dwordx4 v8, s[20:23], s47 offen lds
    s_add_u32 m0, s46, 15360
    s_mov_b32 s47, 7537152
    buffer_load_dwordx4 v15, s[20:23], s47 offen lds
    s_waitcnt vmcnt(16)
    ds_read_b64_tr_b16 a[0:1], v12 offset:16384
    ds_read_b64_tr_b16 a[2:3], v12 offset:16896
    ds_read_b64_tr_b16 a[4:5], v13 offset:16384
    ds_read_b64_tr_b16 a[6:7], v13 offset:16896
    ds_read_b128 v[128:131], v16 offset:24576
    ds_read_b128 v[144:147], v16 offset:28672
    ds_read_b64_tr_b16 a[8:9], v12 offset:18432
    ds_read_b64_tr_b16 a[10:11], v12 offset:18944
    ds_read_b64_tr_b16 a[12:13], v13 offset:18432
    ds_read_b64_tr_b16 a[14:15], v13 offset:18944
    ds_read_b128 v[132:135], v17 offset:24576
    ds_read_b128 v[148:151], v17 offset:28672
    ds_read_b64_tr_b16 a[16:17], v12 offset:20480
    ds_read_b64_tr_b16 a[18:19], v12 offset:20992
    ds_read_b64_tr_b16 a[20:21], v13 offset:20480
    ds_read_b64_tr_b16 a[22:23], v13 offset:20992
    ds_read_b128 v[136:139], v18 offset:24576
    ds_read_b128 v[152:155], v18 offset:28672
    ds_read_b64_tr_b16 a[24:25], v12 offset:22528
    ds_read_b64_tr_b16 a[26:27], v12 offset:23040
    ds_read_b64_tr_b16 a[28:29], v13 offset:22528
    ds_read_b64_tr_b16 a[30:31], v13 offset:23040
    ds_read_b128 v[140:143], v19 offset:24576
    ds_read_b128 v[156:159], v19 offset:28672
    s_waitcnt lgkmcnt(15)
    v_mfma_f32_32x32x16_bf16 v[64:79], a[0:3], v[128:131], v[64:79]
    v_mfma_f32_32x32x16_bf16 v[80:95], a[4:7], v[128:131], v[80:95]
    v_mfma_f32_32x32x16_bf16 v[96:111], a[0:3], v[144:147], v[96:111]
    v_mfma_f32_32x32x16_bf16 v[112:127], a[4:7], v[144:147], v[112:127]
    s_waitcnt lgkmcnt(12)
    v_mfma_f32_32x32x16_bf16 v[64:79], a[8:11], v[132:135], v[64:79]
    v_mfma_f32_32x32x16_bf16 v[80:95], a[12:15], v[132:135], v[80:95]
    v_mfma_f32_32x32x16_bf16 v[96:111], a[8:11], v[148:151], v[96:111]
    v_mfma_f32_32x32x16_bf16 v[112:127], a[12:15], v[148:151], v[112:127]
    s_waitcnt lgkmcnt(6)
    v_mfma_f32_32x32x16_bf16 v[64:79], a[16:19], v[136:139], v[64:79]
    v_mfma_f32_32x32x16_bf16 v[80:95], a[20:23], v[136:139], v[80:95]
    v_mfma_f32_32x32x16_bf16 v[96:111], a[16:19], v[152:155], v[96:111]
    v_mfma_f32_32x32x16_bf16 v[112:127], a[20:23], v[152:155], v[112:127]
    s_waitcnt lgkmcnt(0)
    v_mfma_f32_32x32x16_bf16 v[64:79], a[24:27], v[140:143], v[64:79]
    v_mfma_f32_32x32x16_bf16 v[80:95], a[28:31], v[140:143], v[80:95]
    v_mfma_f32_32x32x16_bf16 v[96:111], a[24:27], v[156:159], v[96:111]
    v_mfma_f32_32x32x16_bf16 v[112:127], a[28:31], v[156:159], v[112:127]
    s_nop 15
    s_nop 3
    v_fma_f32 v32, v64, v20, v32
    v_fma_f32 v32, v96, v24, v32
    v_fma_f32 v33, v65, v20, v33
    v_fma_f32 v33, v97, v24, v33
    v_fma_f32 v34, v66, v20, v34
    v_fma_f32 v34, v98, v24, v34
    v_fma_f32 v35, v67, v20, v35
    v_fma_f32 v35, v99, v24, v35
    v_fma_f32 v36, v68, v20, v36
    v_fma_f32 v36, v100, v24, v36
    v_fma_f32 v37, v69, v20, v37
    v_fma_f32 v37, v101, v24, v37
    v_fma_f32 v38, v70, v20, v38
    v_fma_f32 v38, v102, v24, v38
    v_fma_f32 v39, v71, v20, v39
    v_fma_f32 v39, v103, v24, v39
    v_fma_f32 v40, v72, v20, v40
    v_fma_f32 v40, v104, v24, v40
    v_fma_f32 v41, v73, v20, v41
    v_fma_f32 v41, v105, v24, v41
    v_fma_f32 v42, v74, v20, v42
    v_fma_f32 v42, v106, v24, v42
    v_fma_f32 v43, v75, v20, v43
    v_fma_f32 v43, v107, v24, v43
    v_fma_f32 v44, v76, v20, v44
    v_fma_f32 v44, v108, v24, v44
    v_fma_f32 v45, v77, v20, v45
    v_fma_f32 v45, v109, v24, v45
    v_fma_f32 v46, v78, v20, v46
    v_fma_f32 v46, v110, v24, v46
    v_fma_f32 v47, v79, v20, v47
    v_fma_f32 v47, v111, v24, v47
    v_fma_f32 v48, v80, v20, v48
    v_fma_f32 v48, v112, v24, v48
    v_fma_f32 v49, v81, v20, v49
    v_fma_f32 v49, v113, v24, v49
    v_fma_f32 v50, v82, v20, v50
    v_fma_f32 v50, v114, v24, v50
    v_fma_f32 v51, v83, v20, v51
    v_fma_f32 v51, v115, v24, v51
    v_fma_f32 v52, v84, v20, v52
    v_fma_f32 v52, v116, v24, v52
    v_fma_f32 v53, v85, v20, v53
    v_fma_f32 v53, v117, v24, v53
    v_fma_f32 v54, v86, v20, v54
    v_fma_f32 v54, v118, v24, v54
    v_fma_f32 v55, v87, v20, v55
    v_fma_f32 v55, v119, v24, v55
    v_fma_f32 v56, v88, v20, v56
    v_fma_f32 v56, v120, v24, v56
    v_fma_f32 v57, v89, v20, v57
    v_fma_f32 v57, v121, v24, v57
    v_fma_f32 v58, v90, v20, v58
    v_fma_f32 v58, v122, v24, v58
    v_fma_f32 v59, v91, v20, v59
    v_fma_f32 v59, v123, v24, v59
    v_fma_f32 v60, v92, v20, v60
    v_fma_f32 v60, v124, v24, v60
    v_fma_f32 v61, v93, v20, v61
    v_fma_f32 v61, v125, v24, v61
    v_fma_f32 v62, v94, v20, v62
    v_fma_f32 v62, v126, v24, v62
    v_fma_f32 v63, v95, v20, v63
    v_fma_f32 v63, v127, v24, v63
    s_add_u32 m0, s46, 16384
    s_add_u32 s47, s45, 286720
    buffer_load_dwordx4 v9, s[24:27], s47 offen lds
    s_add_u32 m0, s46, 17408
    s_add_u32 s47, s45, 293888
    buffer_load_dwordx4 v9, s[24:27], s47 offen lds
    s_add_u32 m0, s46, 18432
    s_add_u32 s47, s45, 301056
    buffer_load_dwordx4 v9, s[24:27], s47 offen lds
    s_add_u32 m0, s46, 19456
    s_add_u32 s47, s45, 308224
    buffer_load_dwordx4 v9, s[24:27], s47 offen lds
    s_add_u32 m0, s46, 20480
    s_add_u32 s47, s45, 315392
    buffer_load_dwordx4 v9, s[24:27], s47 offen lds
    s_add_u32 m0, s46, 21504
    s_add_u32 s47, s45, 322560
    buffer_load_dwordx4 v9, s[24:27], s47 offen lds
    s_add_u32 m0, s46, 22528
    s_add_u32 s47, s45, 329728
    buffer_load_dwordx4 v9, s[24:27], s47 offen lds
    s_add_u32 m0, s46, 23552
    s_add_u32 s47, s45, 336896
    buffer_load_dwordx4 v9, s[24:27], s47 offen lds
    s_add_u32 m0, s46, 24576
    s_mov_b32 s47, 640
    buffer_load_dwordx4 v8, s[20:23], s47 offen lds
    s_add_u32 m0, s46, 25600
    s_mov_b32 s47, 66176
    buffer_load_dwordx4 v15, s[20:23], s47 offen lds
    s_add_u32 m0, s46, 26624
    s_mov_b32 s47, 131712
    buffer_load_dwordx4 v8, s[20:23], s47 offen lds
    s_add_u32 m0, s46, 27648
    s_mov_b32 s47, 197248
    buffer_load_dwordx4 v15, s[20:23], s47 offen lds
    s_add_u32 m0, s46, 28672
    s_mov_b32 s47, 7340672
    buffer_load_dwordx4 v8, s[20:23], s47 offen lds
    s_add_u32 m0, s46, 29696
    s_mov_b32 s47, 7406208
    buffer_load_dwordx4 v15, s[20:23], s47 offen lds
    s_add_u32 m0, s46, 30720
    s_mov_b32 s47, 7471744
    buffer_load_dwordx4 v8, s[20:23], s47 offen lds
    s_add_u32 m0, s46, 31744
    s_mov_b32 s47, 7537280
    buffer_load_dwordx4 v15, s[20:23], s47 offen lds
    s_waitcnt vmcnt(16)
    ds_read_b64_tr_b16 a[0:1], v12 offset:0
    ds_read_b64_tr_b16 a[2:3], v12 offset:512
    ds_read_b64_tr_b16 a[4:5], v13 offset:0
    ds_read_b64_tr_b16 a[6:7], v13 offset:512
    ds_read_b128 v[128:131], v16 offset:8192
    ds_read_b128 v[144:147], v16 offset:12288
    ds_read_b64_tr_b16 a[8:9], v12 offset:2048
    ds_read_b64_tr_b16 a[10:11], v12 offset:2560
    ds_read_b64_tr_b16 a[12:13], v13 offset:2048
    ds_read_b64_tr_b16 a[14:15], v13 offset:2560
    ds_read_b128 v[132:135], v17 offset:8192
    ds_read_b128 v[148:151], v17 offset:12288
    ds_read_b64_tr_b16 a[16:17], v12 offset:4096
    ds_read_b64_tr_b16 a[18:19], v12 offset:4608
    ds_read_b64_tr_b16 a[20:21], v13 offset:4096
    ds_read_b64_tr_b16 a[22:23], v13 offset:4608
    ds_read_b128 v[136:139], v18 offset:8192
    ds_read_b128 v[152:155], v18 offset:12288
    ds_read_b64_tr_b16 a[24:25], v12 offset:6144
    ds_read_b64_tr_b16 a[26:27], v12 offset:6656
    ds_read_b64_tr_b16 a[28:29], v13 offset:6144
    ds_read_b64_tr_b16 a[30:31], v13 offset:6656
    ds_read_b128 v[140:143], v19 offset:8192
    ds_read_b128 v[156:159], v19 offset:12288
    s_waitcnt lgkmcnt(15)
    v_mfma_f32_32x32x16_bf16 v[64:79], a[0:3], v[128:131], 0
    v_mfma_f32_32x32x16_bf16 v[80:95], a[4:7], v[128:131], 0
    v_mfma_f32_32x32x16_bf16 v[96:111], a[0:3], v[144:147], 0
    v_mfma_f32_32x32x16_bf16 v[112:127], a[4:7], v[144:147], 0
    s_waitcnt lgkmcnt(12)
    v_mfma_f32_32x32x16_bf16 v[64:79], a[8:11], v[132:135], v[64:79]
    v_mfma_f32_32x32x16_bf16 v[80:95], a[12:15], v[132:135], v[80:95]
    v_mfma_f32_32x32x16_bf16 v[96:111], a[8:11], v[148:151], v[96:111]
    v_mfma_f32_32x32x16_bf16 v[112:127], a[12:15], v[148:151], v[112:127]
    s_waitcnt lgkmcnt(6)
    v_mfma_f32_32x32x16_bf16 v[64:79], a[16:19], v[136:139], v[64:79]
    v_mfma_f32_32x32x16_bf16 v[80:95], a[20:23], v[136:139], v[80:95]
    v_mfma_f32_32x32x16_bf16 v[96:111], a[16:19], v[152:155], v[96:111]
    v_mfma_f32_32x32x16_bf16 v[112:127], a[20:23], v[152:155], v[112:127]
    s_waitcnt lgkmcnt(0)
    v_mfma_f32_32x32x16_bf16 v[64:79], a[24:27], v[140:143], v[64:79]
    v_mfma_f32_32x32x16_bf16 v[80:95], a[28:31], v[140:143], v[80:95]
    v_mfma_f32_32x32x16_bf16 v[96:111], a[24:27], v[156:159], v[96:111]
    v_mfma_f32_32x32x16_bf16 v[112:127], a[28:31], v[156:159], v[112:127]
    s_add_u32 m0, s46, 0
    s_add_u32 s47, s45, 344064
    buffer_load_dwordx4 v9, s[24:27], s47 offen lds
    s_add_u32 m0, s46, 1024
    s_add_u32 s47, s45, 351232
    buffer_load_dwordx4 v9, s[24:27], s47 offen lds
    s_add_u32 m0, s46, 2048
    s_add_u32 s47, s45, 358400
    buffer_load_dwordx4 v9, s[24:27], s47 offen lds
    s_add_u32 m0, s46, 3072
    s_add_u32 s47, s45, 365568
    buffer_load_dwordx4 v9, s[24:27], s47 offen lds
    s_add_u32 m0, s46, 4096
    s_add_u32 s47, s45, 372736
    buffer_load_dwordx4 v9, s[24:27], s47 offen lds
    s_add_u32 m0, s46, 5120
    s_add_u32 s47, s45, 379904
    buffer_load_dwordx4 v9, s[24:27], s47 offen lds
    s_add_u32 m0, s46, 6144
    s_add_u32 s47, s45, 387072
    buffer_load_dwordx4 v9, s[24:27], s47 offen lds
    s_add_u32 m0, s46, 7168
    s_add_u32 s47, s45, 394240
    buffer_load_dwordx4 v9, s[24:27], s47 offen lds
    s_add_u32 m0, s46, 8192
    s_mov_b32 s47, 768
    buffer_load_dwordx4 v8, s[20:23], s47 offen lds
    s_add_u32 m0, s46, 9216
    s_mov_b32 s47, 66304
    buffer_load_dwordx4 v15, s[20:23], s47 offen lds
    s_add_u32 m0, s46, 10240
    s_mov_b32 s47, 131840
    buffer_load_dwordx4 v8, s[20:23], s47 offen lds
    s_add_u32 m0, s46, 11264
    s_mov_b32 s47, 197376
    buffer_load_dwordx4 v15, s[20:23], s47 offen lds
    s_add_u32 m0, s46, 12288
    s_mov_b32 s47, 7340800
    buffer_load_dwordx4 v8, s[20:23], s47 offen lds
    s_add_u32 m0, s46, 13312
    s_mov_b32 s47, 7406336
    buffer_load_dwordx4 v15, s[20:23], s47 offen lds
    s_add_u32 m0, s46, 14336
    s_mov_b32 s47, 7471872
    buffer_load_dwordx4 v8, s[20:23], s47 offen lds
    s_add_u32 m0, s46, 15360
    s_mov_b32 s47, 7537408
    buffer_load_dwordx4 v15, s[20:23], s47 offen lds
    s_waitcnt vmcnt(16)
    ds_read_b64_tr_b16 a[0:1], v12 offset:16384
    ds_read_b64_tr_b16 a[2:3], v12 offset:16896
    ds_read_b64_tr_b16 a[4:5], v13 offset:16384
    ds_read_b64_tr_b16 a[6:7], v13 offset:16896
    ds_read_b128 v[128:131], v16 offset:24576
    ds_read_b128 v[144:147], v16 offset:28672
    ds_read_b64_tr_b16 a[8:9], v12 offset:18432
    ds_read_b64_tr_b16 a[10:11], v12 offset:18944
    ds_read_b64_tr_b16 a[12:13], v13 offset:18432
    ds_read_b64_tr_b16 a[14:15], v13 offset:18944
    ds_read_b128 v[132:135], v17 offset:24576
    ds_read_b128 v[148:151], v17 offset:28672
    ds_read_b64_tr_b16 a[16:17], v12 offset:20480
    ds_read_b64_tr_b16 a[18:19], v12 offset:20992
    ds_read_b64_tr_b16 a[20:21], v13 offset:20480
    ds_read_b64_tr_b16 a[22:23], v13 offset:20992
    ds_read_b128 v[136:139], v18 offset:24576
    ds_read_b128 v[152:155], v18 offset:28672
    ds_read_b64_tr_b16 a[24:25], v12 offset:22528
    ds_read_b64_tr_b16 a[26:27], v12 offset:23040
    ds_read_b64_tr_b16 a[28:29], v13 offset:22528
    ds_read_b64_tr_b16 a[30:31], v13 offset:23040
    ds_read_b128 v[140:143], v19 offset:24576
    ds_read_b128 v[156:159], v19 offset:28672
    s_waitcnt lgkmcnt(15)
    v_mfma_f32_32x32x16_bf16 v[64:79], a[0:3], v[128:131], v[64:79]
    v_mfma_f32_32x32x16_bf16 v[80:95], a[4:7], v[128:131], v[80:95]
    v_mfma_f32_32x32x16_bf16 v[96:111], a[0:3], v[144:147], v[96:111]
    v_mfma_f32_32x32x16_bf16 v[112:127], a[4:7], v[144:147], v[112:127]
    s_waitcnt lgkmcnt(12)
    v_mfma_f32_32x32x16_bf16 v[64:79], a[8:11], v[132:135], v[64:79]
    v_mfma_f32_32x32x16_bf16 v[80:95], a[12:15], v[132:135], v[80:95]
    v_mfma_f32_32x32x16_bf16 v[96:111], a[8:11], v[148:151], v[96:111]
    v_mfma_f32_32x32x16_bf16 v[112:127], a[12:15], v[148:151], v[112:127]
    s_waitcnt lgkmcnt(6)
    v_mfma_f32_32x32x16_bf16 v[64:79], a[16:19], v[136:139], v[64:79]
    v_mfma_f32_32x32x16_bf16 v[80:95], a[20:23], v[136:139], v[80:95]
    v_mfma_f32_32x32x16_bf16 v[96:111], a[16:19], v[152:155], v[96:111]
    v_mfma_f32_32x32x16_bf16 v[112:127], a[20:23], v[152:155], v[112:127]
    s_waitcnt lgkmcnt(0)
    v_mfma_f32_32x32x16_bf16 v[64:79], a[24:27], v[140:143], v[64:79]
    v_mfma_f32_32x32x16_bf16 v[80:95], a[28:31], v[140:143], v[80:95]
    v_mfma_f32_32x32x16_bf16 v[96:111], a[24:27], v[156:159], v[96:111]
    v_mfma_f32_32x32x16_bf16 v[112:127], a[28:31], v[156:159], v[112:127]
    s_add_u32 m0, s46, 16384
    s_add_u32 s47, s45, 401408
    buffer_load_dwordx4 v9, s[24:27], s47 offen lds
    s_add_u32 m0, s46, 17408
    s_add_u32 s47, s45, 408576
    buffer_load_dwordx4 v9, s[24:27], s47 offen lds
    s_add_u32 m0, s46, 18432
    s_add_u32 s47, s45, 415744
    buffer_load_dwordx4 v9, s[24:27], s47 offen lds
    s_add_u32 m0, s46, 19456
    s_add_u32 s47, s45, 422912
    buffer_load_dwordx4 v9, s[24:27], s47 offen lds
    s_add_u32 m0, s46, 20480
    s_add_u32 s47, s45, 430080
    buffer_load_dwordx4 v9, s[24:27], s47 offen lds
    s_add_u32 m0, s46, 21504
    s_add_u32 s47, s45, 437248
    buffer_load_dwordx4 v9, s[24:27], s47 offen lds
    s_add_u32 m0, s46, 22528
    s_add_u32 s47, s45, 444416
    buffer_load_dwordx4 v9, s[24:27], s47 offen lds
    s_add_u32 m0, s46, 23552
    s_add_u32 s47, s45, 451584
    buffer_load_dwordx4 v9, s[24:27], s47 offen lds
    s_add_u32 m0, s46, 24576
    s_mov_b32 s47, 896
    buffer_load_dwordx4 v8, s[20:23], s47 offen lds
    s_add_u32 m0, s46, 25600
    s_mov_b32 s47, 66432
    buffer_load_dwordx4 v15, s[20:23], s47 offen lds
    s_add_u32 m0, s46, 26624
    s_mov_b32 s47, 131968
    buffer_load_dwordx4 v8, s[20:23], s47 offen lds
    s_add_u32 m0, s46, 27648
    s_mov_b32 s47, 197504
    buffer_load_dwordx4 v15, s[20:23], s47 offen lds
    s_add_u32 m0, s46, 28672
    s_mov_b32 s47, 7340928
    buffer_load_dwordx4 v8, s[20:23], s47 offen lds
    s_add_u32 m0, s46, 29696
    s_mov_b32 s47, 7406464
    buffer_load_dwordx4 v15, s[20:23], s47 offen lds
    s_add_u32 m0, s46, 30720
    s_mov_b32 s47, 7472000
    buffer_load_dwordx4 v8, s[20:23], s47 offen lds
    s_add_u32 m0, s46, 31744
    s_mov_b32 s47, 7537536
    buffer_load_dwordx4 v15, s[20:23], s47 offen lds
    s_waitcnt vmcnt(16)
    ds_read_b64_tr_b16 a[0:1], v12 offset:0
    ds_read_b64_tr_b16 a[2:3], v12 offset:512
    ds_read_b64_tr_b16 a[4:5], v13 offset:0
    ds_read_b64_tr_b16 a[6:7], v13 offset:512
    ds_read_b128 v[128:131], v16 offset:8192
    ds_read_b128 v[144:147], v16 offset:12288
    ds_read_b64_tr_b16 a[8:9], v12 offset:2048
    ds_read_b64_tr_b16 a[10:11], v12 offset:2560
    ds_read_b64_tr_b16 a[12:13], v13 offset:2048
    ds_read_b64_tr_b16 a[14:15], v13 offset:2560
    ds_read_b128 v[132:135], v17 offset:8192
    ds_read_b128 v[148:151], v17 offset:12288
    ds_read_b64_tr_b16 a[16:17], v12 offset:4096
    ds_read_b64_tr_b16 a[18:19], v12 offset:4608
    ds_read_b64_tr_b16 a[20:21], v13 offset:4096
    ds_read_b64_tr_b16 a[22:23], v13 offset:4608
    ds_read_b128 v[136:139], v18 offset:8192
    ds_read_b128 v[152:155], v18 offset:12288
    ds_read_b64_tr_b16 a[24:25], v12 offset:6144
    ds_read_b64_tr_b16 a[26:27], v12 offset:6656
    ds_read_b64_tr_b16 a[28:29], v13 offset:6144
    ds_read_b64_tr_b16 a[30:31], v13 offset:6656
    ds_read_b128 v[140:143], v19 offset:8192
    ds_read_b128 v[156:159], v19 offset:12288
    s_waitcnt lgkmcnt(15)
    v_mfma_f32_32x32x16_bf16 v[64:79], a[0:3], v[128:131], v[64:79]
    v_mfma_f32_32x32x16_bf16 v[80:95], a[4:7], v[128:131], v[80:95]
    v_mfma_f32_32x32x16_bf16 v[96:111], a[0:3], v[144:147], v[96:111]
    v_mfma_f32_32x32x16_bf16 v[112:127], a[4:7], v[144:147], v[112:127]
    s_waitcnt lgkmcnt(12)
    v_mfma_f32_32x32x16_bf16 v[64:79], a[8:11], v[132:135], v[64:79]
    v_mfma_f32_32x32x16_bf16 v[80:95], a[12:15], v[132:135], v[80:95]
    v_mfma_f32_32x32x16_bf16 v[96:111], a[8:11], v[148:151], v[96:111]
    v_mfma_f32_32x32x16_bf16 v[112:127], a[12:15], v[148:151], v[112:127]
    s_waitcnt lgkmcnt(6)
    v_mfma_f32_32x32x16_bf16 v[64:79], a[16:19], v[136:139], v[64:79]
    v_mfma_f32_32x32x16_bf16 v[80:95], a[20:23], v[136:139], v[80:95]
    v_mfma_f32_32x32x16_bf16 v[96:111], a[16:19], v[152:155], v[96:111]
    v_mfma_f32_32x32x16_bf16 v[112:127], a[20:23], v[152:155], v[112:127]
    s_waitcnt lgkmcnt(0)
    v_mfma_f32_32x32x16_bf16 v[64:79], a[24:27], v[140:143], v[64:79]
    v_mfma_f32_32x32x16_bf16 v[80:95], a[28:31], v[140:143], v[80:95]
    v_mfma_f32_32x32x16_bf16 v[96:111], a[24:27], v[156:159], v[96:111]
    v_mfma_f32_32x32x16_bf16 v[112:127], a[28:31], v[156:159], v[112:127]
    s_add_u32 m0, s46, 0
    s_add_u32 s47, s45, 458752
    buffer_load_dwordx4 v9, s[24:27], s47 offen lds
    s_add_u32 m0, s46, 1024
    s_add_u32 s47, s45, 465920
    buffer_load_dwordx4 v9, s[24:27], s47 offen lds
    s_add_u32 m0, s46, 2048
    s_add_u32 s47, s45, 473088
    buffer_load_dwordx4 v9, s[24:27], s47 offen lds
    s_add_u32 m0, s46, 3072
    s_add_u32 s47, s45, 480256
    buffer_load_dwordx4 v9, s[24:27], s47 offen lds
    s_add_u32 m0, s46, 4096
    s_add_u32 s47, s45, 487424
    buffer_load_dwordx4 v9, s[24:27], s47 offen lds
    s_add_u32 m0, s46, 5120
    s_add_u32 s47, s45, 494592
    buffer_load_dwordx4 v9, s[24:27], s47 offen lds
    s_add_u32 m0, s46, 6144
    s_add_u32 s47, s45, 501760
    buffer_load_dwordx4 v9, s[24:27], s47 offen lds
    s_add_u32 m0, s46, 7168
    s_add_u32 s47, s45, 508928
    buffer_load_dwordx4 v9, s[24:27], s47 offen lds
    s_add_u32 m0, s46, 8192
    s_mov_b32 s47, 1024
    buffer_load_dwordx4 v8, s[20:23], s47 offen lds
    s_add_u32 m0, s46, 9216
    s_mov_b32 s47, 66560
    buffer_load_dwordx4 v15, s[20:23], s47 offen lds
    s_add_u32 m0, s46, 10240
    s_mov_b32 s47, 132096
    buffer_load_dwordx4 v8, s[20:23], s47 offen lds
    s_add_u32 m0, s46, 11264
    s_mov_b32 s47, 197632
    buffer_load_dwordx4 v15, s[20:23], s47 offen lds
    s_add_u32 m0, s46, 12288
    s_mov_b32 s47, 7341056
    buffer_load_dwordx4 v8, s[20:23], s47 offen lds
    s_add_u32 m0, s46, 13312
    s_mov_b32 s47, 7406592
    buffer_load_dwordx4 v15, s[20:23], s47 offen lds
    s_add_u32 m0, s46, 14336
    s_mov_b32 s47, 7472128
    buffer_load_dwordx4 v8, s[20:23], s47 offen lds
    s_add_u32 m0, s46, 15360
    s_mov_b32 s47, 7537664
    buffer_load_dwordx4 v15, s[20:23], s47 offen lds
    s_waitcnt vmcnt(16)
    ds_read_b64_tr_b16 a[0:1], v12 offset:16384
    ds_read_b64_tr_b16 a[2:3], v12 offset:16896
    ds_read_b64_tr_b16 a[4:5], v13 offset:16384
    ds_read_b64_tr_b16 a[6:7], v13 offset:16896
    ds_read_b128 v[128:131], v16 offset:24576
    ds_read_b128 v[144:147], v16 offset:28672
    ds_read_b64_tr_b16 a[8:9], v12 offset:18432
    ds_read_b64_tr_b16 a[10:11], v12 offset:18944
    ds_read_b64_tr_b16 a[12:13], v13 offset:18432
    ds_read_b64_tr_b16 a[14:15], v13 offset:18944
    ds_read_b128 v[132:135], v17 offset:24576
    ds_read_b128 v[148:151], v17 offset:28672
    ds_read_b64_tr_b16 a[16:17], v12 offset:20480
    ds_read_b64_tr_b16 a[18:19], v12 offset:20992
    ds_read_b64_tr_b16 a[20:21], v13 offset:20480
    ds_read_b64_tr_b16 a[22:23], v13 offset:20992
    ds_read_b128 v[136:139], v18 offset:24576
    ds_read_b128 v[152:155], v18 offset:28672
    ds_read_b64_tr_b16 a[24:25], v12 offset:22528
    ds_read_b64_tr_b16 a[26:27], v12 offset:23040
    ds_read_b64_tr_b16 a[28:29], v13 offset:22528
    ds_read_b64_tr_b16 a[30:31], v13 offset:23040
    ds_read_b128 v[140:143], v19 offset:24576
    ds_read_b128 v[156:159], v19 offset:28672
    s_waitcnt lgkmcnt(15)
    v_mfma_f32_32x32x16_bf16 v[64:79], a[0:3], v[128:131], v[64:79]
    v_mfma_f32_32x32x16_bf16 v[80:95], a[4:7], v[128:131], v[80:95]
    v_mfma_f32_32x32x16_bf16 v[96:111], a[0:3], v[144:147], v[96:111]
    v_mfma_f32_32x32x16_bf16 v[112:127], a[4:7], v[144:147], v[112:127]
    s_waitcnt lgkmcnt(12)
    v_mfma_f32_32x32x16_bf16 v[64:79], a[8:11], v[132:135], v[64:79]
    v_mfma_f32_32x32x16_bf16 v[80:95], a[12:15], v[132:135], v[80:95]
    v_mfma_f32_32x32x16_bf16 v[96:111], a[8:11], v[148:151], v[96:111]
    v_mfma_f32_32x32x16_bf16 v[112:127], a[12:15], v[148:151], v[112:127]
    s_waitcnt lgkmcnt(6)
    v_mfma_f32_32x32x16_bf16 v[64:79], a[16:19], v[136:139], v[64:79]
    v_mfma_f32_32x32x16_bf16 v[80:95], a[20:23], v[136:139], v[80:95]
    v_mfma_f32_32x32x16_bf16 v[96:111], a[16:19], v[152:155], v[96:111]
    v_mfma_f32_32x32x16_bf16 v[112:127], a[20:23], v[152:155], v[112:127]
    s_waitcnt lgkmcnt(0)
    v_mfma_f32_32x32x16_bf16 v[64:79], a[24:27], v[140:143], v[64:79]
    v_mfma_f32_32x32x16_bf16 v[80:95], a[28:31], v[140:143], v[80:95]
    v_mfma_f32_32x32x16_bf16 v[96:111], a[24:27], v[156:159], v[96:111]
    v_mfma_f32_32x32x16_bf16 v[112:127], a[28:31], v[156:159], v[112:127]
    s_nop 15
    s_nop 3
    v_fma_f32 v32, v64, v21, v32
    v_fma_f32 v32, v96, v25, v32
    v_fma_f32 v33, v65, v21, v33
    v_fma_f32 v33, v97, v25, v33
    v_fma_f32 v34, v66, v21, v34
    v_fma_f32 v34, v98, v25, v34
    v_fma_f32 v35, v67, v21, v35
    v_fma_f32 v35, v99, v25, v35
    v_fma_f32 v36, v68, v21, v36
    v_fma_f32 v36, v100, v25, v36
    v_fma_f32 v37, v69, v21, v37
    v_fma_f32 v37, v101, v25, v37
    v_fma_f32 v38, v70, v21, v38
    v_fma_f32 v38, v102, v25, v38
    v_fma_f32 v39, v71, v21, v39
    v_fma_f32 v39, v103, v25, v39
    v_fma_f32 v40, v72, v21, v40
    v_fma_f32 v40, v104, v25, v40
    v_fma_f32 v41, v73, v21, v41
    v_fma_f32 v41, v105, v25, v41
    v_fma_f32 v42, v74, v21, v42
    v_fma_f32 v42, v106, v25, v42
    v_fma_f32 v43, v75, v21, v43
    v_fma_f32 v43, v107, v25, v43
    v_fma_f32 v44, v76, v21, v44
    v_fma_f32 v44, v108, v25, v44
    v_fma_f32 v45, v77, v21, v45
    v_fma_f32 v45, v109, v25, v45
    v_fma_f32 v46, v78, v21, v46
    v_fma_f32 v46, v110, v25, v46
    v_fma_f32 v47, v79, v21, v47
    v_fma_f32 v47, v111, v25, v47
    v_fma_f32 v48, v80, v21, v48
    v_fma_f32 v48, v112, v25, v48
    v_fma_f32 v49, v81, v21, v49
    v_fma_f32 v49, v113, v25, v49
    v_fma_f32 v50, v82, v21, v50
    v_fma_f32 v50, v114, v25, v50
    v_fma_f32 v51, v83, v21, v51
    v_fma_f32 v51, v115, v25, v51
    v_fma_f32 v52, v84, v21, v52
    v_fma_f32 v52, v116, v25, v52
    v_fma_f32 v53, v85, v21, v53
    v_fma_f32 v53, v117, v25, v53
    v_fma_f32 v54, v86, v21, v54
    v_fma_f32 v54, v118, v25, v54
    v_fma_f32 v55, v87, v21, v55
    v_fma_f32 v55, v119, v25, v55
    v_fma_f32 v56, v88, v21, v56
    v_fma_f32 v56, v120, v25, v56
    v_fma_f32 v57, v89, v21, v57
    v_fma_f32 v57, v121, v25, v57
    v_fma_f32 v58, v90, v21, v58
    v_fma_f32 v58, v122, v25, v58
    v_fma_f32 v59, v91, v21, v59
    v_fma_f32 v59, v123, v25, v59
    v_fma_f32 v60, v92, v21, v60
    v_fma_f32 v60, v124, v25, v60
    v_fma_f32 v61, v93, v21, v61
    v_fma_f32 v61, v125, v25, v61
    v_fma_f32 v62, v94, v21, v62
    v_fma_f32 v62, v126, v25, v62
    v_fma_f32 v63, v95, v21, v63
    v_fma_f32 v63, v127, v25, v63
    s_add_u32 m0, s46, 16384
    s_add_u32 s47, s45, 516096
    buffer_load_dwordx4 v9, s[24:27], s47 offen lds
    s_add_u32 m0, s46, 17408
    s_add_u32 s47, s45, 523264
    buffer_load_dwordx4 v9, s[24:27], s47 offen lds
    s_add_u32 m0, s46, 18432
    s_add_u32 s47, s45, 530432
    buffer_load_dwordx4 v9, s[24:27], s47 offen lds
    s_add_u32 m0, s46, 19456
    s_add_u32 s47, s45, 537600
    buffer_load_dwordx4 v9, s[24:27], s47 offen lds
    s_add_u32 m0, s46, 20480
    s_add_u32 s47, s45, 544768
    buffer_load_dwordx4 v9, s[24:27], s47 offen lds
    s_add_u32 m0, s46, 21504
    s_add_u32 s47, s45, 551936
    buffer_load_dwordx4 v9, s[24:27], s47 offen lds
    s_add_u32 m0, s46, 22528
    s_add_u32 s47, s45, 559104
    buffer_load_dwordx4 v9, s[24:27], s47 offen lds
    s_add_u32 m0, s46, 23552
    s_add_u32 s47, s45, 566272
    buffer_load_dwordx4 v9, s[24:27], s47 offen lds
    s_add_u32 m0, s46, 24576
    s_mov_b32 s47, 1152
    buffer_load_dwordx4 v8, s[20:23], s47 offen lds
    s_add_u32 m0, s46, 25600
    s_mov_b32 s47, 66688
    buffer_load_dwordx4 v15, s[20:23], s47 offen lds
    s_add_u32 m0, s46, 26624
    s_mov_b32 s47, 132224
    buffer_load_dwordx4 v8, s[20:23], s47 offen lds
    s_add_u32 m0, s46, 27648
    s_mov_b32 s47, 197760
    buffer_load_dwordx4 v15, s[20:23], s47 offen lds
    s_add_u32 m0, s46, 28672
    s_mov_b32 s47, 7341184
    buffer_load_dwordx4 v8, s[20:23], s47 offen lds
    s_add_u32 m0, s46, 29696
    s_mov_b32 s47, 7406720
    buffer_load_dwordx4 v15, s[20:23], s47 offen lds
    s_add_u32 m0, s46, 30720
    s_mov_b32 s47, 7472256
    buffer_load_dwordx4 v8, s[20:23], s47 offen lds
    s_add_u32 m0, s46, 31744
    s_mov_b32 s47, 7537792
    buffer_load_dwordx4 v15, s[20:23], s47 offen lds
    s_waitcnt vmcnt(16)
    ds_read_b64_tr_b16 a[0:1], v12 offset:0
    ds_read_b64_tr_b16 a[2:3], v12 offset:512
    ds_read_b64_tr_b16 a[4:5], v13 offset:0
    ds_read_b64_tr_b16 a[6:7], v13 offset:512
    ds_read_b128 v[128:131], v16 offset:8192
    ds_read_b128 v[144:147], v16 offset:12288
    ds_read_b64_tr_b16 a[8:9], v12 offset:2048
    ds_read_b64_tr_b16 a[10:11], v12 offset:2560
    ds_read_b64_tr_b16 a[12:13], v13 offset:2048
    ds_read_b64_tr_b16 a[14:15], v13 offset:2560
    ds_read_b128 v[132:135], v17 offset:8192
    ds_read_b128 v[148:151], v17 offset:12288
    ds_read_b64_tr_b16 a[16:17], v12 offset:4096
    ds_read_b64_tr_b16 a[18:19], v12 offset:4608
    ds_read_b64_tr_b16 a[20:21], v13 offset:4096
    ds_read_b64_tr_b16 a[22:23], v13 offset:4608
    ds_read_b128 v[136:139], v18 offset:8192
    ds_read_b128 v[152:155], v18 offset:12288
    ds_read_b64_tr_b16 a[24:25], v12 offset:6144
    ds_read_b64_tr_b16 a[26:27], v12 offset:6656
    ds_read_b64_tr_b16 a[28:29], v13 offset:6144
    ds_read_b64_tr_b16 a[30:31], v13 offset:6656
    ds_read_b128 v[140:143], v19 offset:8192
    ds_read_b128 v[156:159], v19 offset:12288
    s_waitcnt lgkmcnt(15)
    v_mfma_f32_32x32x16_bf16 v[64:79], a[0:3], v[128:131], 0
    v_mfma_f32_32x32x16_bf16 v[80:95], a[4:7], v[128:131], 0
    v_mfma_f32_32x32x16_bf16 v[96:111], a[0:3], v[144:147], 0
    v_mfma_f32_32x32x16_bf16 v[112:127], a[4:7], v[144:147], 0
    s_waitcnt lgkmcnt(12)
    v_mfma_f32_32x32x16_bf16 v[64:79], a[8:11], v[132:135], v[64:79]
    v_mfma_f32_32x32x16_bf16 v[80:95], a[12:15], v[132:135], v[80:95]
    v_mfma_f32_32x32x16_bf16 v[96:111], a[8:11], v[148:151], v[96:111]
    v_mfma_f32_32x32x16_bf16 v[112:127], a[12:15], v[148:151], v[112:127]
    s_waitcnt lgkmcnt(6)
    v_mfma_f32_32x32x16_bf16 v[64:79], a[16:19], v[136:139], v[64:79]
    v_mfma_f32_32x32x16_bf16 v[80:95], a[20:23], v[136:139], v[80:95]
    v_mfma_f32_32x32x16_bf16 v[96:111], a[16:19], v[152:155], v[96:111]
    v_mfma_f32_32x32x16_bf16 v[112:127], a[20:23], v[152:155], v[112:127]
    s_waitcnt lgkmcnt(0)
    v_mfma_f32_32x32x16_bf16 v[64:79], a[24:27], v[140:143], v[64:79]
    v_mfma_f32_32x32x16_bf16 v[80:95], a[28:31], v[140:143], v[80:95]
    v_mfma_f32_32x32x16_bf16 v[96:111], a[24:27], v[156:159], v[96:111]
    v_mfma_f32_32x32x16_bf16 v[112:127], a[28:31], v[156:159], v[112:127]
    s_add_u32 m0, s46, 0
    s_add_u32 s47, s45, 573440
    buffer_load_dwordx4 v9, s[24:27], s47 offen lds
    s_add_u32 m0, s46, 1024
    s_add_u32 s47, s45, 580608
    buffer_load_dwordx4 v9, s[24:27], s47 offen lds
    s_add_u32 m0, s46, 2048
    s_add_u32 s47, s45, 587776
    buffer_load_dwordx4 v9, s[24:27], s47 offen lds
    s_add_u32 m0, s46, 3072
    s_add_u32 s47, s45, 594944
    buffer_load_dwordx4 v9, s[24:27], s47 offen lds
    s_add_u32 m0, s46, 4096
    s_add_u32 s47, s45, 602112
    buffer_load_dwordx4 v9, s[24:27], s47 offen lds
    s_add_u32 m0, s46, 5120
    s_add_u32 s47, s45, 609280
    buffer_load_dwordx4 v9, s[24:27], s47 offen lds
    s_add_u32 m0, s46, 6144
    s_add_u32 s47, s45, 616448
    buffer_load_dwordx4 v9, s[24:27], s47 offen lds
    s_add_u32 m0, s46, 7168
    s_add_u32 s47, s45, 623616
    buffer_load_dwordx4 v9, s[24:27], s47 offen lds
    s_add_u32 m0, s46, 8192
    s_mov_b32 s47, 1280
    buffer_load_dwordx4 v8, s[20:23], s47 offen lds
    s_add_u32 m0, s46, 9216
    s_mov_b32 s47, 66816
    buffer_load_dwordx4 v15, s[20:23], s47 offen lds
    s_add_u32 m0, s46, 10240
    s_mov_b32 s47, 132352
    buffer_load_dwordx4 v8, s[20:23], s47 offen lds
    s_add_u32 m0, s46, 11264
    s_mov_b32 s47, 197888
    buffer_load_dwordx4 v15, s[20:23], s47 offen lds
    s_add_u32 m0, s46, 12288
    s_mov_b32 s47, 7341312
    buffer_load_dwordx4 v8, s[20:23], s47 offen lds
    s_add_u32 m0, s46, 13312
    s_mov_b32 s47, 7406848
    buffer_load_dwordx4 v15, s[20:23], s47 offen lds
    s_add_u32 m0, s46, 14336
    s_mov_b32 s47, 7472384
    buffer_load_dwordx4 v8, s[20:23], s47 offen lds
    s_add_u32 m0, s46, 15360
    s_mov_b32 s47, 7537920
    buffer_load_dwordx4 v15, s[20:23], s47 offen lds
    s_waitcnt vmcnt(16)
    ds_read_b64_tr_b16 a[0:1], v12 offset:16384
    ds_read_b64_tr_b16 a[2:3], v12 offset:16896
    ds_read_b64_tr_b16 a[4:5], v13 offset:16384
    ds_read_b64_tr_b16 a[6:7], v13 offset:16896
    ds_read_b128 v[128:131], v16 offset:24576
    ds_read_b128 v[144:147], v16 offset:28672
    ds_read_b64_tr_b16 a[8:9], v12 offset:18432
    ds_read_b64_tr_b16 a[10:11], v12 offset:18944
    ds_read_b64_tr_b16 a[12:13], v13 offset:18432
    ds_read_b64_tr_b16 a[14:15], v13 offset:18944
    ds_read_b128 v[132:135], v17 offset:24576
    ds_read_b128 v[148:151], v17 offset:28672
    ds_read_b64_tr_b16 a[16:17], v12 offset:20480
    ds_read_b64_tr_b16 a[18:19], v12 offset:20992
    ds_read_b64_tr_b16 a[20:21], v13 offset:20480
    ds_read_b64_tr_b16 a[22:23], v13 offset:20992
    ds_read_b128 v[136:139], v18 offset:24576
    ds_read_b128 v[152:155], v18 offset:28672
    ds_read_b64_tr_b16 a[24:25], v12 offset:22528
    ds_read_b64_tr_b16 a[26:27], v12 offset:23040
    ds_read_b64_tr_b16 a[28:29], v13 offset:22528
    ds_read_b64_tr_b16 a[30:31], v13 offset:23040
    ds_read_b128 v[140:143], v19 offset:24576
    ds_read_b128 v[156:159], v19 offset:28672
    s_waitcnt lgkmcnt(15)
    v_mfma_f32_32x32x16_bf16 v[64:79], a[0:3], v[128:131], v[64:79]
    v_mfma_f32_32x32x16_bf16 v[80:95], a[4:7], v[128:131], v[80:95]
    v_mfma_f32_32x32x16_bf16 v[96:111], a[0:3], v[144:147], v[96:111]
    v_mfma_f32_32x32x16_bf16 v[112:127], a[4:7], v[144:147], v[112:127]
    s_waitcnt lgkmcnt(12)
    v_mfma_f32_32x32x16_bf16 v[64:79], a[8:11], v[132:135], v[64:79]
    v_mfma_f32_32x32x16_bf16 v[80:95], a[12:15], v[132:135], v[80:95]
    v_mfma_f32_32x32x16_bf16 v[96:111], a[8:11], v[148:151], v[96:111]
    v_mfma_f32_32x32x16_bf16 v[112:127], a[12:15], v[148:151], v[112:127]
    s_waitcnt lgkmcnt(6)
    v_mfma_f32_32x32x16_bf16 v[64:79], a[16:19], v[136:139], v[64:79]
    v_mfma_f32_32x32x16_bf16 v[80:95], a[20:23], v[136:139], v[80:95]
    v_mfma_f32_32x32x16_bf16 v[96:111], a[16:19], v[152:155], v[96:111]
    v_mfma_f32_32x32x16_bf16 v[112:127], a[20:23], v[152:155], v[112:127]
    s_waitcnt lgkmcnt(0)
    v_mfma_f32_32x32x16_bf16 v[64:79], a[24:27], v[140:143], v[64:79]
    v_mfma_f32_32x32x16_bf16 v[80:95], a[28:31], v[140:143], v[80:95]
    v_mfma_f32_32x32x16_bf16 v[96:111], a[24:27], v[156:159], v[96:111]
    v_mfma_f32_32x32x16_bf16 v[112:127], a[28:31], v[156:159], v[112:127]
    s_add_u32 m0, s46, 16384
    s_add_u32 s47, s45, 630784
    buffer_load_dwordx4 v9, s[24:27], s47 offen lds
    s_add_u32 m0, s46, 17408
    s_add_u32 s47, s45, 637952
    buffer_load_dwordx4 v9, s[24:27], s47 offen lds
    s_add_u32 m0, s46, 18432
    s_add_u32 s47, s45, 645120
    buffer_load_dwordx4 v9, s[24:27], s47 offen lds
    s_add_u32 m0, s46, 19456
    s_add_u32 s47, s45, 652288
    buffer_load_dwordx4 v9, s[24:27], s47 offen lds
    s_add_u32 m0, s46, 20480
    s_add_u32 s47, s45, 659456
    buffer_load_dwordx4 v9, s[24:27], s47 offen lds
    s_add_u32 m0, s46, 21504
    s_add_u32 s47, s45, 666624
    buffer_load_dwordx4 v9, s[24:27], s47 offen lds
    s_add_u32 m0, s46, 22528
    s_add_u32 s47, s45, 673792
    buffer_load_dwordx4 v9, s[24:27], s47 offen lds
    s_add_u32 m0, s46, 23552
    s_add_u32 s47, s45, 680960
    buffer_load_dwordx4 v9, s[24:27], s47 offen lds
    s_add_u32 m0, s46, 24576
    s_mov_b32 s47, 1408
    buffer_load_dwordx4 v8, s[20:23], s47 offen lds
    s_add_u32 m0, s46, 25600
    s_mov_b32 s47, 66944
    buffer_load_dwordx4 v15, s[20:23], s47 offen lds
    s_add_u32 m0, s46, 26624
    s_mov_b32 s47, 132480
    buffer_load_dwordx4 v8, s[20:23], s47 offen lds
    s_add_u32 m0, s46, 27648
    s_mov_b32 s47, 198016
    buffer_load_dwordx4 v15, s[20:23], s47 offen lds
    s_add_u32 m0, s46, 28672
    s_mov_b32 s47, 7341440
    buffer_load_dwordx4 v8, s[20:23], s47 offen lds
    s_add_u32 m0, s46, 29696
    s_mov_b32 s47, 7406976
    buffer_load_dwordx4 v15, s[20:23], s47 offen lds
    s_add_u32 m0, s46, 30720
    s_mov_b32 s47, 7472512
    buffer_load_dwordx4 v8, s[20:23], s47 offen lds
    s_add_u32 m0, s46, 31744
    s_mov_b32 s47, 7538048
    buffer_load_dwordx4 v15, s[20:23], s47 offen lds
    s_waitcnt vmcnt(16)
    ds_read_b64_tr_b16 a[0:1], v12 offset:0
    ds_read_b64_tr_b16 a[2:3], v12 offset:512
    ds_read_b64_tr_b16 a[4:5], v13 offset:0
    ds_read_b64_tr_b16 a[6:7], v13 offset:512
    ds_read_b128 v[128:131], v16 offset:8192
    ds_read_b128 v[144:147], v16 offset:12288
    ds_read_b64_tr_b16 a[8:9], v12 offset:2048
    ds_read_b64_tr_b16 a[10:11], v12 offset:2560
    ds_read_b64_tr_b16 a[12:13], v13 offset:2048
    ds_read_b64_tr_b16 a[14:15], v13 offset:2560
    ds_read_b128 v[132:135], v17 offset:8192
    ds_read_b128 v[148:151], v17 offset:12288
    ds_read_b64_tr_b16 a[16:17], v12 offset:4096
    ds_read_b64_tr_b16 a[18:19], v12 offset:4608
    ds_read_b64_tr_b16 a[20:21], v13 offset:4096
    ds_read_b64_tr_b16 a[22:23], v13 offset:4608
    ds_read_b128 v[136:139], v18 offset:8192
    ds_read_b128 v[152:155], v18 offset:12288
    ds_read_b64_tr_b16 a[24:25], v12 offset:6144
    ds_read_b64_tr_b16 a[26:27], v12 offset:6656
    ds_read_b64_tr_b16 a[28:29], v13 offset:6144
    ds_read_b64_tr_b16 a[30:31], v13 offset:6656
    ds_read_b128 v[140:143], v19 offset:8192
    ds_read_b128 v[156:159], v19 offset:12288
    s_waitcnt lgkmcnt(15)
    v_mfma_f32_32x32x16_bf16 v[64:79], a[0:3], v[128:131], v[64:79]
    v_mfma_f32_32x32x16_bf16 v[80:95], a[4:7], v[128:131], v[80:95]
    v_mfma_f32_32x32x16_bf16 v[96:111], a[0:3], v[144:147], v[96:111]
    v_mfma_f32_32x32x16_bf16 v[112:127], a[4:7], v[144:147], v[112:127]
    s_waitcnt lgkmcnt(12)
    v_mfma_f32_32x32x16_bf16 v[64:79], a[8:11], v[132:135], v[64:79]
    v_mfma_f32_32x32x16_bf16 v[80:95], a[12:15], v[132:135], v[80:95]
    v_mfma_f32_32x32x16_bf16 v[96:111], a[8:11], v[148:151], v[96:111]
    v_mfma_f32_32x32x16_bf16 v[112:127], a[12:15], v[148:151], v[112:127]
    s_waitcnt lgkmcnt(6)
    v_mfma_f32_32x32x16_bf16 v[64:79], a[16:19], v[136:139], v[64:79]
    v_mfma_f32_32x32x16_bf16 v[80:95], a[20:23], v[136:139], v[80:95]
    v_mfma_f32_32x32x16_bf16 v[96:111], a[16:19], v[152:155], v[96:111]
    v_mfma_f32_32x32x16_bf16 v[112:127], a[20:23], v[152:155], v[112:127]
    s_waitcnt lgkmcnt(0)
    v_mfma_f32_32x32x16_bf16 v[64:79], a[24:27], v[140:143], v[64:79]
    v_mfma_f32_32x32x16_bf16 v[80:95], a[28:31], v[140:143], v[80:95]
    v_mfma_f32_32x32x16_bf16 v[96:111], a[24:27], v[156:159], v[96:111]
    v_mfma_f32_32x32x16_bf16 v[112:127], a[28:31], v[156:159], v[112:127]
    s_add_u32 m0, s46, 0
    s_add_u32 s47, s45, 688128
    buffer_load_dwordx4 v9, s[24:27], s47 offen lds
    s_add_u32 m0, s46, 1024
    s_add_u32 s47, s45, 695296
    buffer_load_dwordx4 v9, s[24:27], s47 offen lds
    s_add_u32 m0, s46, 2048
    s_add_u32 s47, s45, 702464
    buffer_load_dwordx4 v9, s[24:27], s47 offen lds
    s_add_u32 m0, s46, 3072
    s_add_u32 s47, s45, 709632
    buffer_load_dwordx4 v9, s[24:27], s47 offen lds
    s_add_u32 m0, s46, 4096
    s_add_u32 s47, s45, 716800
    buffer_load_dwordx4 v9, s[24:27], s47 offen lds
    s_add_u32 m0, s46, 5120
    s_add_u32 s47, s45, 723968
    buffer_load_dwordx4 v9, s[24:27], s47 offen lds
    s_add_u32 m0, s46, 6144
    s_add_u32 s47, s45, 731136
    buffer_load_dwordx4 v9, s[24:27], s47 offen lds
    s_add_u32 m0, s46, 7168
    s_add_u32 s47, s45, 738304
    buffer_load_dwordx4 v9, s[24:27], s47 offen lds
    s_add_u32 m0, s46, 8192
    s_mov_b32 s47, 1536
    buffer_load_dwordx4 v8, s[20:23], s47 offen lds
    s_add_u32 m0, s46, 9216
    s_mov_b32 s47, 67072
    buffer_load_dwordx4 v15, s[20:23], s47 offen lds
    s_add_u32 m0, s46, 10240
    s_mov_b32 s47, 132608
    buffer_load_dwordx4 v8, s[20:23], s47 offen lds
    s_add_u32 m0, s46, 11264
    s_mov_b32 s47, 198144
    buffer_load_dwordx4 v15, s[20:23], s47 offen lds
    s_add_u32 m0, s46, 12288
    s_mov_b32 s47, 7341568
    buffer_load_dwordx4 v8, s[20:23], s47 offen lds
    s_add_u32 m0, s46, 13312
    s_mov_b32 s47, 7407104
    buffer_load_dwordx4 v15, s[20:23], s47 offen lds
    s_add_u32 m0, s46, 14336
    s_mov_b32 s47, 7472640
    buffer_load_dwordx4 v8, s[20:23], s47 offen lds
    s_add_u32 m0, s46, 15360
    s_mov_b32 s47, 7538176
    buffer_load_dwordx4 v15, s[20:23], s47 offen lds
    s_waitcnt vmcnt(16)
    ds_read_b64_tr_b16 a[0:1], v12 offset:16384
    ds_read_b64_tr_b16 a[2:3], v12 offset:16896
    ds_read_b64_tr_b16 a[4:5], v13 offset:16384
    ds_read_b64_tr_b16 a[6:7], v13 offset:16896
    ds_read_b128 v[128:131], v16 offset:24576
    ds_read_b128 v[144:147], v16 offset:28672
    ds_read_b64_tr_b16 a[8:9], v12 offset:18432
    ds_read_b64_tr_b16 a[10:11], v12 offset:18944
    ds_read_b64_tr_b16 a[12:13], v13 offset:18432
    ds_read_b64_tr_b16 a[14:15], v13 offset:18944
    ds_read_b128 v[132:135], v17 offset:24576
    ds_read_b128 v[148:151], v17 offset:28672
    ds_read_b64_tr_b16 a[16:17], v12 offset:20480
    ds_read_b64_tr_b16 a[18:19], v12 offset:20992
    ds_read_b64_tr_b16 a[20:21], v13 offset:20480
    ds_read_b64_tr_b16 a[22:23], v13 offset:20992
    ds_read_b128 v[136:139], v18 offset:24576
    ds_read_b128 v[152:155], v18 offset:28672
    ds_read_b64_tr_b16 a[24:25], v12 offset:22528
    ds_read_b64_tr_b16 a[26:27], v12 offset:23040
    ds_read_b64_tr_b16 a[28:29], v13 offset:22528
    ds_read_b64_tr_b16 a[30:31], v13 offset:23040
    ds_read_b128 v[140:143], v19 offset:24576
    ds_read_b128 v[156:159], v19 offset:28672
    s_waitcnt lgkmcnt(15)
    v_mfma_f32_32x32x16_bf16 v[64:79], a[0:3], v[128:131], v[64:79]
    v_mfma_f32_32x32x16_bf16 v[80:95], a[4:7], v[128:131], v[80:95]
    v_mfma_f32_32x32x16_bf16 v[96:111], a[0:3], v[144:147], v[96:111]
    v_mfma_f32_32x32x16_bf16 v[112:127], a[4:7], v[144:147], v[112:127]
    s_waitcnt lgkmcnt(12)
    v_mfma_f32_32x32x16_bf16 v[64:79], a[8:11], v[132:135], v[64:79]
    v_mfma_f32_32x32x16_bf16 v[80:95], a[12:15], v[132:135], v[80:95]
    v_mfma_f32_32x32x16_bf16 v[96:111], a[8:11], v[148:151], v[96:111]
    v_mfma_f32_32x32x16_bf16 v[112:127], a[12:15], v[148:151], v[112:127]
    s_waitcnt lgkmcnt(6)
    v_mfma_f32_32x32x16_bf16 v[64:79], a[16:19], v[136:139], v[64:79]
    v_mfma_f32_32x32x16_bf16 v[80:95], a[20:23], v[136:139], v[80:95]
    v_mfma_f32_32x32x16_bf16 v[96:111], a[16:19], v[152:155], v[96:111]
    v_mfma_f32_32x32x16_bf16 v[112:127], a[20:23], v[152:155], v[112:127]
    s_waitcnt lgkmcnt(0)
    v_mfma_f32_32x32x16_bf16 v[64:79], a[24:27], v[140:143], v[64:79]
    v_mfma_f32_32x32x16_bf16 v[80:95], a[28:31], v[140:143], v[80:95]
    v_mfma_f32_32x32x16_bf16 v[96:111], a[24:27], v[156:159], v[96:111]
    v_mfma_f32_32x32x16_bf16 v[112:127], a[28:31], v[156:159], v[112:127]
    s_nop 15
    s_nop 3
    v_fma_f32 v32, v64, v22, v32
    v_fma_f32 v32, v96, v26, v32
    v_fma_f32 v33, v65, v22, v33
    v_fma_f32 v33, v97, v26, v33
    v_fma_f32 v34, v66, v22, v34
    v_fma_f32 v34, v98, v26, v34
    v_fma_f32 v35, v67, v22, v35
    v_fma_f32 v35, v99, v26, v35
    v_fma_f32 v36, v68, v22, v36
    v_fma_f32 v36, v100, v26, v36
    v_fma_f32 v37, v69, v22, v37
    v_fma_f32 v37, v101, v26, v37
    v_fma_f32 v38, v70, v22, v38
    v_fma_f32 v38, v102, v26, v38
    v_fma_f32 v39, v71, v22, v39
    v_fma_f32 v39, v103, v26, v39
    v_fma_f32 v40, v72, v22, v40
    v_fma_f32 v40, v104, v26, v40
    v_fma_f32 v41, v73, v22, v41
    v_fma_f32 v41, v105, v26, v41
    v_fma_f32 v42, v74, v22, v42
    v_fma_f32 v42, v106, v26, v42
    v_fma_f32 v43, v75, v22, v43
    v_fma_f32 v43, v107, v26, v43
    v_fma_f32 v44, v76, v22, v44
    v_fma_f32 v44, v108, v26, v44
    v_fma_f32 v45, v77, v22, v45
    v_fma_f32 v45, v109, v26, v45
    v_fma_f32 v46, v78, v22, v46
    v_fma_f32 v46, v110, v26, v46
    v_fma_f32 v47, v79, v22, v47
    v_fma_f32 v47, v111, v26, v47
    v_fma_f32 v48, v80, v22, v48
    v_fma_f32 v48, v112, v26, v48
    v_fma_f32 v49, v81, v22, v49
    v_fma_f32 v49, v113, v26, v49
    v_fma_f32 v50, v82, v22, v50
    v_fma_f32 v50, v114, v26, v50
    v_fma_f32 v51, v83, v22, v51
    v_fma_f32 v51, v115, v26, v51
    v_fma_f32 v52, v84, v22, v52
    v_fma_f32 v52, v116, v26, v52
    v_fma_f32 v53, v85, v22, v53
    v_fma_f32 v53, v117, v26, v53
    v_fma_f32 v54, v86, v22, v54
    v_fma_f32 v54, v118, v26, v54
    v_fma_f32 v55, v87, v22, v55
    v_fma_f32 v55, v119, v26, v55
    v_fma_f32 v56, v88, v22, v56
    v_fma_f32 v56, v120, v26, v56
    v_fma_f32 v57, v89, v22, v57
    v_fma_f32 v57, v121, v26, v57
    v_fma_f32 v58, v90, v22, v58
    v_fma_f32 v58, v122, v26, v58
    v_fma_f32 v59, v91, v22, v59
    v_fma_f32 v59, v123, v26, v59
    v_fma_f32 v60, v92, v22, v60
    v_fma_f32 v60, v124, v26, v60
    v_fma_f32 v61, v93, v22, v61
    v_fma_f32 v61, v125, v26, v61
    v_fma_f32 v62, v94, v22, v62
    v_fma_f32 v62, v126, v26, v62
    v_fma_f32 v63, v95, v22, v63
    v_fma_f32 v63, v127, v26, v63
    s_add_u32 m0, s46, 16384
    s_add_u32 s47, s45, 745472
    buffer_load_dwordx4 v9, s[24:27], s47 offen lds
    s_add_u32 m0, s46, 17408
    s_add_u32 s47, s45, 752640
    buffer_load_dwordx4 v9, s[24:27], s47 offen lds
    s_add_u32 m0, s46, 18432
    s_add_u32 s47, s45, 759808
    buffer_load_dwordx4 v9, s[24:27], s47 offen lds
    s_add_u32 m0, s46, 19456
    s_add_u32 s47, s45, 766976
    buffer_load_dwordx4 v9, s[24:27], s47 offen lds
    s_add_u32 m0, s46, 20480
    s_add_u32 s47, s45, 774144
    buffer_load_dwordx4 v9, s[24:27], s47 offen lds
    s_add_u32 m0, s46, 21504
    s_add_u32 s47, s45, 781312
    buffer_load_dwordx4 v9, s[24:27], s47 offen lds
    s_add_u32 m0, s46, 22528
    s_add_u32 s47, s45, 788480
    buffer_load_dwordx4 v9, s[24:27], s47 offen lds
    s_add_u32 m0, s46, 23552
    s_add_u32 s47, s45, 795648
    buffer_load_dwordx4 v9, s[24:27], s47 offen lds
    s_add_u32 m0, s46, 24576
    s_mov_b32 s47, 1664
    buffer_load_dwordx4 v8, s[20:23], s47 offen lds
    s_add_u32 m0, s46, 25600
    s_mov_b32 s47, 67200
    buffer_load_dwordx4 v15, s[20:23], s47 offen lds
    s_add_u32 m0, s46, 26624
    s_mov_b32 s47, 132736
    buffer_load_dwordx4 v8, s[20:23], s47 offen lds
    s_add_u32 m0, s46, 27648
    s_mov_b32 s47, 198272
    buffer_load_dwordx4 v15, s[20:23], s47 offen lds
    s_add_u32 m0, s46, 28672
    s_mov_b32 s47, 7341696
    buffer_load_dwordx4 v8, s[20:23], s47 offen lds
    s_add_u32 m0, s46, 29696
    s_mov_b32 s47, 7407232
    buffer_load_dwordx4 v15, s[20:23], s47 offen lds
    s_add_u32 m0, s46, 30720
    s_mov_b32 s47, 7472768
    buffer_load_dwordx4 v8, s[20:23], s47 offen lds
    s_add_u32 m0, s46, 31744
    s_mov_b32 s47, 7538304
    buffer_load_dwordx4 v15, s[20:23], s47 offen lds
    s_waitcnt vmcnt(16)
    ds_read_b64_tr_b16 a[0:1], v12 offset:0
    ds_read_b64_tr_b16 a[2:3], v12 offset:512
    ds_read_b64_tr_b16 a[4:5], v13 offset:0
    ds_read_b64_tr_b16 a[6:7], v13 offset:512
    ds_read_b128 v[128:131], v16 offset:8192
    ds_read_b128 v[144:147], v16 offset:12288
    ds_read_b64_tr_b16 a[8:9], v12 offset:2048
    ds_read_b64_tr_b16 a[10:11], v12 offset:2560
    ds_read_b64_tr_b16 a[12:13], v13 offset:2048
    ds_read_b64_tr_b16 a[14:15], v13 offset:2560
    ds_read_b128 v[132:135], v17 offset:8192
    ds_read_b128 v[148:151], v17 offset:12288
    ds_read_b64_tr_b16 a[16:17], v12 offset:4096
    ds_read_b64_tr_b16 a[18:19], v12 offset:4608
    ds_read_b64_tr_b16 a[20:21], v13 offset:4096
    ds_read_b64_tr_b16 a[22:23], v13 offset:4608
    ds_read_b128 v[136:139], v18 offset:8192
    ds_read_b128 v[152:155], v18 offset:12288
    ds_read_b64_tr_b16 a[24:25], v12 offset:6144
    ds_read_b64_tr_b16 a[26:27], v12 offset:6656
    ds_read_b64_tr_b16 a[28:29], v13 offset:6144
    ds_read_b64_tr_b16 a[30:31], v13 offset:6656
    ds_read_b128 v[140:143], v19 offset:8192
    ds_read_b128 v[156:159], v19 offset:12288
    s_waitcnt lgkmcnt(15)
    v_mfma_f32_32x32x16_bf16 v[64:79], a[0:3], v[128:131], 0
    v_mfma_f32_32x32x16_bf16 v[80:95], a[4:7], v[128:131], 0
    v_mfma_f32_32x32x16_bf16 v[96:111], a[0:3], v[144:147], 0
    v_mfma_f32_32x32x16_bf16 v[112:127], a[4:7], v[144:147], 0
    s_waitcnt lgkmcnt(12)
    v_mfma_f32_32x32x16_bf16 v[64:79], a[8:11], v[132:135], v[64:79]
    v_mfma_f32_32x32x16_bf16 v[80:95], a[12:15], v[132:135], v[80:95]
    v_mfma_f32_32x32x16_bf16 v[96:111], a[8:11], v[148:151], v[96:111]
    v_mfma_f32_32x32x16_bf16 v[112:127], a[12:15], v[148:151], v[112:127]
    s_waitcnt lgkmcnt(6)
    v_mfma_f32_32x32x16_bf16 v[64:79], a[16:19], v[136:139], v[64:79]
    v_mfma_f32_32x32x16_bf16 v[80:95], a[20:23], v[136:139], v[80:95]
    v_mfma_f32_32x32x16_bf16 v[96:111], a[16:19], v[152:155], v[96:111]
    v_mfma_f32_32x32x16_bf16 v[112:127], a[20:23], v[152:155], v[112:127]
    s_waitcnt lgkmcnt(0)
    v_mfma_f32_32x32x16_bf16 v[64:79], a[24:27], v[140:143], v[64:79]
    v_mfma_f32_32x32x16_bf16 v[80:95], a[28:31], v[140:143], v[80:95]
    v_mfma_f32_32x32x16_bf16 v[96:111], a[24:27], v[156:159], v[96:111]
    v_mfma_f32_32x32x16_bf16 v[112:127], a[28:31], v[156:159], v[112:127]
    s_add_u32 m0, s46, 0
    s_add_u32 s47, s45, 802816
    buffer_load_dwordx4 v9, s[24:27], s47 offen lds
    s_add_u32 m0, s46, 1024
    s_add_u32 s47, s45, 809984
    buffer_load_dwordx4 v9, s[24:27], s47 offen lds
    s_add_u32 m0, s46, 2048
    s_add_u32 s47, s45, 817152
    buffer_load_dwordx4 v9, s[24:27], s47 offen lds
    s_add_u32 m0, s46, 3072
    s_add_u32 s47, s45, 824320
    buffer_load_dwordx4 v9, s[24:27], s47 offen lds
    s_add_u32 m0, s46, 4096
    s_add_u32 s47, s45, 831488
    buffer_load_dwordx4 v9, s[24:27], s47 offen lds
    s_add_u32 m0, s46, 5120
    s_add_u32 s47, s45, 838656
    buffer_load_dwordx4 v9, s[24:27], s47 offen lds
    s_add_u32 m0, s46, 6144
    s_add_u32 s47, s45, 845824
    buffer_load_dwordx4 v9, s[24:27], s47 offen lds
    s_add_u32 m0, s46, 7168
    s_add_u32 s47, s45, 852992
    buffer_load_dwordx4 v9, s[24:27], s47 offen lds
    s_add_u32 m0, s46, 8192
    s_mov_b32 s47, 1792
    buffer_load_dwordx4 v8, s[20:23], s47 offen lds
    s_add_u32 m0, s46, 9216
    s_mov_b32 s47, 67328
    buffer_load_dwordx4 v15, s[20:23], s47 offen lds
    s_add_u32 m0, s46, 10240
    s_mov_b32 s47, 132864
    buffer_load_dwordx4 v8, s[20:23], s47 offen lds
    s_add_u32 m0, s46, 11264
    s_mov_b32 s47, 198400
    buffer_load_dwordx4 v15, s[20:23], s47 offen lds
    s_add_u32 m0, s46, 12288
    s_mov_b32 s47, 7341824
    buffer_load_dwordx4 v8, s[20:23], s47 offen lds
    s_add_u32 m0, s46, 13312
    s_mov_b32 s47, 7407360
    buffer_load_dwordx4 v15, s[20:23], s47 offen lds
    s_add_u32 m0, s46, 14336
    s_mov_b32 s47, 7472896
    buffer_load_dwordx4 v8, s[20:23], s47 offen lds
    s_add_u32 m0, s46, 15360
    s_mov_b32 s47, 7538432
    buffer_load_dwordx4 v15, s[20:23], s47 offen lds
    s_waitcnt vmcnt(16)
    ds_read_b64_tr_b16 a[0:1], v12 offset:16384
    ds_read_b64_tr_b16 a[2:3], v12 offset:16896
    ds_read_b64_tr_b16 a[4:5], v13 offset:16384
    ds_read_b64_tr_b16 a[6:7], v13 offset:16896
    ds_read_b128 v[128:131], v16 offset:24576
    ds_read_b128 v[144:147], v16 offset:28672
    ds_read_b64_tr_b16 a[8:9], v12 offset:18432
    ds_read_b64_tr_b16 a[10:11], v12 offset:18944
    ds_read_b64_tr_b16 a[12:13], v13 offset:18432
    ds_read_b64_tr_b16 a[14:15], v13 offset:18944
    ds_read_b128 v[132:135], v17 offset:24576
    ds_read_b128 v[148:151], v17 offset:28672
    ds_read_b64_tr_b16 a[16:17], v12 offset:20480
    ds_read_b64_tr_b16 a[18:19], v12 offset:20992
    ds_read_b64_tr_b16 a[20:21], v13 offset:20480
    ds_read_b64_tr_b16 a[22:23], v13 offset:20992
    ds_read_b128 v[136:139], v18 offset:24576
    ds_read_b128 v[152:155], v18 offset:28672
    ds_read_b64_tr_b16 a[24:25], v12 offset:22528
    ds_read_b64_tr_b16 a[26:27], v12 offset:23040
    ds_read_b64_tr_b16 a[28:29], v13 offset:22528
    ds_read_b64_tr_b16 a[30:31], v13 offset:23040
    ds_read_b128 v[140:143], v19 offset:24576
    ds_read_b128 v[156:159], v19 offset:28672
    s_waitcnt lgkmcnt(15)
    v_mfma_f32_32x32x16_bf16 v[64:79], a[0:3], v[128:131], v[64:79]
    v_mfma_f32_32x32x16_bf16 v[80:95], a[4:7], v[128:131], v[80:95]
    v_mfma_f32_32x32x16_bf16 v[96:111], a[0:3], v[144:147], v[96:111]
    v_mfma_f32_32x32x16_bf16 v[112:127], a[4:7], v[144:147], v[112:127]
    s_waitcnt lgkmcnt(12)
    v_mfma_f32_32x32x16_bf16 v[64:79], a[8:11], v[132:135], v[64:79]
    v_mfma_f32_32x32x16_bf16 v[80:95], a[12:15], v[132:135], v[80:95]
    v_mfma_f32_32x32x16_bf16 v[96:111], a[8:11], v[148:151], v[96:111]
    v_mfma_f32_32x32x16_bf16 v[112:127], a[12:15], v[148:151], v[112:127]
    s_waitcnt lgkmcnt(6)
    v_mfma_f32_32x32x16_bf16 v[64:79], a[16:19], v[136:139], v[64:79]
    v_mfma_f32_32x32x16_bf16 v[80:95], a[20:23], v[136:139], v[80:95]
    v_mfma_f32_32x32x16_bf16 v[96:111], a[16:19], v[152:155], v[96:111]
    v_mfma_f32_32x32x16_bf16 v[112:127], a[20:23], v[152:155], v[112:127]
    s_waitcnt lgkmcnt(0)
    v_mfma_f32_32x32x16_bf16 v[64:79], a[24:27], v[140:143], v[64:79]
    v_mfma_f32_32x32x16_bf16 v[80:95], a[28:31], v[140:143], v[80:95]
    v_mfma_f32_32x32x16_bf16 v[96:111], a[24:27], v[156:159], v[96:111]
    v_mfma_f32_32x32x16_bf16 v[112:127], a[28:31], v[156:159], v[112:127]
    s_add_u32 m0, s46, 16384
    s_add_u32 s47, s45, 860160
    buffer_load_dwordx4 v9, s[24:27], s47 offen lds
    s_add_u32 m0, s46, 17408
    s_add_u32 s47, s45, 867328
    buffer_load_dwordx4 v9, s[24:27], s47 offen lds
    s_add_u32 m0, s46, 18432
    s_add_u32 s47, s45, 874496
    buffer_load_dwordx4 v9, s[24:27], s47 offen lds
    s_add_u32 m0, s46, 19456
    s_add_u32 s47, s45, 881664
    buffer_load_dwordx4 v9, s[24:27], s47 offen lds
    s_add_u32 m0, s46, 20480
    s_add_u32 s47, s45, 888832
    buffer_load_dwordx4 v9, s[24:27], s47 offen lds
    s_add_u32 m0, s46, 21504
    s_add_u32 s47, s45, 896000
    buffer_load_dwordx4 v9, s[24:27], s47 offen lds
    s_add_u32 m0, s46, 22528
    s_add_u32 s47, s45, 903168
    buffer_load_dwordx4 v9, s[24:27], s47 offen lds
    s_add_u32 m0, s46, 23552
    s_add_u32 s47, s45, 910336
    buffer_load_dwordx4 v9, s[24:27], s47 offen lds
    s_add_u32 m0, s46, 24576
    s_mov_b32 s47, 1920
    buffer_load_dwordx4 v8, s[20:23], s47 offen lds
    s_add_u32 m0, s46, 25600
    s_mov_b32 s47, 67456
    buffer_load_dwordx4 v15, s[20:23], s47 offen lds
    s_add_u32 m0, s46, 26624
    s_mov_b32 s47, 132992
    buffer_load_dwordx4 v8, s[20:23], s47 offen lds
    s_add_u32 m0, s46, 27648
    s_mov_b32 s47, 198528
    buffer_load_dwordx4 v15, s[20:23], s47 offen lds
    s_add_u32 m0, s46, 28672
    s_mov_b32 s47, 7341952
    buffer_load_dwordx4 v8, s[20:23], s47 offen lds
    s_add_u32 m0, s46, 29696
    s_mov_b32 s47, 7407488
    buffer_load_dwordx4 v15, s[20:23], s47 offen lds
    s_add_u32 m0, s46, 30720
    s_mov_b32 s47, 7473024
    buffer_load_dwordx4 v8, s[20:23], s47 offen lds
    s_add_u32 m0, s46, 31744
    s_mov_b32 s47, 7538560
    buffer_load_dwordx4 v15, s[20:23], s47 offen lds
    s_waitcnt vmcnt(16)
    ds_read_b64_tr_b16 a[0:1], v12 offset:0
    ds_read_b64_tr_b16 a[2:3], v12 offset:512
    ds_read_b64_tr_b16 a[4:5], v13 offset:0
    ds_read_b64_tr_b16 a[6:7], v13 offset:512
    ds_read_b128 v[128:131], v16 offset:8192
    ds_read_b128 v[144:147], v16 offset:12288
    ds_read_b64_tr_b16 a[8:9], v12 offset:2048
    ds_read_b64_tr_b16 a[10:11], v12 offset:2560
    ds_read_b64_tr_b16 a[12:13], v13 offset:2048
    ds_read_b64_tr_b16 a[14:15], v13 offset:2560
    ds_read_b128 v[132:135], v17 offset:8192
    ds_read_b128 v[148:151], v17 offset:12288
    ds_read_b64_tr_b16 a[16:17], v12 offset:4096
    ds_read_b64_tr_b16 a[18:19], v12 offset:4608
    ds_read_b64_tr_b16 a[20:21], v13 offset:4096
    ds_read_b64_tr_b16 a[22:23], v13 offset:4608
    ds_read_b128 v[136:139], v18 offset:8192
    ds_read_b128 v[152:155], v18 offset:12288
    ds_read_b64_tr_b16 a[24:25], v12 offset:6144
    ds_read_b64_tr_b16 a[26:27], v12 offset:6656
    ds_read_b64_tr_b16 a[28:29], v13 offset:6144
    ds_read_b64_tr_b16 a[30:31], v13 offset:6656
    ds_read_b128 v[140:143], v19 offset:8192
    ds_read_b128 v[156:159], v19 offset:12288
    s_waitcnt lgkmcnt(15)
    v_mfma_f32_32x32x16_bf16 v[64:79], a[0:3], v[128:131], v[64:79]
    v_mfma_f32_32x32x16_bf16 v[80:95], a[4:7], v[128:131], v[80:95]
    v_mfma_f32_32x32x16_bf16 v[96:111], a[0:3], v[144:147], v[96:111]
    v_mfma_f32_32x32x16_bf16 v[112:127], a[4:7], v[144:147], v[112:127]
    s_waitcnt lgkmcnt(12)
    v_mfma_f32_32x32x16_bf16 v[64:79], a[8:11], v[132:135], v[64:79]
    v_mfma_f32_32x32x16_bf16 v[80:95], a[12:15], v[132:135], v[80:95]
    v_mfma_f32_32x32x16_bf16 v[96:111], a[8:11], v[148:151], v[96:111]
    v_mfma_f32_32x32x16_bf16 v[112:127], a[12:15], v[148:151], v[112:127]
    s_waitcnt lgkmcnt(6)
    v_mfma_f32_32x32x16_bf16 v[64:79], a[16:19], v[136:139], v[64:79]
    v_mfma_f32_32x32x16_bf16 v[80:95], a[20:23], v[136:139], v[80:95]
    v_mfma_f32_32x32x16_bf16 v[96:111], a[16:19], v[152:155], v[96:111]
    v_mfma_f32_32x32x16_bf16 v[112:127], a[20:23], v[152:155], v[112:127]
    s_waitcnt lgkmcnt(0)
    v_mfma_f32_32x32x16_bf16 v[64:79], a[24:27], v[140:143], v[64:79]
    v_mfma_f32_32x32x16_bf16 v[80:95], a[28:31], v[140:143], v[80:95]
    v_mfma_f32_32x32x16_bf16 v[96:111], a[24:27], v[156:159], v[96:111]
    v_mfma_f32_32x32x16_bf16 v[112:127], a[28:31], v[156:159], v[112:127]
    s_waitcnt vmcnt(0)
    ds_read_b64_tr_b16 a[0:1], v12 offset:16384
    ds_read_b64_tr_b16 a[2:3], v12 offset:16896
    ds_read_b64_tr_b16 a[4:5], v13 offset:16384
    ds_read_b64_tr_b16 a[6:7], v13 offset:16896
    ds_read_b128 v[128:131], v16 offset:24576
    ds_read_b128 v[144:147], v16 offset:28672
    ds_read_b64_tr_b16 a[8:9], v12 offset:18432
    ds_read_b64_tr_b16 a[10:11], v12 offset:18944
    ds_read_b64_tr_b16 a[12:13], v13 offset:18432
    ds_read_b64_tr_b16 a[14:15], v13 offset:18944
    ds_read_b128 v[132:135], v17 offset:24576
    ds_read_b128 v[148:151], v17 offset:28672
    ds_read_b64_tr_b16 a[16:17], v12 offset:20480
    ds_read_b64_tr_b16 a[18:19], v12 offset:20992
    ds_read_b64_tr_b16 a[20:21], v13 offset:20480
    ds_read_b64_tr_b16 a[22:23], v13 offset:20992
    ds_read_b128 v[136:139], v18 offset:24576
    ds_read_b128 v[152:155], v18 offset:28672
    ds_read_b64_tr_b16 a[24:25], v12 offset:22528
    ds_read_b64_tr_b16 a[26:27], v12 offset:23040
    ds_read_b64_tr_b16 a[28:29], v13 offset:22528
    ds_read_b64_tr_b16 a[30:31], v13 offset:23040
    ds_read_b128 v[140:143], v19 offset:24576
    ds_read_b128 v[156:159], v19 offset:28672
    s_waitcnt lgkmcnt(15)
    v_mfma_f32_32x32x16_bf16 v[64:79], a[0:3], v[128:131], v[64:79]
    v_mfma_f32_32x32x16_bf16 v[80:95], a[4:7], v[128:131], v[80:95]
    v_mfma_f32_32x32x16_bf16 v[96:111], a[0:3], v[144:147], v[96:111]
    v_mfma_f32_32x32x16_bf16 v[112:127], a[4:7], v[144:147], v[112:127]
    s_waitcnt lgkmcnt(12)
    v_mfma_f32_32x32x16_bf16 v[64:79], a[8:11], v[132:135], v[64:79]
    v_mfma_f32_32x32x16_bf16 v[80:95], a[12:15], v[132:135], v[80:95]
    v_mfma_f32_32x32x16_bf16 v[96:111], a[8:11], v[148:151], v[96:111]
    v_mfma_f32_32x32x16_bf16 v[112:127], a[12:15], v[148:151], v[112:127]
    s_waitcnt lgkmcnt(6)
    v_mfma_f32_32x32x16_bf16 v[64:79], a[16:19], v[136:139], v[64:79]
    v_mfma_f32_32x32x16_bf16 v[80:95], a[20:23], v[136:139], v[80:95]
    v_mfma_f32_32x32x16_bf16 v[96:111], a[16:19], v[152:155], v[96:111]
    v_mfma_f32_32x32x16_bf16 v[112:127], a[20:23], v[152:155], v[112:127]
    s_waitcnt lgkmcnt(0)
    v_mfma_f32_32x32x16_bf16 v[64:79], a[24:27], v[140:143], v[64:79]
    v_mfma_f32_32x32x16_bf16 v[80:95], a[28:31], v[140:143], v[80:95]
    v_mfma_f32_32x32x16_bf16 v[96:111], a[24:27], v[156:159], v[96:111]
    v_mfma_f32_32x32x16_bf16 v[112:127], a[28:31], v[156:159], v[112:127]
    s_nop 15
    s_nop 3
    v_fma_f32 v32, v64, v23, v32
    v_fma_f32 v32, v96, v27, v32
    v_fma_f32 v33, v65, v23, v33
    v_fma_f32 v33, v97, v27, v33
    v_fma_f32 v34, v66, v23, v34
    v_fma_f32 v34, v98, v27, v34
    v_fma_f32 v35, v67, v23, v35
    v_fma_f32 v35, v99, v27, v35
    v_fma_f32 v36, v68, v23, v36
    v_fma_f32 v36, v100, v27, v36
    v_fma_f32 v37, v69, v23, v37
    v_fma_f32 v37, v101, v27, v37
    v_fma_f32 v38, v70, v23, v38
    v_fma_f32 v38, v102, v27, v38
    v_fma_f32 v39, v71, v23, v39
    v_fma_f32 v39, v103, v27, v39
    v_fma_f32 v40, v72, v23, v40
    v_fma_f32 v40, v104, v27, v40
    v_fma_f32 v41, v73, v23, v41
    v_fma_f32 v41, v105, v27, v41
    v_fma_f32 v42, v74, v23, v42
    v_fma_f32 v42, v106, v27, v42
    v_fma_f32 v43, v75, v23, v43
    v_fma_f32 v43, v107, v27, v43
    v_fma_f32 v44, v76, v23, v44
    v_fma_f32 v44, v108, v27, v44
    v_fma_f32 v45, v77, v23, v45
    v_fma_f32 v45, v109, v27, v45
    v_fma_f32 v46, v78, v23, v46
    v_fma_f32 v46, v110, v27, v46
    v_fma_f32 v47, v79, v23, v47
    v_fma_f32 v47, v111, v27, v47
    v_fma_f32 v48, v80, v23, v48
    v_fma_f32 v48, v112, v27, v48
    v_fma_f32 v49, v81, v23, v49
    v_fma_f32 v49, v113, v27, v49
    v_fma_f32 v50, v82, v23, v50
    v_fma_f32 v50, v114, v27, v50
    v_fma_f32 v51, v83, v23, v51
    v_fma_f32 v51, v115, v27, v51
    v_fma_f32 v52, v84, v23, v52
    v_fma_f32 v52, v116, v27, v52
    v_fma_f32 v53, v85, v23, v53
    v_fma_f32 v53, v117, v27, v53
    v_fma_f32 v54, v86, v23, v54
    v_fma_f32 v54, v118, v27, v54
    v_fma_f32 v55, v87, v23, v55
    v_fma_f32 v55, v119, v27, v55
    v_fma_f32 v56, v88, v23, v56
    v_fma_f32 v56, v120, v27, v56
    v_fma_f32 v57, v89, v23, v57
    v_fma_f32 v57, v121, v27, v57
    v_fma_f32 v58, v90, v23, v58
    v_fma_f32 v58, v122, v27, v58
    v_fma_f32 v59, v91, v23, v59
    v_fma_f32 v59, v123, v27, v59
    v_fma_f32 v60, v92, v23, v60
    v_fma_f32 v60, v124, v27, v60
    v_fma_f32 v61, v93, v23, v61
    v_fma_f32 v61, v125, v27, v61
    v_fma_f32 v62, v94, v23, v62
    v_fma_f32 v62, v126, v27, v62
    v_fma_f32 v63, v95, v23, v63
    v_fma_f32 v63, v127, v27, v63
    v_lshlrev_b32 v16, 4, v1
    v_add_u32 v17, s46, v16
    ds_write_b128 v17, v[32:35] offset:0
    ds_write_b128 v17, v[36:39] offset:1024
    ds_write_b128 v17, v[40:43] offset:2048
    ds_write_b128 v17, v[44:47] offset:3072
    ds_write_b128 v17, v[48:51] offset:4096
    ds_write_b128 v17, v[52:55] offset:5120
    ds_write_b128 v17, v[56:59] offset:6144
    ds_write_b128 v17, v[60:63] offset:7168
    s_waitcnt lgkmcnt(0)
    s_barrier
    s_cmp_lg_u32 s40, 0
    s_cbranch_scc1 LB_end
    v_add_u32 v18, 32768, v16
    ds_read_b128 v[128:131], v18 offset:0
    ds_read_b128 v[132:135], v18 offset:1024
    ds_read_b128 v[136:139], v18 offset:2048
    ds_read_b128 v[140:143], v18 offset:3072
    ds_read_b128 v[144:147], v18 offset:4096
    ds_read_b128 v[148:151], v18 offset:5120
    ds_read_b128 v[152:155], v18 offset:6144
    ds_read_b128 v[156:159], v18 offset:7168
    s_waitcnt lgkmcnt(0)
    v_add_f32 v32, v32, v128
    v_add_f32 v33, v33, v129
    v_add_f32 v34, v34, v130
    v_add_f32 v35, v35, v131
    v_add_f32 v36, v36, v132
    v_add_f32 v37, v37, v133
    v_add_f32 v38, v38, v134
    v_add_f32 v39, v39, v135
    v_add_f32 v40, v40, v136
    v_add_f32 v41, v41, v137
    v_add_f32 v42, v42, v138
    v_add_f32 v43, v43, v139
    v_add_f32 v44, v44, v140
    v_add_f32 v45, v45, v141
    v_add_f32 v46, v46, v142
    v_add_f32 v47, v47, v143
    v_add_f32 v48, v48, v144
    v_add_f32 v49, v49, v145
    v_add_f32 v50, v50, v146
    v_add_f32 v51, v51, v147
    v_add_f32 v52, v52, v148
    v_add_f32 v53, v53, v149
    v_add_f32 v54, v54, v150
    v_add_f32 v55, v55, v151
    v_add_f32 v56, v56, v152
    v_add_f32 v57, v57, v153
    v_add_f32 v58, v58, v154
    v_add_f32 v59, v59, v155
    v_add_f32 v60, v60, v156
    v_add_f32 v61, v61, v157
    v_add_f32 v62, v62, v158
    v_add_f32 v63, v63, v159
    v_add_u32 v18, 65536, v16
    ds_read_b128 v[128:131], v18 offset:0
    ds_read_b128 v[132:135], v18 offset:1024
    ds_read_b128 v[136:139], v18 offset:2048
    ds_read_b128 v[140:143], v18 offset:3072
    ds_read_b128 v[144:147], v18 offset:4096
    ds_read_b128 v[148:151], v18 offset:5120
    ds_read_b128 v[152:155], v18 offset:6144
    ds_read_b128 v[156:159], v18 offset:7168
    s_waitcnt lgkmcnt(0)
    v_add_f32 v32, v32, v128
    v_add_f32 v33, v33, v129
    v_add_f32 v34, v34, v130
    v_add_f32 v35, v35, v131
    v_add_f32 v36, v36, v132
    v_add_f32 v37, v37, v133
    v_add_f32 v38, v38, v134
    v_add_f32 v39, v39, v135
    v_add_f32 v40, v40, v136
    v_add_f32 v41, v41, v137
    v_add_f32 v42, v42, v138
    v_add_f32 v43, v43, v139
    v_add_f32 v44, v44, v140
    v_add_f32 v45, v45, v141
    v_add_f32 v46, v46, v142
    v_add_f32 v47, v47, v143
    v_add_f32 v48, v48, v144
    v_add_f32 v49, v49, v145
    v_add_f32 v50, v50, v146
    v_add_f32 v51, v51, v147
    v_add_f32 v52, v52, v148
    v_add_f32 v53, v53, v149
    v_add_f32 v54, v54, v150
    v_add_f32 v55, v55, v151
    v_add_f32 v56, v56, v152
    v_add_f32 v57, v57, v153
    v_add_f32 v58, v58, v154
    v_add_f32 v59, v59, v155
    v_add_f32 v60, v60, v156
    v_add_f32 v61, v61, v157
    v_add_f32 v62, v62, v158
    v_add_f32 v63, v63, v159
    v_add_u32 v18, 98304, v16
    ds_read_b128 v[128:131], v18 offset:0
    ds_read_b128 v[132:135], v18 offset:1024
    ds_read_b128 v[136:139], v18 offset:2048
    ds_read_b128 v[140:143], v18 offset:3072
    ds_read_b128 v[144:147], v18 offset:4096
    ds_read_b128 v[148:151], v18 offset:5120
    ds_read_b128 v[152:155], v18 offset:6144
    ds_read_b128 v[156:159], v18 offset:7168
    s_waitcnt lgkmcnt(0)
    v_add_f32 v32, v32, v128
    v_add_f32 v33, v33, v129
    v_add_f32 v34, v34, v130
    v_add_f32 v35, v35, v131
    v_add_f32 v36, v36, v132
    v_add_f32 v37, v37, v133
    v_add_f32 v38, v38, v134
    v_add_f32 v39, v39, v135
    v_add_f32 v40, v40, v136
    v_add_f32 v41, v41, v137
    v_add_f32 v42, v42, v138
    v_add_f32 v43, v43, v139
    v_add_f32 v44, v44, v140
    v_add_f32 v45, v45, v141
    v_add_f32 v46, v46, v142
    v_add_f32 v47, v47, v143
    v_add_f32 v48, v48, v144
    v_add_f32 v49, v49, v145
    v_add_f32 v50, v50, v146
    v_add_f32 v51, v51, v147
    v_add_f32 v52, v52, v148
    v_add_f32 v53, v53, v149
    v_add_f32 v54, v54, v150
    v_add_f32 v55, v55, v151
    v_add_f32 v56, v56, v152
    v_add_f32 v57, v57, v153
    v_add_f32 v58, v58, v154
    v_add_f32 v59, v59, v155
    v_add_f32 v60, v60, v156
    v_add_f32 v61, v61, v157
    v_add_f32 v62, v62, v158
    v_add_f32 v63, v63, v159
    v_mul_u32_u24 v16, 896, v7
    s_lshl_b32 s44, s43, 7
    v_add_u32 v16, s44, v16
    v_lshl_add_u32 v16, v3, 4, v16
    v_cvt_pk_bf16_f32 v120, v32, v33
    v_cvt_pk_bf16_f32 v121, v34, v35
    v_cvt_pk_bf16_f32 v122, v36, v37
    v_cvt_pk_bf16_f32 v123, v38, v39
    s_nop 1
    v_permlane32_swap_b32 v120, v122
    v_permlane32_swap_b32 v121, v123
    s_nop 1
    buffer_store_dwordx4 v[120:123], v16, s[28:31], 0 offen offset:0
    s_nop 1
    v_cvt_pk_bf16_f32 v120, v40, v41
    v_cvt_pk_bf16_f32 v121, v42, v43
    v_cvt_pk_bf16_f32 v122, v44, v45
    v_cvt_pk_bf16_f32 v123, v46, v47
    s_nop 1
    v_permlane32_swap_b32 v120, v122
    v_permlane32_swap_b32 v121, v123
    s_nop 1
    buffer_store_dwordx4 v[120:123], v16, s[28:31], 0 offen offset:32
    s_nop 1
    v_cvt_pk_bf16_f32 v120, v48, v49
    v_cvt_pk_bf16_f32 v121, v50, v51
    v_cvt_pk_bf16_f32 v122, v52, v53
    v_cvt_pk_bf16_f32 v123, v54, v55
    s_nop 1
    v_permlane32_swap_b32 v120, v122
    v_permlane32_swap_b32 v121, v123
    s_nop 1
    buffer_store_dwordx4 v[120:123], v16, s[28:31], 0 offen offset:64
    s_nop 1
    v_cvt_pk_bf16_f32 v120, v56, v57
    v_cvt_pk_bf16_f32 v121, v58, v59
    v_cvt_pk_bf16_f32 v122, v60, v61
    v_cvt_pk_bf16_f32 v123, v62, v63
    s_nop 1
    v_permlane32_swap_b32 v120, v122
    v_permlane32_swap_b32 v121, v123
    s_nop 1
    buffer_store_dwordx4 v[120:123], v16, s[28:31], 0 offen offset:96
    s_nop 1
LB_end:
    s_endpgm
.section .rodata,"a"
.p2align 6
.amdhsa_kernel attn_kernel
  .amdhsa_next_free_vgpr 512
  .amdhsa_next_free_sgpr 102
  .amdhsa_accum_offset 256
  .amdhsa_group_segment_fixed_size 0
  .amdhsa_kernarg_size 64
  .amdhsa_user_sgpr_count 2
  .amdhsa_user_sgpr_kernarg_segment_ptr 1
  .amdhsa_system_sgpr_workgroup_id_x 1
.end_amdhsa_kernel
.p2align 6
.amdhsa_kernel oproj_kernel
  .amdhsa_next_free_vgpr 288
  .amdhsa_next_free_sgpr 102
  .amdhsa_accum_offset 256
  .amdhsa_group_segment_fixed_size 0
  .amdhsa_kernarg_size 64
  .amdhsa_user_sgpr_count 2
  .amdhsa_user_sgpr_kernarg_segment_ptr 1
  .amdhsa_system_sgpr_workgroup_id_x 1
.end_amdhsa_kernel
```
